```python
import torch

def _softmax(x, axis=-1):
    return torch.softmax(x, dim=axis)
def _gelu(x):
    return torch.nn.functional.gelu(x, approximate="tanh")
def _silu(x):
    return torch.nn.functional.silu(x)
def _sigmoid(x):
    return torch.sigmoid(x)
def _layernorm(x, axis=-1, eps=1e-5):
    m = x.mean(dim=axis, keepdim=True)
    v = x.var(dim=axis, keepdim=True, unbiased=False)
    return (x - m) / torch.sqrt(v + eps)
def _scatter_add(tgt, idx, src, axis=0):
    return tgt.clone().index_add_(axis, idx, src)
def _segment_sum(src, seg, n):
    out = torch.zeros((n,) + src.shape[1:], dtype=src.dtype)
    return out.index_add_(0, seg, src)
def _pad(x, pw):
    flat = tuple(v for pair in reversed(pw) for v in pair)
    return torch.nn.functional.pad(x, flat)

kernel_name = 'recurrent_scan__linear_kernel_hedgehog__glu_gated_reglu__prompt'

def setup_inputs():

    _w = (lambda a: (lambda t: t.to(torch.bfloat16) if t.is_floating_point() else t)(torch.as_tensor(a)))
    def _A_setup():
        B, S, D, H = 1, 2048, 512, 32
        Dh = D // H
        return {
            "x": _w((lambda *s: torch.randn(*s, dtype=torch.bfloat16) * 0.05)(B, S, D)),
            "wqkv": _w((lambda *s: torch.randn(*s, dtype=torch.bfloat16) * 0.8)(D, 3 * D)),
            "w_phi": _w((lambda *s: torch.randn(*s, dtype=torch.bfloat16) * 0.8)(H, Dh, Dh) * (Dh ** -0.5)),
            "wo": _w((lambda *s: torch.randn(*s, dtype=torch.bfloat16) * 0.8)(D, D)),
        }
    _A_in = _A_setup()

    def _B_setup():
        B, S, D, F = 1, 2048, 512, 1376
        return {
            "x": _w((lambda *s: torch.randn(*s, dtype=torch.bfloat16) * 0.05)(B, S, D)),
            "W_gate": _w((lambda *s: torch.randn(*s, dtype=torch.bfloat16) * 0.2)(D, F) * (2.0 / D) ** 0.5),
            "W_up": _w((lambda *s: torch.randn(*s, dtype=torch.bfloat16) * 0.2)(D, F) * (2.0 / D) ** 0.5),
            "W_down": _w((lambda *s: torch.randn(*s, dtype=torch.bfloat16) * 0.2)(F, D) * (1.0 / F) ** 0.5),
        }
    _B_in = _B_setup()

    return {
        "A_x": _A_in["x"],
        "A_wqkv": _A_in["wqkv"],
        "A_w_phi": _A_in["w_phi"],
        "A_wo": _A_in["wo"],
        "B_x": _B_in["x"],
        "B_W_gate": _B_in["W_gate"],
        "B_W_up": _B_in["W_up"],
        "B_W_down": _B_in["W_down"],
    }

def reference(A_x, A_wqkv, A_w_phi, A_wo, B_x, B_W_gate, B_W_up, B_W_down):
    def _A_ref(x, wqkv, w_phi, wo):
        B, S, D = x.shape
        H = 32; Dh = D // H
        qkv = (lambda x, *d: x.permute(*d))((x @ wqkv).reshape(B, S, 3, H, Dh), 2, 0, 3, 1, 4)
        q, k, v = qkv[0], qkv[1], qkv[2]
        pq = torch.einsum("bhsd,hdf->bhsf", q, w_phi)
        pk = torch.einsum("bhsd,hdf->bhsf", k, w_phi)
        phi_q = torch.concatenate([_softmax(pq, axis=-1), _softmax(-pq, axis=-1)], axis=-1)
        phi_k = torch.concatenate([_softmax(pk, axis=-1), _softmax(-pk, axis=-1)], axis=-1)
        kv = torch.einsum("bhsf,bhsd->bhfd", phi_k, v)
        z  = torch.einsum("bhsf->bhf", phi_k)
        num = torch.einsum("bhqf,bhfd->bhqd", phi_q, kv)
        den = torch.einsum("bhqf,bhf->bhq", phi_q, z)[..., None] + 1e-6
        o = num / den
        return (lambda x, *d: x.permute(*d))(o, 0, 2, 1, 3).reshape(B, S, D) @ wo

    def _B_ref(x, W_gate, W_up, W_down):
        gate = torch.einsum("bsd,df->bsf", x, W_gate)
        up = torch.einsum("bsd,df->bsf", x, W_up)
        gate = gate * (lambda x, dt: x.to(dt))(gate > 0, gate.dtype)
        h = gate * up
        return torch.einsum("bsf,fd->bsd", h, W_down)

    x = A_x
    xn = _layernorm(x, axis=-1)
    s = _A_ref(xn, A_wqkv, A_w_phi, A_wo)
    g = _silu(_B_ref(xn, B_W_gate, B_W_up, B_W_down))
    return x + s * g
```

```asm
; @launch grid=(256,1,1) block=(256,1,1) lds=163840
.amdgcn_target "amdgcn-amd-amdhsa--gfx950"
.text
.globl recurrent_scan__linear_kernel_hedgehog__glu_gated_reglu__prompt_kernel
.p2align 8
.type recurrent_scan__linear_kernel_hedgehog__glu_gated_reglu__prompt_kernel,@function
recurrent_scan__linear_kernel_hedgehog__glu_gated_reglu__prompt_kernel:
s_cmp_ge_u32 s2, 0x100
s_cbranch_scc1 L_end
s_load_dwordx16 s[4:19], s[0:1], 0
s_load_dwordx4 s[20:23], s[0:1], 64
s_load_dwordx2 s[24:25], s[0:1], 80
v_and_b32 v1, 63, v0
v_lshrrev_b32 v2, 6, v0
s_nop 0
v_readfirstlane_b32 s68, v2
s_and_b32 s81, s2, 7
s_lshr_b32 s82, s2, 3
s_lshr_b32 s69, s81, 1
s_lshl_b32 s69, s69, 2
s_lshr_b32 s83, s82, 3
s_add_u32 s69, s69, s83
s_and_b32 s72, s81, 1
s_and_b32 s73, s82, 7
s_lshr_b32 s71, s73, 2
s_and_b32 s83, s73, 3
s_lshl_b32 s70, s72, 2
s_add_u32 s70, s70, s83
v_lshrrev_b32 v8, 4, v1
v_and_b32 v9, 15, v1
v_add_u32 v10, 0, v8
v_xor_b32 v11, v9, v10
v_lshlrev_b32 v11, 4, v11
v_lshlrev_b32 v10, 10, v10
v_add_u32 v4, v10, v11
v_add_u32 v10, 4, v8
v_xor_b32 v11, v9, v10
v_lshlrev_b32 v11, 4, v11
v_lshlrev_b32 v10, 10, v10
v_add_u32 v5, v10, v11
v_add_u32 v10, 8, v8
v_xor_b32 v11, v9, v10
v_lshlrev_b32 v11, 4, v11
v_lshlrev_b32 v10, 10, v10
v_add_u32 v6, v10, v11
v_add_u32 v10, 12, v8
v_xor_b32 v11, v9, v10
v_lshlrev_b32 v11, 4, v11
v_lshlrev_b32 v10, 10, v10
v_add_u32 v7, v10, v11
s_lshl_b32 s74, s68, 10
s_lshl_b32 s75, s69, 17
s_lshl_b32 s99, s68, 15
s_add_u32 s75, s75, s99
s_add_u32 s76, s75, 0x4000
s_waitcnt lgkmcnt(0)
s_mov_b32 s28, s4
s_mov_b32 s29, s5
s_mov_b32 s30, 0x200000
s_mov_b32 s31, 0x20000
s_add_u32 s26, s69, s73
s_and_b32 s26, s26, 3
s_add_u32 s0, s26, 0
s_and_b32 s0, s0, 3
s_lshl_b32 s0, s0, 8
s_add_u32 s1, s26, 1
s_and_b32 s1, s1, 3
s_lshl_b32 s1, s1, 8
s_add_u32 s100, s26, 2
s_and_b32 s100, s100, 3
s_lshl_b32 s100, s100, 8
s_add_u32 s101, s26, 3
s_and_b32 s101, s101, 3
s_lshl_b32 s101, s101, 8
s_cmp_eq_u32 s71, 0
s_cbranch_scc1 L_kvpath
L_qpath:
s_add_u32 s3, s75, s0
s_add_u32 m0, s99, 0
s_nop 0
buffer_load_dwordx4 v4, s[28:31], s3 offen lds
v_and_b32 v8, 31, v1
v_lshrrev_b32 v9, 5, v1
v_and_b32 v10, 15, v8
v_lshlrev_b32 v11, 8, v8
v_add_u32 v11, s99, v11
v_add_u32 v12, 0, v9
v_xor_b32 v12, v12, v10
v_lshlrev_b32 v12, 4, v12
v_add_u32 v24, v11, v12
s_add_u32 m0, s99, 0x400
v_add_u32 v12, 2, v9
buffer_load_dwordx4 v5, s[28:31], s3 offen lds
v_xor_b32 v12, v12, v10
v_lshlrev_b32 v12, 4, v12
v_add_u32 v25, v11, v12
v_add_u32 v12, 4, v9
v_xor_b32 v12, v12, v10
v_lshlrev_b32 v12, 4, v12
v_add_u32 v26, v11, v12
v_add_u32 v12, 6, v9
s_add_u32 m0, s99, 0x800
v_xor_b32 v12, v12, v10
buffer_load_dwordx4 v6, s[28:31], s3 offen lds
v_lshlrev_b32 v12, 4, v12
v_add_u32 v27, v11, v12
v_add_u32 v12, 8, v9
v_xor_b32 v12, v12, v10
v_lshlrev_b32 v12, 4, v12
v_add_u32 v28, v11, v12
v_add_u32 v12, 10, v9
v_xor_b32 v12, v12, v10
s_add_u32 m0, s99, 0xc00
v_lshlrev_b32 v12, 4, v12
buffer_load_dwordx4 v7, s[28:31], s3 offen lds
v_add_u32 v29, v11, v12
v_add_u32 v12, 12, v9
v_xor_b32 v12, v12, v10
v_lshlrev_b32 v12, 4, v12
v_add_u32 v30, v11, v12
v_add_u32 v12, 14, v9
v_xor_b32 v12, v12, v10
v_lshlrev_b32 v12, 4, v12
s_add_u32 s3, s76, s0
s_add_u32 m0, s99, 0x1000
v_add_u32 v31, v11, v12
buffer_load_dwordx4 v4, s[28:31], s3 offen lds
v_mov_b32 v32, 0x3f803f80
s_mov_b32 s32, s6
s_mov_b32 s33, s7
s_mov_b32 s34, 0x180000
s_mov_b32 s35, 0x20000
s_lshl_b32 s82, s70, 7
s_cmp_eq_u32 s71, 0
s_cselect_b32 s83, 0x400, 0
s_add_u32 m0, s99, 0x1400
s_nop 0
buffer_load_dwordx4 v5, s[28:31], s3 offen lds
s_add_u32 s79, s82, s83
s_add_u32 s87, s82, 0x800
v_lshrrev_b32 v8, 3, v1
v_and_b32 v9, 7, v1
v_bfe_u32 v10, v8, 1, 1
v_lshlrev_b32 v10, 2, v10
v_xor_b32 v10, v10, v9
v_lshlrev_b32 v10, 4, v10
s_lshl_b32 s82, s68, 3
s_add_u32 m0, s99, 0x1800
v_add_u32 v11, s82, v8
buffer_load_dwordx4 v6, s[28:31], s3 offen lds
s_mov_b32 s83, 0xc00
v_mul_lo_u32 v11, v11, s83
v_add_u32 v20, v10, v11
v_add_u32 v21, 0x18000, v20
s_mov_b32 s64, s24
s_mov_b32 s65, s25
s_mov_b32 s66, 0x782000
s_mov_b32 s67, 0x20000
s_add_u32 m0, s99, 0x1c00
s_nop 0
buffer_load_dwordx4 v7, s[28:31], s3 offen lds
s_mov_b32 s36, s8
s_mov_b32 s37, s9
s_mov_b32 s38, 0x4000
s_mov_b32 s39, 0x20000
s_mov_b32 s40, s10
s_mov_b32 s41, s11
s_mov_b32 s42, 0x80000
s_mov_b32 s43, 0x20000
s_mov_b32 s44, s14
s_add_u32 s3, s75, s1
s_add_u32 m0, s99, 0x2000
s_nop 0
buffer_load_dwordx4 v4, s[28:31], s3 offen lds
s_mov_b32 s45, s15
s_mov_b32 s46, 0x158000
s_mov_b32 s47, 0x20000
s_mov_b32 s48, s16
s_mov_b32 s49, s17
s_mov_b32 s50, 0x158000
s_mov_b32 s51, 0x20000
s_mov_b32 s52, s18
s_mov_b32 s53, s19
s_add_u32 m0, s99, 0x2400
s_nop 0
buffer_load_dwordx4 v5, s[28:31], s3 offen lds
s_mov_b32 s54, 0x158000
s_mov_b32 s55, 0x20000
s_mov_b32 s56, s20
s_mov_b32 s57, s21
s_mov_b32 s58, 0x200000
s_mov_b32 s59, 0x20000
s_mov_b32 s60, s22
s_mov_b32 s61, s23
s_mov_b32 s62, 0x100
s_add_u32 m0, s99, 0x2800
s_nop 0
buffer_load_dwordx4 v6, s[28:31], s3 offen lds
s_mov_b32 s63, 0x20000
v_lshlrev_b32 v22, 4, v1
s_lshl_b32 s81, s26, 1
s_add_u32 s81, s81, 0
s_and_b32 s81, s81, 7
s_mul_i32 s4, s81, 0x30000
s_mul_i32 s12, s81, 0x2b000
s_lshl_b32 s81, s26, 1
s_add_u32 s81, s81, 1
s_add_u32 m0, s99, 0x2c00
s_nop 0
buffer_load_dwordx4 v7, s[28:31], s3 offen lds
s_and_b32 s81, s81, 7
s_mul_i32 s5, s81, 0x30000
s_mul_i32 s13, s81, 0x2b000
s_lshl_b32 s81, s26, 1
s_add_u32 s81, s81, 2
s_and_b32 s81, s81, 7
s_mul_i32 s6, s81, 0x30000
s_mul_i32 s14, s81, 0x2b000
s_lshl_b32 s81, s26, 1
s_add_u32 s3, s76, s1
s_add_u32 m0, s99, 0x3000
s_nop 0
buffer_load_dwordx4 v4, s[28:31], s3 offen lds
s_add_u32 s81, s81, 3
s_and_b32 s81, s81, 7
s_mul_i32 s7, s81, 0x30000
s_mul_i32 s15, s81, 0x2b000
s_lshl_b32 s81, s26, 1
s_add_u32 s81, s81, 4
s_and_b32 s81, s81, 7
s_mul_i32 s8, s81, 0x30000
s_mul_i32 s16, s81, 0x2b000
s_add_u32 m0, s99, 0x3400
s_nop 0
buffer_load_dwordx4 v5, s[28:31], s3 offen lds
s_lshl_b32 s81, s26, 1
s_add_u32 s81, s81, 5
s_and_b32 s81, s81, 7
s_mul_i32 s9, s81, 0x30000
s_mul_i32 s17, s81, 0x2b000
s_lshl_b32 s81, s26, 1
s_add_u32 s81, s81, 6
s_and_b32 s81, s81, 7
s_mul_i32 s10, s81, 0x30000
s_add_u32 m0, s99, 0x3800
s_nop 0
buffer_load_dwordx4 v6, s[28:31], s3 offen lds
s_mul_i32 s18, s81, 0x2b000
s_lshl_b32 s81, s26, 1
s_add_u32 s81, s81, 7
s_and_b32 s81, s81, 7
s_mul_i32 s11, s81, 0x30000
s_mul_i32 s19, s81, 0x2b000
v_and_b32 v8, 31, v1
v_lshrrev_b32 v9, 5, v1
v_lshlrev_b32 v12, 2, v9
s_add_u32 m0, s99, 0x3c00
v_sub_u32 v12, v8, v12
buffer_load_dwordx4 v7, s[28:31], s3 offen lds
v_mov_b32 v14, 0x3f80
v_mov_b32 v15, 0x3f800000
v_cmp_eq_u32 vcc, 0, v12
s_nop 1
v_cndmask_b32 v36, 0, v14, vcc
v_cmp_eq_u32 vcc, 1, v12
s_nop 1
v_cndmask_b32 v36, v36, v15, vcc
v_cmp_eq_u32 vcc, 2, v12
s_nop 1
v_cndmask_b32 v37, 0, v14, vcc
s_add_u32 s3, s75, s100
s_add_u32 m0, s99, 0x4000
v_cmp_eq_u32 vcc, 3, v12
buffer_load_dwordx4 v4, s[28:31], s3 offen lds
s_nop 0
v_cndmask_b32 v37, v37, v15, vcc
v_cmp_eq_u32 vcc, 8, v12
s_nop 1
v_cndmask_b32 v38, 0, v14, vcc
v_cmp_eq_u32 vcc, 9, v12
s_nop 1
v_cndmask_b32 v38, v38, v15, vcc
v_cmp_eq_u32 vcc, 10, v12
s_nop 1
v_cndmask_b32 v39, 0, v14, vcc
v_cmp_eq_u32 vcc, 11, v12
s_add_u32 m0, s99, 0x4400
s_nop 0
v_cndmask_b32 v39, v39, v15, vcc
buffer_load_dwordx4 v5, s[28:31], s3 offen lds
v_cmp_eq_u32 vcc, 16, v12
s_nop 1
v_cndmask_b32 v40, 0, v14, vcc
v_cmp_eq_u32 vcc, 17, v12
s_nop 1
v_cndmask_b32 v40, v40, v15, vcc
v_cmp_eq_u32 vcc, 18, v12
s_nop 1
v_cndmask_b32 v41, 0, v14, vcc
v_cmp_eq_u32 vcc, 19, v12
s_nop 1
v_cndmask_b32 v41, v41, v15, vcc
s_add_u32 m0, s99, 0x4800
v_cmp_eq_u32 vcc, 24, v12
buffer_load_dwordx4 v6, s[28:31], s3 offen lds
s_nop 0
v_cndmask_b32 v42, 0, v14, vcc
v_cmp_eq_u32 vcc, 25, v12
s_nop 1
v_cndmask_b32 v42, v42, v15, vcc
v_cmp_eq_u32 vcc, 26, v12
s_nop 1
v_cndmask_b32 v43, 0, v14, vcc
v_cmp_eq_u32 vcc, 27, v12
s_nop 1
v_cndmask_b32 v43, v43, v15, vcc
v_mov_b32 v44, 0
s_add_u32 m0, s99, 0x4c00
v_mov_b32 v45, 0
buffer_load_dwordx4 v7, s[28:31], s3 offen lds
v_mov_b32 v46, 0
v_mov_b32 v47, 0
v_add_u32 v13, 0x26800, v22
ds_write_b128 v13, v[44:47] offset:0
ds_write_b128 v13, v[44:47] offset:1024
s_mul_i32 s81, s70, 7
s_add_u32 s81, s81, 32
s_cmp_eq_u32 s70, 7
s_cselect_b32 s81, 0x50, s81
s_add_u32 s3, s76, s100
s_add_u32 m0, s99, 0x5000
s_nop 0
buffer_load_dwordx4 v4, s[28:31], s3 offen lds
s_lshl_b32 s80, s81, 5
s_lshl_b32 s82, s69, 2
s_add_u32 s82, s82, s68
s_mul_i32 s82, s82, 0x56
s_add_u32 s82, s82, s81
s_lshl_b32 s85, s82, 10
s_add_u32 s86, s85, 0x1000
v_lshrrev_b32 v8, 4, v1
v_and_b32 v9, 15, v1
s_add_u32 m0, s99, 0x5400
v_lshlrev_b32 v10, 1, v8
buffer_load_dwordx4 v5, s[28:31], s3 offen lds
v_xor_b32 v9, v9, v10
s_lshl_b32 s81, s68, 2
v_add_u32 v11, s81, v8
s_mov_b32 s82, 0xac0
v_mul_lo_u32 v11, v11, s82
v_xor_b32 v10, 0, v9
v_min_u32 v10, 13, v10
v_lshlrev_b32 v10, 4, v10
s_add_u32 m0, s99, 0x5800
v_add_u32 v225, v10, v11
buffer_load_dwordx4 v6, s[28:31], s3 offen lds
v_add_u32 v226, 0xac00, v225
v_add_u32 v227, 0x15800, v225
v_add_u32 v228, 0x20400, v225
v_xor_b32 v10, 8, v9
v_min_u32 v10, 13, v10
v_lshlrev_b32 v10, 4, v10
v_add_u32 v229, v10, v11
v_add_u32 v230, 0xac00, v229
s_add_u32 m0, s99, 0x5c00
v_add_u32 v231, 0x15800, v229
buffer_load_dwordx4 v7, s[28:31], s3 offen lds
v_add_u32 v232, 0x20400, v229
v_and_b32 v12, 15, v1
v_lshrrev_b32 v8, 2, v12
v_and_b32 v9, 3, v12
v_bfe_u32 v10, v1, 4, 1
v_lshrrev_b32 v11, 5, v1
v_lshrrev_b32 v12, 1, v9
v_lshlrev_b32 v12, 4, v12
s_add_u32 s3, s75, s101
s_add_u32 m0, s99, 0x6000
v_and_b32 v14, 1, v9
buffer_load_dwordx4 v4, s[28:31], s3 offen lds
v_lshlrev_b32 v14, 3, v14
v_add_u32 v12, v12, v14
v_lshlrev_b32 v14, 5, v10
v_add_u32 v12, v12, v14
v_mul_u32_u24 v14, 8, v11
v_add_u32 v14, v14, v8
v_lshlrev_b32 v14, 7, v14
v_add_u32 v12, v12, v14
s_add_u32 m0, s99, 0x6400
v_bfe_u32 v13, v8, 1, 1
buffer_load_dwordx4 v5, s[28:31], s3 offen lds
v_xor_b32 v14, 0, v13
v_lshlrev_b32 v14, 6, v14
v_add_u32 v200, v12, v14
v_add_u32 v201, 0x20000, v200
v_xor_b32 v14, 1, v13
v_lshlrev_b32 v14, 6, v14
v_add_u32 v202, v12, v14
v_add_u32 v203, 0x20000, v202
s_add_u32 m0, s99, 0x6800
v_lshlrev_b32 v13, 2, v11
buffer_load_dwordx4 v6, s[28:31], s3 offen lds
v_add_u32 v13, v13, v8
v_lshlrev_b32 v13, 5, v13
v_lshlrev_b32 v14, 3, v9
v_add_u32 v13, v13, v14
v_add_u32 v13, 0x26000, v13
v_mov_b32 v15, 0x26800
v_cmp_eq_u32 vcc, 0, v10
s_nop 1
v_cndmask_b32 v18, v15, v13, vcc
s_add_u32 m0, s99, 0x6c00
v_cmp_eq_u32 vcc, 1, v10
buffer_load_dwordx4 v7, s[28:31], s3 offen lds
s_nop 0
v_cndmask_b32 v19, v15, v13, vcc
v_mov_b32 v242, 0
v_lshlrev_b32 v241, 4, v1
s_waitcnt vmcnt(20)
ds_read_b128 v[64:67], v24 offset:0
ds_read_b128 v[68:71], v25 offset:0
ds_read_b128 v[72:75], v26 offset:0
ds_read_b128 v[76:79], v27 offset:0
s_add_u32 s3, s76, s101
s_add_u32 m0, s99, 0x7000
ds_read_b128 v[80:83], v28 offset:0
buffer_load_dwordx4 v4, s[28:31], s3 offen lds
ds_read_b128 v[84:87], v29 offset:0
ds_read_b128 v[88:91], v30 offset:0
ds_read_b128 v[92:95], v31 offset:0
ds_read_b128 a[0:3], v24 offset:0
ds_read_b128 a[4:7], v25 offset:0
ds_read_b128 a[8:11], v26 offset:0
ds_read_b128 a[12:15], v27 offset:0
ds_read_b128 a[16:19], v28 offset:0
s_add_u32 m0, s99, 0x7400
ds_read_b128 a[20:23], v29 offset:0
buffer_load_dwordx4 v5, s[28:31], s3 offen lds
ds_read_b128 a[24:27], v30 offset:0
ds_read_b128 a[28:31], v31 offset:0
s_waitcnt vmcnt(14)
ds_read_b128 v[96:99], v24 offset:8192
ds_read_b128 v[100:103], v25 offset:8192
ds_read_b128 v[104:107], v26 offset:8192
ds_read_b128 v[108:111], v27 offset:8192
ds_read_b128 v[112:115], v28 offset:8192
s_add_u32 m0, s99, 0x7800
ds_read_b128 v[116:119], v29 offset:8192
buffer_load_dwordx4 v6, s[28:31], s3 offen lds
ds_read_b128 v[120:123], v30 offset:8192
ds_read_b128 v[124:127], v31 offset:8192
ds_read_b128 a[32:35], v24 offset:8192
ds_read_b128 a[36:39], v25 offset:8192
ds_read_b128 a[40:43], v26 offset:8192
ds_read_b128 a[44:47], v27 offset:8192
ds_read_b128 a[48:51], v28 offset:8192
ds_read_b128 a[52:55], v29 offset:8192
s_add_u32 m0, s99, 0x7c00
ds_read_b128 a[56:59], v30 offset:8192
buffer_load_dwordx4 v7, s[28:31], s3 offen lds
ds_read_b128 a[60:63], v31 offset:8192
s_waitcnt lgkmcnt(15)
v_dot2c_f32_bf16 v44, v32, v64
v_dot2c_f32_bf16 v46, v64, v64
v_dot2c_f32_bf16 v45, v32, v65
v_dot2c_f32_bf16 v47, v65, v65
v_dot2c_f32_bf16 v44, v32, v66
v_dot2c_f32_bf16 v46, v66, v66
v_dot2c_f32_bf16 v45, v32, v67
s_cmp_ge_u32 s2, 16
s_cbranch_scc1 L_nozero_1
v_mov_b32 v128, 0
v_mov_b32 v129, 0
v_mov_b32 v130, 0
v_mov_b32 v131, 0
s_lshl_b32 s100, s2, 13
s_lshl_b32 s101, s68, 11
s_add_u32 s100, s100, s101
s_add_u32 s100, s100, 0x760000
buffer_store_dwordx4 v[128:131], v22, s[64:67], s100 offen sc1
buffer_store_dwordx4 v[128:131], v22, s[64:67], s100 offen offset:1024 sc1
v_lshrrev_b32 v132, 3, v1
v_min_u32 v132, 2, v132
v_lshlrev_b32 v132, 11, v132
v_and_b32 v133, 7, v1
v_lshlrev_b32 v133, 4, v133
v_add_u32 v132, v132, v133
s_lshl_b32 s101, s2, 7
s_add_u32 s101, s101, 0x780000
buffer_store_dwordx4 v[128:131], v132, s[64:67], s101 offen sc1
L_nozero_1:
v_dot2c_f32_bf16 v47, v67, v67
v_dot2c_f32_bf16 v44, v32, v68
v_dot2c_f32_bf16 v46, v68, v68
v_dot2c_f32_bf16 v45, v32, v69
v_dot2c_f32_bf16 v47, v69, v69
v_dot2c_f32_bf16 v44, v32, v70
v_dot2c_f32_bf16 v46, v70, v70
v_dot2c_f32_bf16 v45, v32, v71
v_dot2c_f32_bf16 v47, v71, v71
s_add_u32 s77, s79, s4
s_add_u32 m0, s74, 0x20000
v_dot2c_f32_bf16 v44, v32, v72
buffer_load_dwordx4 v20, s[32:35], s77 offen lds
v_dot2c_f32_bf16 v46, v72, v72
v_dot2c_f32_bf16 v45, v32, v73
v_dot2c_f32_bf16 v47, v73, v73
v_dot2c_f32_bf16 v44, v32, v74
v_dot2c_f32_bf16 v46, v74, v74
v_dot2c_f32_bf16 v45, v32, v75
v_dot2c_f32_bf16 v47, v75, v75
v_dot2c_f32_bf16 v44, v32, v76
s_add_u32 m0, s74, 0x21000
v_dot2c_f32_bf16 v46, v76, v76
buffer_load_dwordx4 v21, s[32:35], s77 offen lds
v_dot2c_f32_bf16 v45, v32, v77
v_dot2c_f32_bf16 v47, v77, v77
v_dot2c_f32_bf16 v44, v32, v78
v_dot2c_f32_bf16 v46, v78, v78
v_dot2c_f32_bf16 v45, v32, v79
v_dot2c_f32_bf16 v47, v79, v79
v_dot2c_f32_bf16 v44, v32, v80
v_dot2c_f32_bf16 v46, v80, v80
s_add_u32 s77, s79, s5
s_add_u32 m0, s74, 0x22000
v_dot2c_f32_bf16 v45, v32, v81
buffer_load_dwordx4 v20, s[32:35], s77 offen lds
v_dot2c_f32_bf16 v47, v81, v81
v_dot2c_f32_bf16 v44, v32, v82
v_dot2c_f32_bf16 v46, v82, v82
v_dot2c_f32_bf16 v45, v32, v83
v_dot2c_f32_bf16 v47, v83, v83
v_dot2c_f32_bf16 v44, v32, v84
v_dot2c_f32_bf16 v46, v84, v84
v_dot2c_f32_bf16 v45, v32, v85
s_add_u32 m0, s74, 0x23000
v_dot2c_f32_bf16 v47, v85, v85
buffer_load_dwordx4 v21, s[32:35], s77 offen lds
v_dot2c_f32_bf16 v44, v32, v86
v_dot2c_f32_bf16 v46, v86, v86
v_dot2c_f32_bf16 v45, v32, v87
v_dot2c_f32_bf16 v47, v87, v87
v_dot2c_f32_bf16 v44, v32, v88
v_dot2c_f32_bf16 v46, v88, v88
v_dot2c_f32_bf16 v45, v32, v89
v_dot2c_f32_bf16 v47, v89, v89
s_add_u32 s77, s79, s6
s_add_u32 m0, s74, 0x24000
v_dot2c_f32_bf16 v44, v32, v90
buffer_load_dwordx4 v20, s[32:35], s77 offen lds
v_dot2c_f32_bf16 v46, v90, v90
v_dot2c_f32_bf16 v45, v32, v91
v_dot2c_f32_bf16 v47, v91, v91
v_dot2c_f32_bf16 v44, v32, v92
v_dot2c_f32_bf16 v46, v92, v92
v_dot2c_f32_bf16 v45, v32, v93
v_dot2c_f32_bf16 v47, v93, v93
v_dot2c_f32_bf16 v44, v32, v94
s_add_u32 m0, s74, 0x25000
v_dot2c_f32_bf16 v46, v94, v94
buffer_load_dwordx4 v21, s[32:35], s77 offen lds
v_dot2c_f32_bf16 v45, v32, v95
v_dot2c_f32_bf16 v47, v95, v95
s_waitcnt vmcnt(14)
ds_read_b128 v[64:67], v24 offset:16384
ds_read_b128 v[68:71], v25 offset:16384
ds_read_b128 v[72:75], v26 offset:16384
ds_read_b128 v[76:79], v27 offset:16384
ds_read_b128 v[80:83], v28 offset:16384
s_and_b32 s3, s68, 1
s_lshl_b32 s3, s3, 10
s_lshl_b32 s98, s70, 11
s_add_u32 s98, s98, s3
s_add_u32 m0, s3, 0x26000
ds_read_b128 v[84:87], v29 offset:16384
buffer_load_dwordx4 v22, s[36:39], s98 offen lds
ds_read_b128 v[88:91], v30 offset:16384
ds_read_b128 v[92:95], v31 offset:16384
ds_read_b128 a[64:67], v24 offset:16384
ds_read_b128 a[68:71], v25 offset:16384
ds_read_b128 a[72:75], v26 offset:16384
ds_read_b128 a[76:79], v27 offset:16384
ds_read_b128 a[80:83], v28 offset:16384
ds_read_b128 a[84:87], v29 offset:16384
s_lshl_b32 s0, s2, 2
s_add_u32 s0, s0, s68
s_mul_i32 s1, s0, 0x580
v_min_u32 v134, 10, v1
v_lshlrev_b32 v134, 7, v134
buffer_load_dword v255, v134, s[44:47], s1 offen
ds_read_b128 a[88:91], v30 offset:16384
ds_read_b128 a[92:95], v31 offset:16384
v_dot2c_f32_bf16 v44, v32, v96
v_dot2c_f32_bf16 v46, v96, v96
v_dot2c_f32_bf16 v45, v32, v97
v_dot2c_f32_bf16 v47, v97, v97
v_dot2c_f32_bf16 v44, v32, v98
v_dot2c_f32_bf16 v46, v98, v98
v_dot2c_f32_bf16 v45, v32, v99
s_mul_i32 s1, s0, 0x580
v_min_u32 v134, 10, v1
v_lshlrev_b32 v134, 7, v134
buffer_load_dword v255, v134, s[48:51], s1 offen
v_dot2c_f32_bf16 v47, v99, v99
s_waitcnt lgkmcnt(15)
v_dot2c_f32_bf16 v44, v32, v100
v_dot2c_f32_bf16 v46, v100, v100
v_dot2c_f32_bf16 v45, v32, v101
v_dot2c_f32_bf16 v47, v101, v101
v_dot2c_f32_bf16 v44, v32, v102
v_dot2c_f32_bf16 v46, v102, v102
v_dot2c_f32_bf16 v45, v32, v103
v_dot2c_f32_bf16 v47, v103, v103
s_mul_i32 s1, s0, 0x600
v_min_u32 v134, 11, v1
v_lshlrev_b32 v134, 7, v134
buffer_load_dword v255, v134, s[32:35], s1 offen
v_dot2c_f32_bf16 v44, v32, v104
v_dot2c_f32_bf16 v46, v104, v104
v_dot2c_f32_bf16 v45, v32, v105
v_dot2c_f32_bf16 v47, v105, v105
v_dot2c_f32_bf16 v44, v32, v106
v_dot2c_f32_bf16 v46, v106, v106
v_dot2c_f32_bf16 v45, v32, v107
v_dot2c_f32_bf16 v47, v107, v107
v_dot2c_f32_bf16 v44, v32, v108
s_mul_i32 s1, s0, 0x580
v_min_u32 v134, 10, v1
v_lshlrev_b32 v134, 7, v134
buffer_load_dword v255, v134, s[52:55], s1 offen
v_dot2c_f32_bf16 v46, v108, v108
v_dot2c_f32_bf16 v45, v32, v109
v_dot2c_f32_bf16 v47, v109, v109
v_dot2c_f32_bf16 v44, v32, v110
v_dot2c_f32_bf16 v46, v110, v110
v_dot2c_f32_bf16 v45, v32, v111
v_dot2c_f32_bf16 v47, v111, v111
v_dot2c_f32_bf16 v44, v32, v112
v_dot2c_f32_bf16 v46, v112, v112
s_mul_i32 s1, s0, 0x200
v_min_u32 v134, 3, v1
v_lshlrev_b32 v134, 7, v134
buffer_load_dword v255, v134, s[40:43], s1 offen
v_dot2c_f32_bf16 v45, v32, v113
v_dot2c_f32_bf16 v47, v113, v113
v_dot2c_f32_bf16 v44, v32, v114
v_dot2c_f32_bf16 v46, v114, v114
v_dot2c_f32_bf16 v45, v32, v115
v_dot2c_f32_bf16 v47, v115, v115
v_dot2c_f32_bf16 v44, v32, v116
v_dot2c_f32_bf16 v46, v116, v116
v_dot2c_f32_bf16 v45, v32, v117
s_getpc_b64 s[100:101]
L_pc_2:
s_sub_u32 s100, s100, L_pc_2-recurrent_scan__linear_kernel_hedgehog__glu_gated_reglu__prompt_kernel
s_subb_u32 s101, s101, 0
s_lshr_b32 s98, s2, 3
s_lshl_b32 s98, s98, 11
v_lshlrev_b32 v23, 3, v0
v_add_u32 v23, s98, v23
s_mov_b32 s98, L_codeend-recurrent_scan__linear_kernel_hedgehog__glu_gated_reglu__prompt_kernel-8
v_min_u32 v23, s98, v23
global_load_dwordx2 v[254:255], v23, s[100:101]
v_dot2c_f32_bf16 v47, v117, v117
v_dot2c_f32_bf16 v44, v32, v118
v_dot2c_f32_bf16 v46, v118, v118
v_dot2c_f32_bf16 v45, v32, v119
v_dot2c_f32_bf16 v47, v119, v119
v_dot2c_f32_bf16 v44, v32, v120
v_dot2c_f32_bf16 v46, v120, v120
v_dot2c_f32_bf16 v45, v32, v121
v_dot2c_f32_bf16 v47, v121, v121
v_dot2c_f32_bf16 v44, v32, v122
v_dot2c_f32_bf16 v46, v122, v122
v_dot2c_f32_bf16 v45, v32, v123
v_dot2c_f32_bf16 v47, v123, v123
v_dot2c_f32_bf16 v44, v32, v124
v_dot2c_f32_bf16 v46, v124, v124
v_dot2c_f32_bf16 v45, v32, v125
v_dot2c_f32_bf16 v47, v125, v125
v_dot2c_f32_bf16 v44, v32, v126
v_dot2c_f32_bf16 v46, v126, v126
v_dot2c_f32_bf16 v45, v32, v127
v_dot2c_f32_bf16 v47, v127, v127
s_waitcnt vmcnt(13)
ds_read_b128 v[96:99], v24 offset:24576
ds_read_b128 v[100:103], v25 offset:24576
ds_read_b128 v[104:107], v26 offset:24576
ds_read_b128 v[108:111], v27 offset:24576
ds_read_b128 v[112:115], v28 offset:24576
ds_read_b128 v[116:119], v29 offset:24576
ds_read_b128 v[120:123], v30 offset:24576
ds_read_b128 v[124:127], v31 offset:24576
ds_read_b128 a[96:99], v24 offset:24576
ds_read_b128 a[100:103], v25 offset:24576
ds_read_b128 a[104:107], v26 offset:24576
ds_read_b128 a[108:111], v27 offset:24576
ds_read_b128 a[112:115], v28 offset:24576
ds_read_b128 a[116:119], v29 offset:24576
ds_read_b128 a[120:123], v30 offset:24576
ds_read_b128 a[124:127], v31 offset:24576
v_dot2c_f32_bf16 v44, v32, v64
v_dot2c_f32_bf16 v46, v64, v64
v_dot2c_f32_bf16 v45, v32, v65
v_dot2c_f32_bf16 v47, v65, v65
v_dot2c_f32_bf16 v44, v32, v66
v_dot2c_f32_bf16 v46, v66, v66
v_dot2c_f32_bf16 v45, v32, v67
v_dot2c_f32_bf16 v47, v67, v67
s_waitcnt lgkmcnt(15)
v_dot2c_f32_bf16 v44, v32, v68
v_dot2c_f32_bf16 v46, v68, v68
v_dot2c_f32_bf16 v45, v32, v69
v_dot2c_f32_bf16 v47, v69, v69
v_dot2c_f32_bf16 v44, v32, v70
v_dot2c_f32_bf16 v46, v70, v70
v_dot2c_f32_bf16 v45, v32, v71
v_dot2c_f32_bf16 v47, v71, v71
v_dot2c_f32_bf16 v44, v32, v72
v_dot2c_f32_bf16 v46, v72, v72
v_dot2c_f32_bf16 v45, v32, v73
v_dot2c_f32_bf16 v47, v73, v73
v_dot2c_f32_bf16 v44, v32, v74
v_dot2c_f32_bf16 v46, v74, v74
v_dot2c_f32_bf16 v45, v32, v75
v_dot2c_f32_bf16 v47, v75, v75
v_dot2c_f32_bf16 v44, v32, v76
v_dot2c_f32_bf16 v46, v76, v76
v_dot2c_f32_bf16 v45, v32, v77
v_dot2c_f32_bf16 v47, v77, v77
v_dot2c_f32_bf16 v44, v32, v78
v_dot2c_f32_bf16 v46, v78, v78
v_dot2c_f32_bf16 v45, v32, v79
v_dot2c_f32_bf16 v47, v79, v79
v_dot2c_f32_bf16 v44, v32, v80
v_dot2c_f32_bf16 v46, v80, v80
v_dot2c_f32_bf16 v45, v32, v81
v_dot2c_f32_bf16 v47, v81, v81
v_dot2c_f32_bf16 v44, v32, v82
v_dot2c_f32_bf16 v46, v82, v82
v_dot2c_f32_bf16 v45, v32, v83
v_dot2c_f32_bf16 v47, v83, v83
v_dot2c_f32_bf16 v44, v32, v84
v_dot2c_f32_bf16 v46, v84, v84
v_dot2c_f32_bf16 v45, v32, v85
v_dot2c_f32_bf16 v47, v85, v85
v_dot2c_f32_bf16 v44, v32, v86
v_dot2c_f32_bf16 v46, v86, v86
v_dot2c_f32_bf16 v45, v32, v87
v_dot2c_f32_bf16 v47, v87, v87
v_dot2c_f32_bf16 v44, v32, v88
v_dot2c_f32_bf16 v46, v88, v88
v_dot2c_f32_bf16 v45, v32, v89
v_dot2c_f32_bf16 v47, v89, v89
v_dot2c_f32_bf16 v44, v32, v90
v_dot2c_f32_bf16 v46, v90, v90
v_dot2c_f32_bf16 v45, v32, v91
v_dot2c_f32_bf16 v47, v91, v91
v_dot2c_f32_bf16 v44, v32, v92
v_dot2c_f32_bf16 v46, v92, v92
v_dot2c_f32_bf16 v45, v32, v93
v_dot2c_f32_bf16 v47, v93, v93
v_dot2c_f32_bf16 v44, v32, v94
v_dot2c_f32_bf16 v46, v94, v94
v_dot2c_f32_bf16 v45, v32, v95
v_dot2c_f32_bf16 v47, v95, v95
v_dot2c_f32_bf16 v44, v32, v96
v_dot2c_f32_bf16 v46, v96, v96
v_dot2c_f32_bf16 v45, v32, v97
v_dot2c_f32_bf16 v47, v97, v97
v_dot2c_f32_bf16 v44, v32, v98
v_dot2c_f32_bf16 v46, v98, v98
v_dot2c_f32_bf16 v45, v32, v99
v_dot2c_f32_bf16 v47, v99, v99
s_waitcnt lgkmcnt(14)
v_dot2c_f32_bf16 v44, v32, v100
v_dot2c_f32_bf16 v46, v100, v100
v_dot2c_f32_bf16 v45, v32, v101
v_dot2c_f32_bf16 v47, v101, v101
v_dot2c_f32_bf16 v44, v32, v102
v_dot2c_f32_bf16 v46, v102, v102
v_dot2c_f32_bf16 v45, v32, v103
v_dot2c_f32_bf16 v47, v103, v103
s_waitcnt lgkmcnt(13)
v_dot2c_f32_bf16 v44, v32, v104
v_dot2c_f32_bf16 v46, v104, v104
v_dot2c_f32_bf16 v45, v32, v105
v_dot2c_f32_bf16 v47, v105, v105
v_dot2c_f32_bf16 v44, v32, v106
v_dot2c_f32_bf16 v46, v106, v106
v_dot2c_f32_bf16 v45, v32, v107
v_dot2c_f32_bf16 v47, v107, v107
s_waitcnt lgkmcnt(12)
v_dot2c_f32_bf16 v44, v32, v108
v_dot2c_f32_bf16 v46, v108, v108
v_dot2c_f32_bf16 v45, v32, v109
v_dot2c_f32_bf16 v47, v109, v109
v_dot2c_f32_bf16 v44, v32, v110
v_dot2c_f32_bf16 v46, v110, v110
v_dot2c_f32_bf16 v45, v32, v111
v_dot2c_f32_bf16 v47, v111, v111
s_waitcnt lgkmcnt(11)
v_dot2c_f32_bf16 v44, v32, v112
v_dot2c_f32_bf16 v46, v112, v112
v_dot2c_f32_bf16 v45, v32, v113
v_dot2c_f32_bf16 v47, v113, v113
v_dot2c_f32_bf16 v44, v32, v114
v_dot2c_f32_bf16 v46, v114, v114
v_dot2c_f32_bf16 v45, v32, v115
v_dot2c_f32_bf16 v47, v115, v115
s_waitcnt lgkmcnt(10)
v_dot2c_f32_bf16 v44, v32, v116
v_dot2c_f32_bf16 v46, v116, v116
v_dot2c_f32_bf16 v45, v32, v117
v_dot2c_f32_bf16 v47, v117, v117
v_dot2c_f32_bf16 v44, v32, v118
v_dot2c_f32_bf16 v46, v118, v118
v_dot2c_f32_bf16 v45, v32, v119
v_dot2c_f32_bf16 v47, v119, v119
s_waitcnt lgkmcnt(9)
v_dot2c_f32_bf16 v44, v32, v120
v_dot2c_f32_bf16 v46, v120, v120
v_dot2c_f32_bf16 v45, v32, v121
v_dot2c_f32_bf16 v47, v121, v121
v_dot2c_f32_bf16 v44, v32, v122
v_dot2c_f32_bf16 v46, v122, v122
v_dot2c_f32_bf16 v45, v32, v123
v_dot2c_f32_bf16 v47, v123, v123
s_waitcnt lgkmcnt(8)
v_dot2c_f32_bf16 v44, v32, v124
v_dot2c_f32_bf16 v46, v124, v124
v_dot2c_f32_bf16 v45, v32, v125
v_dot2c_f32_bf16 v47, v125, v125
v_dot2c_f32_bf16 v44, v32, v126
v_dot2c_f32_bf16 v46, v126, v126
v_dot2c_f32_bf16 v45, v32, v127
v_dot2c_f32_bf16 v47, v127, v127
s_waitcnt vmcnt(6)
s_waitcnt lgkmcnt(0)
s_barrier
s_cmp_ge_u32 s2, 16
s_cbranch_scc1 L_nogate_3
s_cmp_lg_u32 s68, 0
s_cbranch_scc1 L_nogate_3
s_mov_b64 exec, 1
v_mov_b32 v8, 0
v_mov_b32 v9, 1
buffer_atomic_add v9, v8, s[60:63], 0 offen sc1
s_mov_b64 exec, -1
L_nogate_3:
ds_read_b64_tr_b16 a[160:161], v18 offset:0
ds_read_b64_tr_b16 a[162:163], v18 offset:256
ds_read_b64_tr_b16 a[164:165], v19 offset:512
ds_read_b64_tr_b16 a[166:167], v19 offset:768
ds_read_b64_tr_b16 a[168:169], v18 offset:1024
ds_read_b64_tr_b16 a[170:171], v18 offset:1280
ds_read_b64_tr_b16 a[172:173], v19 offset:1536
ds_read_b64_tr_b16 a[174:175], v19 offset:1792
v_add_f32 v64, v44, v45
v_add_f32 v65, v46, v47
s_nop 1
v_permlane32_swap_b32 v64, v65
v_add_f32 v66, v64, v65
s_add_u32 s77, s79, s7
s_add_u32 m0, s74, 0
s_nop 0
buffer_load_dwordx4 v20, s[32:35], s77 offen lds
v_mov_b32 v67, v66
s_nop 1
v_permlane32_swap_b32 v66, v67
v_mul_f32 v48, 0xbb000000, v66
v_mul_f32 v67, 0x3b000000, v67
v_mul_f32 v64, v48, v48
v_mov_b32 v49, v48
v_mov_b32 v50, v48
v_mov_b32 v51, v48
v_mov_b32 v52, v48
v_mov_b32 v53, v48
v_mov_b32 v54, v48
v_mov_b32 v55, v48
v_mov_b32 v56, v48
v_mov_b32 v57, v48
v_mov_b32 v58, v48
v_mov_b32 v59, v48
v_mov_b32 v60, v48
v_mov_b32 v61, v48
v_mov_b32 v62, v48
v_mov_b32 v63, v48
v_sub_f32 v67, v67, v64
v_max_f32 v67, 0, v67
v_add_f32 v67, 0x3727c5ac, v67
v_rsq_f32 v2, v67
s_nop 0
v_mul_f32 v3, 0x3fb8aa3b, v2
v_mul_f32 v4, v2, v2
v_mfma_f32_32x32x16_bf16 v[64:79], v[36:39], a[0:3], v[48:63]
v_mfma_f32_32x32x16_bf16 v[64:79], v[40:43], a[4:7], v[64:79]
v_mfma_f32_32x32x16_bf16 v[80:95], v[36:39], a[8:11], v[48:63]
v_mfma_f32_32x32x16_bf16 v[80:95], v[40:43], a[12:15], v[80:95]
s_add_u32 m0, s74, 0x1000
s_nop 0
buffer_load_dwordx4 v21, s[32:35], s77 offen lds
v_mfma_f32_32x32x16_bf16 v[96:111], v[36:39], a[16:19], v[48:63]
s_nop 5
v_cvt_pk_bf16_f32 v112, v64, v65
v_cvt_pk_bf16_f32 v113, v66, v67
v_cvt_pk_bf16_f32 v114, v68, v69
v_cvt_pk_bf16_f32 v115, v70, v71
v_cvt_pk_bf16_f32 v116, v72, v73
v_cvt_pk_bf16_f32 v117, v74, v75
v_cvt_pk_bf16_f32 v118, v76, v77
v_cvt_pk_bf16_f32 v119, v78, v79
v_mfma_f32_32x32x16_bf16 v[96:111], v[40:43], a[20:23], v[96:111]
v_accvgpr_write_b32 a0, v112
v_accvgpr_write_b32 a1, v113
v_accvgpr_write_b32 a2, v114
v_accvgpr_write_b32 a3, v115
v_accvgpr_write_b32 a4, v116
v_accvgpr_write_b32 a5, v117
v_accvgpr_write_b32 a6, v118
v_accvgpr_write_b32 a7, v119
v_mfma_f32_32x32x16_bf16 v[64:79], v[36:39], a[24:27], v[48:63]
v_cvt_pk_bf16_f32 v112, v80, v81
v_cvt_pk_bf16_f32 v113, v82, v83
v_cvt_pk_bf16_f32 v114, v84, v85
v_cvt_pk_bf16_f32 v115, v86, v87
v_cvt_pk_bf16_f32 v116, v88, v89
v_cvt_pk_bf16_f32 v117, v90, v91
v_cvt_pk_bf16_f32 v118, v92, v93
v_cvt_pk_bf16_f32 v119, v94, v95
v_mfma_f32_32x32x16_bf16 v[64:79], v[40:43], a[28:31], v[64:79]
v_accvgpr_write_b32 a8, v112
v_accvgpr_write_b32 a9, v113
v_accvgpr_write_b32 a10, v114
v_accvgpr_write_b32 a11, v115
v_accvgpr_write_b32 a12, v116
v_accvgpr_write_b32 a13, v117
v_accvgpr_write_b32 a14, v118
v_accvgpr_write_b32 a15, v119
s_add_u32 s77, s79, s8
s_add_u32 m0, s74, 0x2000
s_nop 0
buffer_load_dwordx4 v20, s[32:35], s77 offen lds
v_mfma_f32_32x32x16_bf16 v[80:95], v[36:39], a[32:35], v[48:63]
v_cvt_pk_bf16_f32 v112, v96, v97
v_cvt_pk_bf16_f32 v113, v98, v99
v_cvt_pk_bf16_f32 v114, v100, v101
v_cvt_pk_bf16_f32 v115, v102, v103
v_cvt_pk_bf16_f32 v116, v104, v105
v_cvt_pk_bf16_f32 v117, v106, v107
v_cvt_pk_bf16_f32 v118, v108, v109
v_cvt_pk_bf16_f32 v119, v110, v111
v_mfma_f32_32x32x16_bf16 v[80:95], v[40:43], a[36:39], v[80:95]
v_accvgpr_write_b32 a16, v112
v_accvgpr_write_b32 a17, v113
v_accvgpr_write_b32 a18, v114
v_accvgpr_write_b32 a19, v115
v_accvgpr_write_b32 a20, v116
v_accvgpr_write_b32 a21, v117
v_accvgpr_write_b32 a22, v118
v_accvgpr_write_b32 a23, v119
v_mfma_f32_32x32x16_bf16 v[96:111], v[36:39], a[40:43], v[48:63]
v_cvt_pk_bf16_f32 v112, v64, v65
v_cvt_pk_bf16_f32 v113, v66, v67
v_cvt_pk_bf16_f32 v114, v68, v69
v_cvt_pk_bf16_f32 v115, v70, v71
v_cvt_pk_bf16_f32 v116, v72, v73
v_cvt_pk_bf16_f32 v117, v74, v75
v_cvt_pk_bf16_f32 v118, v76, v77
v_cvt_pk_bf16_f32 v119, v78, v79
v_mfma_f32_32x32x16_bf16 v[96:111], v[40:43], a[44:47], v[96:111]
v_accvgpr_write_b32 a24, v112
v_accvgpr_write_b32 a25, v113
v_accvgpr_write_b32 a26, v114
v_accvgpr_write_b32 a27, v115
v_accvgpr_write_b32 a28, v116
v_accvgpr_write_b32 a29, v117
v_accvgpr_write_b32 a30, v118
v_accvgpr_write_b32 a31, v119
s_add_u32 m0, s74, 0x3000
s_nop 0
buffer_load_dwordx4 v21, s[32:35], s77 offen lds
v_mfma_f32_32x32x16_bf16 v[64:79], v[36:39], a[48:51], v[48:63]
v_cvt_pk_bf16_f32 v112, v80, v81
v_cvt_pk_bf16_f32 v113, v82, v83
v_cvt_pk_bf16_f32 v114, v84, v85
v_cvt_pk_bf16_f32 v115, v86, v87
v_cvt_pk_bf16_f32 v116, v88, v89
v_cvt_pk_bf16_f32 v117, v90, v91
v_cvt_pk_bf16_f32 v118, v92, v93
v_cvt_pk_bf16_f32 v119, v94, v95
v_mfma_f32_32x32x16_bf16 v[64:79], v[40:43], a[52:55], v[64:79]
v_accvgpr_write_b32 a32, v112
v_accvgpr_write_b32 a33, v113
v_accvgpr_write_b32 a34, v114
v_accvgpr_write_b32 a35, v115
v_accvgpr_write_b32 a36, v116
v_accvgpr_write_b32 a37, v117
v_accvgpr_write_b32 a38, v118
v_accvgpr_write_b32 a39, v119
v_mfma_f32_32x32x16_bf16 v[80:95], v[36:39], a[56:59], v[48:63]
v_cvt_pk_bf16_f32 v112, v96, v97
v_cvt_pk_bf16_f32 v113, v98, v99
v_cvt_pk_bf16_f32 v114, v100, v101
v_cvt_pk_bf16_f32 v115, v102, v103
v_cvt_pk_bf16_f32 v116, v104, v105
v_cvt_pk_bf16_f32 v117, v106, v107
v_cvt_pk_bf16_f32 v118, v108, v109
v_cvt_pk_bf16_f32 v119, v110, v111
v_mfma_f32_32x32x16_bf16 v[80:95], v[40:43], a[60:63], v[80:95]
v_accvgpr_write_b32 a40, v112
v_accvgpr_write_b32 a41, v113
v_accvgpr_write_b32 a42, v114
v_accvgpr_write_b32 a43, v115
v_accvgpr_write_b32 a44, v116
v_accvgpr_write_b32 a45, v117
v_accvgpr_write_b32 a46, v118
v_accvgpr_write_b32 a47, v119
s_add_u32 s77, s79, s9
s_add_u32 m0, s74, 0x4000
s_nop 0
buffer_load_dwordx4 v20, s[32:35], s77 offen lds
v_mfma_f32_32x32x16_bf16 v[96:111], v[36:39], a[64:67], v[48:63]
v_cvt_pk_bf16_f32 v112, v64, v65
v_cvt_pk_bf16_f32 v113, v66, v67
v_cvt_pk_bf16_f32 v114, v68, v69
v_cvt_pk_bf16_f32 v115, v70, v71
v_cvt_pk_bf16_f32 v116, v72, v73
v_cvt_pk_bf16_f32 v117, v74, v75
v_cvt_pk_bf16_f32 v118, v76, v77
v_cvt_pk_bf16_f32 v119, v78, v79
v_mfma_f32_32x32x16_bf16 v[96:111], v[40:43], a[68:71], v[96:111]
v_accvgpr_write_b32 a48, v112
v_accvgpr_write_b32 a49, v113
v_accvgpr_write_b32 a50, v114
v_accvgpr_write_b32 a51, v115
v_accvgpr_write_b32 a52, v116
v_accvgpr_write_b32 a53, v117
v_accvgpr_write_b32 a54, v118
v_accvgpr_write_b32 a55, v119
v_mfma_f32_32x32x16_bf16 v[64:79], v[36:39], a[72:75], v[48:63]
v_cvt_pk_bf16_f32 v112, v80, v81
v_cvt_pk_bf16_f32 v113, v82, v83
v_cvt_pk_bf16_f32 v114, v84, v85
v_cvt_pk_bf16_f32 v115, v86, v87
v_cvt_pk_bf16_f32 v116, v88, v89
v_cvt_pk_bf16_f32 v117, v90, v91
v_cvt_pk_bf16_f32 v118, v92, v93
v_cvt_pk_bf16_f32 v119, v94, v95
v_mfma_f32_32x32x16_bf16 v[64:79], v[40:43], a[76:79], v[64:79]
v_accvgpr_write_b32 a56, v112
v_accvgpr_write_b32 a57, v113
v_accvgpr_write_b32 a58, v114
v_accvgpr_write_b32 a59, v115
v_accvgpr_write_b32 a60, v116
v_accvgpr_write_b32 a61, v117
v_accvgpr_write_b32 a62, v118
v_accvgpr_write_b32 a63, v119
s_add_u32 m0, s74, 0x5000
s_nop 0
buffer_load_dwordx4 v21, s[32:35], s77 offen lds
v_mfma_f32_32x32x16_bf16 v[80:95], v[36:39], a[80:83], v[48:63]
v_cvt_pk_bf16_f32 v112, v96, v97
v_cvt_pk_bf16_f32 v113, v98, v99
v_cvt_pk_bf16_f32 v114, v100, v101
v_cvt_pk_bf16_f32 v115, v102, v103
v_cvt_pk_bf16_f32 v116, v104, v105
v_cvt_pk_bf16_f32 v117, v106, v107
v_cvt_pk_bf16_f32 v118, v108, v109
v_cvt_pk_bf16_f32 v119, v110, v111
v_mfma_f32_32x32x16_bf16 v[80:95], v[40:43], a[84:87], v[80:95]
v_accvgpr_write_b32 a64, v112
v_accvgpr_write_b32 a65, v113
v_accvgpr_write_b32 a66, v114
v_accvgpr_write_b32 a67, v115
v_accvgpr_write_b32 a68, v116
v_accvgpr_write_b32 a69, v117
v_accvgpr_write_b32 a70, v118
v_accvgpr_write_b32 a71, v119
v_mfma_f32_32x32x16_bf16 v[96:111], v[36:39], a[88:91], v[48:63]
v_cvt_pk_bf16_f32 v112, v64, v65
v_cvt_pk_bf16_f32 v113, v66, v67
v_cvt_pk_bf16_f32 v114, v68, v69
v_cvt_pk_bf16_f32 v115, v70, v71
v_cvt_pk_bf16_f32 v116, v72, v73
v_cvt_pk_bf16_f32 v117, v74, v75
v_cvt_pk_bf16_f32 v118, v76, v77
v_cvt_pk_bf16_f32 v119, v78, v79
v_mfma_f32_32x32x16_bf16 v[96:111], v[40:43], a[92:95], v[96:111]
v_accvgpr_write_b32 a72, v112
v_accvgpr_write_b32 a73, v113
v_accvgpr_write_b32 a74, v114
v_accvgpr_write_b32 a75, v115
v_accvgpr_write_b32 a76, v116
v_accvgpr_write_b32 a77, v117
v_accvgpr_write_b32 a78, v118
v_accvgpr_write_b32 a79, v119
s_add_u32 s77, s79, s10
s_add_u32 m0, s74, 0x6000
s_nop 0
buffer_load_dwordx4 v20, s[32:35], s77 offen lds
v_mfma_f32_32x32x16_bf16 v[64:79], v[36:39], a[96:99], v[48:63]
v_cvt_pk_bf16_f32 v112, v80, v81
v_cvt_pk_bf16_f32 v113, v82, v83
v_cvt_pk_bf16_f32 v114, v84, v85
v_cvt_pk_bf16_f32 v115, v86, v87
v_cvt_pk_bf16_f32 v116, v88, v89
v_cvt_pk_bf16_f32 v117, v90, v91
v_cvt_pk_bf16_f32 v118, v92, v93
v_cvt_pk_bf16_f32 v119, v94, v95
v_mfma_f32_32x32x16_bf16 v[64:79], v[40:43], a[100:103], v[64:79]
v_accvgpr_write_b32 a80, v112
v_accvgpr_write_b32 a81, v113
v_accvgpr_write_b32 a82, v114
v_accvgpr_write_b32 a83, v115
v_accvgpr_write_b32 a84, v116
v_accvgpr_write_b32 a85, v117
v_accvgpr_write_b32 a86, v118
v_accvgpr_write_b32 a87, v119
v_mfma_f32_32x32x16_bf16 v[80:95], v[36:39], a[104:107], v[48:63]
v_cvt_pk_bf16_f32 v112, v96, v97
v_cvt_pk_bf16_f32 v113, v98, v99
v_cvt_pk_bf16_f32 v114, v100, v101
v_cvt_pk_bf16_f32 v115, v102, v103
v_cvt_pk_bf16_f32 v116, v104, v105
v_cvt_pk_bf16_f32 v117, v106, v107
v_cvt_pk_bf16_f32 v118, v108, v109
v_cvt_pk_bf16_f32 v119, v110, v111
v_mfma_f32_32x32x16_bf16 v[80:95], v[40:43], a[108:111], v[80:95]
v_accvgpr_write_b32 a88, v112
v_accvgpr_write_b32 a89, v113
v_accvgpr_write_b32 a90, v114
v_accvgpr_write_b32 a91, v115
v_accvgpr_write_b32 a92, v116
v_accvgpr_write_b32 a93, v117
v_accvgpr_write_b32 a94, v118
v_accvgpr_write_b32 a95, v119
s_add_u32 m0, s74, 0x7000
s_nop 0
buffer_load_dwordx4 v21, s[32:35], s77 offen lds
v_mfma_f32_32x32x16_bf16 v[96:111], v[36:39], a[112:115], v[48:63]
v_cvt_pk_bf16_f32 v112, v64, v65
v_cvt_pk_bf16_f32 v113, v66, v67
v_cvt_pk_bf16_f32 v114, v68, v69
v_cvt_pk_bf16_f32 v115, v70, v71
v_cvt_pk_bf16_f32 v116, v72, v73
v_cvt_pk_bf16_f32 v117, v74, v75
v_cvt_pk_bf16_f32 v118, v76, v77
v_cvt_pk_bf16_f32 v119, v78, v79
v_mfma_f32_32x32x16_bf16 v[96:111], v[40:43], a[116:119], v[96:111]
v_accvgpr_write_b32 a96, v112
v_accvgpr_write_b32 a97, v113
v_accvgpr_write_b32 a98, v114
v_accvgpr_write_b32 a99, v115
v_accvgpr_write_b32 a100, v116
v_accvgpr_write_b32 a101, v117
v_accvgpr_write_b32 a102, v118
v_accvgpr_write_b32 a103, v119
v_mfma_f32_32x32x16_bf16 v[64:79], v[36:39], a[120:123], v[48:63]
v_cvt_pk_bf16_f32 v112, v80, v81
v_cvt_pk_bf16_f32 v113, v82, v83
v_cvt_pk_bf16_f32 v114, v84, v85
v_cvt_pk_bf16_f32 v115, v86, v87
v_cvt_pk_bf16_f32 v116, v88, v89
v_cvt_pk_bf16_f32 v117, v90, v91
v_cvt_pk_bf16_f32 v118, v92, v93
v_cvt_pk_bf16_f32 v119, v94, v95
v_mfma_f32_32x32x16_bf16 v[64:79], v[40:43], a[124:127], v[64:79]
v_accvgpr_write_b32 a104, v112
v_accvgpr_write_b32 a105, v113
v_accvgpr_write_b32 a106, v114
v_accvgpr_write_b32 a107, v115
v_accvgpr_write_b32 a108, v116
v_accvgpr_write_b32 a109, v117
v_accvgpr_write_b32 a110, v118
v_accvgpr_write_b32 a111, v119
s_add_u32 s77, s80, s12
s_add_u32 m0, s74, 0x8000
s_nop 0
buffer_load_dwordx4 v225, s[44:47], s77 offen lds
v_cvt_pk_bf16_f32 v112, v96, v97
v_cvt_pk_bf16_f32 v113, v98, v99
v_cvt_pk_bf16_f32 v114, v100, v101
v_cvt_pk_bf16_f32 v115, v102, v103
v_cvt_pk_bf16_f32 v116, v104, v105
v_cvt_pk_bf16_f32 v117, v106, v107
v_cvt_pk_bf16_f32 v118, v108, v109
v_cvt_pk_bf16_f32 v119, v110, v111
v_accvgpr_write_b32 a112, v112
v_accvgpr_write_b32 a113, v113
v_accvgpr_write_b32 a114, v114
v_accvgpr_write_b32 a115, v115
v_accvgpr_write_b32 a116, v116
v_accvgpr_write_b32 a117, v117
v_accvgpr_write_b32 a118, v118
v_accvgpr_write_b32 a119, v119
v_cvt_pk_bf16_f32 v112, v64, v65
v_cvt_pk_bf16_f32 v113, v66, v67
v_cvt_pk_bf16_f32 v114, v68, v69
v_cvt_pk_bf16_f32 v115, v70, v71
v_cvt_pk_bf16_f32 v116, v72, v73
v_cvt_pk_bf16_f32 v117, v74, v75
v_cvt_pk_bf16_f32 v118, v76, v77
v_cvt_pk_bf16_f32 v119, v78, v79
s_add_u32 m0, s74, 0xc000
s_nop 0
buffer_load_dwordx4 v229, s[48:51], s77 offen lds
v_accvgpr_write_b32 a120, v112
v_accvgpr_write_b32 a121, v113
v_accvgpr_write_b32 a122, v114
v_accvgpr_write_b32 a123, v115
v_accvgpr_write_b32 a124, v116
v_accvgpr_write_b32 a125, v117
v_accvgpr_write_b32 a126, v118
v_accvgpr_write_b32 a127, v119
s_waitcnt lgkmcnt(0)
s_add_u32 m0, s74, 0x9000
ds_read_b64_tr_b16 a[128:129], v201 offset:0
ds_read_b64_tr_b16 a[130:131], v201 offset:512
ds_read_b64_tr_b16 a[132:133], v203 offset:0
ds_read_b64_tr_b16 a[134:135], v203 offset:512
ds_read_b64_tr_b16 a[136:137], v201 offset:2048
ds_read_b64_tr_b16 a[138:139], v201 offset:2560
ds_read_b64_tr_b16 a[140:141], v203 offset:2048
ds_read_b64_tr_b16 a[142:143], v203 offset:2560
ds_read_b64_tr_b16 a[144:145], v201 offset:4096
ds_read_b64_tr_b16 a[146:147], v201 offset:4608
buffer_load_dwordx4 v226, s[44:47], s77 offen lds
s_waitcnt lgkmcnt(6)
v_mfma_f32_32x32x16_bf16 v[32:47], a[128:131], a[0:3], 0
ds_read_b64_tr_b16 a[148:149], v203 offset:4096
ds_read_b64_tr_b16 a[150:151], v203 offset:4608
v_and_b32 v12, 15, v1
v_lshrrev_b32 v8, 2, v12
v_and_b32 v9, 3, v12
v_mfma_f32_32x32x16_bf16 v[48:63], a[132:135], a[0:3], 0
ds_read_b64_tr_b16 a[152:153], v201 offset:6144
ds_read_b64_tr_b16 a[154:155], v201 offset:6656
v_bfe_u32 v10, v1, 4, 1
v_lshrrev_b32 v11, 5, v1
v_lshrrev_b32 v12, 1, v9
s_waitcnt lgkmcnt(6)
v_mfma_f32_32x32x16_bf16 v[32:47], a[136:139], a[4:7], v[32:47]
s_add_u32 m0, s74, 0xd000
ds_read_b64_tr_b16 a[156:157], v203 offset:6144
ds_read_b64_tr_b16 a[158:159], v203 offset:6656
buffer_load_dwordx4 v230, s[48:51], s77 offen lds
v_mfma_f32_32x32x16_bf16 v[48:63], a[140:143], a[4:7], v[48:63]
ds_read_b64_tr_b16 a[128:129], v201 offset:8192
ds_read_b64_tr_b16 a[130:131], v201 offset:8704
v_lshlrev_b32 v12, 4, v12
v_and_b32 v13, 1, v9
v_lshlrev_b32 v13, 3, v13
s_waitcnt lgkmcnt(6)
v_mfma_f32_32x32x16_bf16 v[32:47], a[144:147], a[8:11], v[32:47]
ds_read_b64_tr_b16 a[132:133], v203 offset:8192
ds_read_b64_tr_b16 a[134:135], v203 offset:8704
v_add_u32 v12, v12, v13
v_lshlrev_b32 v13, 3, v11
v_add_u32 v13, v13, v8
v_mfma_f32_32x32x16_bf16 v[48:63], a[148:151], a[8:11], v[48:63]
s_add_u32 m0, s74, 0xa000
ds_read_b64_tr_b16 a[136:137], v201 offset:10240
ds_read_b64_tr_b16 a[138:139], v201 offset:10752
buffer_load_dwordx4 v227, s[44:47], s77 offen lds
s_waitcnt lgkmcnt(6)
v_mfma_f32_32x32x16_bf16 v[32:47], a[152:155], a[12:15], v[32:47]
ds_read_b64_tr_b16 a[140:141], v203 offset:10240
ds_read_b64_tr_b16 a[142:143], v203 offset:10752
v_lshlrev_b32 v13, 8, v13
v_add_u32 v12, v12, v13
v_lshlrev_b32 v13, 14, v10
v_mfma_f32_32x32x16_bf16 v[48:63], a[156:159], a[12:15], v[48:63]
ds_read_b64_tr_b16 a[144:145], v201 offset:12288
ds_read_b64_tr_b16 a[146:147], v201 offset:12800
v_add_u32 v12, v12, v13
v_lshlrev_b32 v14, 2, v10
v_xor_b32 v13, 0, v8
s_waitcnt lgkmcnt(6)
v_mfma_f32_32x32x16_bf16 v[32:47], a[128:131], a[16:19], v[32:47]
s_add_u32 m0, s74, 0xe000
ds_read_b64_tr_b16 a[148:149], v203 offset:12288
ds_read_b64_tr_b16 a[150:151], v203 offset:12800
buffer_load_dwordx4 v231, s[48:51], s77 offen lds
v_mfma_f32_32x32x16_bf16 v[48:63], a[132:135], a[16:19], v[48:63]
ds_read_b64_tr_b16 a[152:153], v201 offset:14336
ds_read_b64_tr_b16 a[154:155], v201 offset:14848
v_xor_b32 v13, v13, v14
v_lshlrev_b32 v13, 5, v13
v_add_u32 v204, v12, v13
s_waitcnt lgkmcnt(6)
v_mfma_f32_32x32x16_bf16 v[32:47], a[136:139], a[20:23], v[32:47]
ds_read_b64_tr_b16 a[156:157], v203 offset:14336
ds_read_b64_tr_b16 a[158:159], v203 offset:14848
v_add_u32 v205, 0x10000, v204
v_add_u32 v206, 0x20000, v204
v_xor_b32 v13, 1, v8
v_mfma_f32_32x32x16_bf16 v[48:63], a[140:143], a[20:23], v[48:63]
s_add_u32 m0, s74, 0xb000
ds_read_b64_tr_b16 a[128:129], v201 offset:16384
ds_read_b64_tr_b16 a[130:131], v201 offset:16896
buffer_load_dwordx4 v228, s[44:47], s77 offen lds
s_waitcnt lgkmcnt(6)
v_mfma_f32_32x32x16_bf16 v[32:47], a[144:147], a[24:27], v[32:47]
ds_read_b64_tr_b16 a[132:133], v203 offset:16384
ds_read_b64_tr_b16 a[134:135], v203 offset:16896
v_xor_b32 v13, v13, v14
v_lshlrev_b32 v13, 5, v13
v_add_u32 v207, v12, v13
v_mfma_f32_32x32x16_bf16 v[48:63], a[148:151], a[24:27], v[48:63]
ds_read_b64_tr_b16 a[136:137], v201 offset:18432
ds_read_b64_tr_b16 a[138:139], v201 offset:18944
v_add_u32 v208, 0x10000, v207
v_add_u32 v209, 0x20000, v207
v_xor_b32 v13, 2, v8
s_waitcnt lgkmcnt(6)
v_mfma_f32_32x32x16_bf16 v[32:47], a[152:155], a[28:31], v[32:47]
s_add_u32 m0, s74, 0xf000
ds_read_b64_tr_b16 a[140:141], v203 offset:18432
ds_read_b64_tr_b16 a[142:143], v203 offset:18944
buffer_load_dwordx4 v232, s[48:51], s77 offen lds
v_mfma_f32_32x32x16_bf16 v[48:63], a[156:159], a[28:31], v[48:63]
ds_read_b64_tr_b16 a[144:145], v201 offset:20480
ds_read_b64_tr_b16 a[146:147], v201 offset:20992
v_xor_b32 v13, v13, v14
v_lshlrev_b32 v13, 5, v13
v_add_u32 v210, v12, v13
s_waitcnt lgkmcnt(6)
v_mfma_f32_32x32x16_bf16 v[32:47], a[128:131], a[32:35], v[32:47]
ds_read_b64_tr_b16 a[148:149], v203 offset:20480
ds_read_b64_tr_b16 a[150:151], v203 offset:20992
v_add_u32 v211, 0x10000, v210
v_add_u32 v212, 0x20000, v210
v_xor_b32 v13, 3, v8
v_mfma_f32_32x32x16_bf16 v[48:63], a[132:135], a[32:35], v[48:63]
ds_read_b64_tr_b16 a[152:153], v201 offset:22528
ds_read_b64_tr_b16 a[154:155], v201 offset:23040
v_xor_b32 v13, v13, v14
v_lshlrev_b32 v13, 5, v13
v_add_u32 v213, v12, v13
s_waitcnt lgkmcnt(6)
v_mfma_f32_32x32x16_bf16 v[32:47], a[136:139], a[36:39], v[32:47]
ds_read_b64_tr_b16 a[156:157], v203 offset:22528
ds_read_b64_tr_b16 a[158:159], v203 offset:23040
v_add_u32 v214, 0x10000, v213
v_add_u32 v215, 0x20000, v213
v_xor_b32 v13, 4, v8
v_mfma_f32_32x32x16_bf16 v[48:63], a[140:143], a[36:39], v[48:63]
s_waitcnt vmcnt(8)
s_barrier
s_add_u32 s77, s79, s11
s_add_u32 m0, s74, 0x20000
ds_read_b64_tr_b16 a[128:129], v200 offset:0
ds_read_b64_tr_b16 a[130:131], v200 offset:512
buffer_load_dwordx4 v20, s[32:35], s77 offen lds
s_waitcnt lgkmcnt(6)
v_mfma_f32_32x32x16_bf16 v[32:47], a[144:147], a[40:43], v[32:47]
ds_read_b64_tr_b16 a[132:133], v202 offset:0
ds_read_b64_tr_b16 a[134:135], v202 offset:512
v_xor_b32 v13, v13, v14
v_lshlrev_b32 v13, 5, v13
v_add_u32 v216, v12, v13
v_mfma_f32_32x32x16_bf16 v[48:63], a[148:151], a[40:43], v[48:63]
ds_read_b64_tr_b16 a[136:137], v200 offset:2048
ds_read_b64_tr_b16 a[138:139], v200 offset:2560
v_add_u32 v217, 0x10000, v216
v_add_u32 v218, 0x20000, v216
v_xor_b32 v13, 5, v8
s_waitcnt lgkmcnt(6)
v_mfma_f32_32x32x16_bf16 v[32:47], a[152:155], a[44:47], v[32:47]
s_add_u32 m0, s74, 0x21000
ds_read_b64_tr_b16 a[140:141], v202 offset:2048
ds_read_b64_tr_b16 a[142:143], v202 offset:2560
buffer_load_dwordx4 v21, s[32:35], s77 offen lds
v_mfma_f32_32x32x16_bf16 v[48:63], a[156:159], a[44:47], v[48:63]
ds_read_b64_tr_b16 a[144:145], v200 offset:4096
ds_read_b64_tr_b16 a[146:147], v200 offset:4608
v_xor_b32 v13, v13, v14
v_lshlrev_b32 v13, 5, v13
v_add_u32 v219, v12, v13
s_waitcnt lgkmcnt(6)
v_mfma_f32_32x32x16_bf16 v[32:47], a[128:131], a[48:51], v[32:47]
ds_read_b64_tr_b16 a[148:149], v202 offset:4096
ds_read_b64_tr_b16 a[150:151], v202 offset:4608
v_add_u32 v220, 0x10000, v219
v_add_u32 v221, 0x20000, v219
v_xor_b32 v13, 6, v8
v_mfma_f32_32x32x16_bf16 v[48:63], a[132:135], a[48:51], v[48:63]
s_add_u32 s77, s80, s13
s_add_u32 m0, s74, 0x10000
ds_read_b64_tr_b16 a[152:153], v200 offset:6144
ds_read_b64_tr_b16 a[154:155], v200 offset:6656
buffer_load_dwordx4 v225, s[44:47], s77 offen lds
s_waitcnt lgkmcnt(6)
v_mfma_f32_32x32x16_bf16 v[32:47], a[136:139], a[52:55], v[32:47]
ds_read_b64_tr_b16 a[156:157], v202 offset:6144
ds_read_b64_tr_b16 a[158:159], v202 offset:6656
v_xor_b32 v13, v13, v14
v_lshlrev_b32 v13, 5, v13
v_add_u32 v222, v12, v13
v_mfma_f32_32x32x16_bf16 v[48:63], a[140:143], a[52:55], v[48:63]
ds_read_b64_tr_b16 a[128:129], v200 offset:8192
ds_read_b64_tr_b16 a[130:131], v200 offset:8704
v_add_u32 v223, 0x10000, v222
v_add_u32 v224, 0x20000, v222
s_lshr_b32 s95, s68, 1
s_waitcnt lgkmcnt(6)
v_mfma_f32_32x32x16_bf16 v[32:47], a[144:147], a[56:59], v[32:47]
s_add_u32 m0, s74, 0x14000
ds_read_b64_tr_b16 a[132:133], v202 offset:8192
ds_read_b64_tr_b16 a[134:135], v202 offset:8704
buffer_load_dwordx4 v229, s[48:51], s77 offen lds
v_mfma_f32_32x32x16_bf16 v[48:63], a[148:151], a[56:59], v[48:63]
ds_read_b64_tr_b16 a[136:137], v200 offset:10240
ds_read_b64_tr_b16 a[138:139], v200 offset:10752
s_and_b32 s96, s68, 1
s_lshl_b32 s94, s68, 11
v_mov_b32 v15, s95
s_waitcnt lgkmcnt(6)
v_mfma_f32_32x32x16_bf16 v[32:47], a[152:155], a[60:63], v[32:47]
ds_read_b64_tr_b16 a[140:141], v202 offset:10240
ds_read_b64_tr_b16 a[142:143], v202 offset:10752
v_lshrrev_b32 v12, 1, v9
v_lshlrev_b32 v12, 4, v12
v_and_b32 v14, 1, v9
v_mfma_f32_32x32x16_bf16 v[48:63], a[156:159], a[60:63], v[48:63]
s_add_u32 m0, s74, 0x11000
ds_read_b64_tr_b16 a[144:145], v200 offset:12288
ds_read_b64_tr_b16 a[146:147], v200 offset:12800
buffer_load_dwordx4 v226, s[44:47], s77 offen lds
s_waitcnt lgkmcnt(6)
v_mfma_f32_32x32x16_bf16 v[32:47], a[128:131], a[64:67], v[32:47]
ds_read_b64_tr_b16 a[148:149], v202 offset:12288
ds_read_b64_tr_b16 a[150:151], v202 offset:12800
v_lshlrev_b32 v14, 3, v14
v_add_u32 v12, v12, v14
v_lshlrev_b32 v14, 5, v10
v_mfma_f32_32x32x16_bf16 v[48:63], a[132:135], a[64:67], v[48:63]
ds_read_b64_tr_b16 a[152:153], v200 offset:14336
ds_read_b64_tr_b16 a[154:155], v200 offset:14848
v_add_u32 v12, v12, v14
v_mul_u32_u24 v14, 4, v11
v_add_u32 v14, v14, v8
s_waitcnt lgkmcnt(6)
v_mfma_f32_32x32x16_bf16 v[32:47], a[136:139], a[68:71], v[32:47]
s_add_u32 m0, s74, 0x15000
ds_read_b64_tr_b16 a[156:157], v202 offset:14336
ds_read_b64_tr_b16 a[158:159], v202 offset:14848
buffer_load_dwordx4 v230, s[48:51], s77 offen lds
v_mfma_f32_32x32x16_bf16 v[48:63], a[140:143], a[68:71], v[48:63]
ds_read_b64_tr_b16 a[128:129], v200 offset:16384
ds_read_b64_tr_b16 a[130:131], v200 offset:16896
v_lshlrev_b32 v14, 7, v14
v_add_u32 v12, v12, v14
v_bfe_u32 v13, v8, 1, 1
s_waitcnt lgkmcnt(6)
v_mfma_f32_32x32x16_bf16 v[32:47], a[144:147], a[72:75], v[32:47]
ds_read_b64_tr_b16 a[132:133], v202 offset:16384
ds_read_b64_tr_b16 a[134:135], v202 offset:16896
v_xor_b32 v13, v15, v13
v_xor_b32 v14, 0, v13
v_lshlrev_b32 v14, 6, v14
v_mfma_f32_32x32x16_bf16 v[48:63], a[148:151], a[72:75], v[48:63]
s_add_u32 m0, s74, 0x12000
ds_read_b64_tr_b16 a[136:137], v200 offset:18432
ds_read_b64_tr_b16 a[138:139], v200 offset:18944
buffer_load_dwordx4 v227, s[44:47], s77 offen lds
s_waitcnt lgkmcnt(6)
v_mfma_f32_32x32x16_bf16 v[32:47], a[152:155], a[76:79], v[32:47]
ds_read_b64_tr_b16 a[140:141], v202 offset:18432
ds_read_b64_tr_b16 a[142:143], v202 offset:18944
v_add_u32 v235, v12, v14
v_add_u32 v236, 0x10000, v235
v_add_u32 v237, 0x20000, v235
v_mfma_f32_32x32x16_bf16 v[48:63], a[156:159], a[76:79], v[48:63]
ds_read_b64_tr_b16 a[144:145], v200 offset:20480
ds_read_b64_tr_b16 a[146:147], v200 offset:20992
v_xor_b32 v14, 1, v13
v_lshlrev_b32 v14, 6, v14
v_add_u32 v238, v12, v14
s_waitcnt lgkmcnt(6)
v_mfma_f32_32x32x16_bf16 v[32:47], a[128:131], a[80:83], v[32:47]
s_add_u32 m0, s74, 0x16000
ds_read_b64_tr_b16 a[148:149], v202 offset:20480
ds_read_b64_tr_b16 a[150:151], v202 offset:20992
buffer_load_dwordx4 v231, s[48:51], s77 offen lds
v_mfma_f32_32x32x16_bf16 v[48:63], a[132:135], a[80:83], v[48:63]
ds_read_b64_tr_b16 a[152:153], v200 offset:22528
ds_read_b64_tr_b16 a[154:155], v200 offset:23040
v_add_u32 v239, 0x10000, v238
v_add_u32 v240, 0x20000, v238
s_lshl_b32 s81, s95, 13
s_waitcnt lgkmcnt(6)
v_mfma_f32_32x32x16_bf16 v[32:47], a[136:139], a[84:87], v[32:47]
ds_read_b64_tr_b16 a[156:157], v202 offset:22528
ds_read_b64_tr_b16 a[158:159], v202 offset:23040
v_add_u32 v235, s81, v235
v_add_u32 v236, s81, v236
v_add_u32 v237, s81, v237
v_mfma_f32_32x32x16_bf16 v[48:63], a[140:143], a[84:87], v[48:63]
s_add_u32 m0, s74, 0x13000
ds_read_b64_tr_b16 a[128:129], v200 offset:24576
ds_read_b64_tr_b16 a[130:131], v200 offset:25088
buffer_load_dwordx4 v228, s[44:47], s77 offen lds
s_waitcnt lgkmcnt(6)
v_mfma_f32_32x32x16_bf16 v[32:47], a[144:147], a[88:91], v[32:47]
ds_read_b64_tr_b16 a[132:133], v202 offset:24576
ds_read_b64_tr_b16 a[134:135], v202 offset:25088
v_add_u32 v238, s81, v238
v_add_u32 v239, s81, v239
v_add_u32 v240, s81, v240
v_mfma_f32_32x32x16_bf16 v[48:63], a[148:151], a[88:91], v[48:63]
ds_read_b64_tr_b16 a[136:137], v200 offset:26624
ds_read_b64_tr_b16 a[138:139], v200 offset:27136
v_lshrrev_b32 v12, 3, v1
v_and_b32 v13, 7, v1
v_bfe_u32 v14, v12, 1, 1
s_waitcnt lgkmcnt(6)
v_mfma_f32_32x32x16_bf16 v[32:47], a[152:155], a[92:95], v[32:47]
s_add_u32 m0, s74, 0x17000
ds_read_b64_tr_b16 a[140:141], v202 offset:26624
ds_read_b64_tr_b16 a[142:143], v202 offset:27136
buffer_load_dwordx4 v232, s[48:51], s77 offen lds
v_mfma_f32_32x32x16_bf16 v[48:63], a[156:159], a[92:95], v[48:63]
ds_read_b64_tr_b16 a[144:145], v200 offset:28672
ds_read_b64_tr_b16 a[146:147], v200 offset:29184
v_lshlrev_b32 v14, 2, v14
v_xor_b32 v14, v14, v13
v_lshlrev_b32 v14, 4, v14
s_waitcnt lgkmcnt(6)
v_mfma_f32_32x32x16_bf16 v[32:47], a[128:131], a[96:99], v[32:47]
ds_read_b64_tr_b16 a[148:149], v202 offset:28672
ds_read_b64_tr_b16 a[150:151], v202 offset:29184
s_lshl_b32 s81, s68, 4
v_add_u32 v15, s81, v12
v_lshlrev_b32 v15, 10, v15
v_mfma_f32_32x32x16_bf16 v[48:63], a[132:135], a[96:99], v[48:63]
s_add_u32 s77, s80, s14
s_add_u32 m0, s74, 0x18000
ds_read_b64_tr_b16 a[152:153], v200 offset:30720
ds_read_b64_tr_b16 a[154:155], v200 offset:31232
buffer_load_dwordx4 v225, s[44:47], s77 offen lds
s_waitcnt lgkmcnt(6)
v_mfma_f32_32x32x16_bf16 v[32:47], a[136:139], a[100:103], v[32:47]
ds_read_b64_tr_b16 a[156:157], v202 offset:30720
ds_read_b64_tr_b16 a[158:159], v202 offset:31232
v_add_u32 v233, v14, v15
v_add_u32 v234, 0x2000, v233
s_lshl_b32 s88, s73, 7
v_mfma_f32_32x32x16_bf16 v[48:63], a[140:143], a[100:103], v[48:63]
s_waitcnt vmcnt(9)
s_barrier
ds_read_b64_tr_b16 a[128:129], v201 offset:0
ds_read_b64_tr_b16 a[130:131], v201 offset:512
s_lshl_b32 s81, s69, 2
s_waitcnt lgkmcnt(6)
v_mfma_f32_32x32x16_bf16 v[32:47], a[144:147], a[104:107], v[32:47]
s_add_u32 m0, s74, 0x1c000
ds_read_b64_tr_b16 a[132:133], v203 offset:0
ds_read_b64_tr_b16 a[134:135], v203 offset:512
buffer_load_dwordx4 v229, s[48:51], s77 offen lds
v_mfma_f32_32x32x16_bf16 v[48:63], a[148:151], a[104:107], v[48:63]
ds_read_b64_tr_b16 a[136:137], v201 offset:2048
ds_read_b64_tr_b16 a[138:139], v201 offset:2560
s_lshl_b32 s82, s72, 1
s_add_u32 s81, s81, s82
s_add_u32 s81, s81, s96
s_waitcnt lgkmcnt(6)
v_mfma_f32_32x32x16_bf16 v[32:47], a[152:155], a[108:111], v[32:47]
ds_read_b64_tr_b16 a[140:141], v203 offset:2048
ds_read_b64_tr_b16 a[142:143], v203 offset:2560
s_mul_i32 s90, s81, 0x56
s_mul_i32 s82, s95, 43
s_add_u32 s90, s90, s82
v_mfma_f32_32x32x16_bf16 v[48:63], a[156:159], a[108:111], v[48:63]
s_add_u32 m0, s74, 0x19000
ds_read_b64_tr_b16 a[144:145], v201 offset:4096
ds_read_b64_tr_b16 a[146:147], v201 offset:4608
buffer_load_dwordx4 v226, s[44:47], s77 offen lds
s_waitcnt lgkmcnt(6)
v_mfma_f32_32x32x16_bf16 v[32:47], a[128:131], a[112:115], v[32:47]
ds_read_b64_tr_b16 a[148:149], v203 offset:4096
ds_read_b64_tr_b16 a[150:151], v203 offset:4608
s_lshl_b32 s90, s90, 10
s_lshl_b32 s91, s81, 5
s_lshl_b32 s82, s95, 4
v_mfma_f32_32x32x16_bf16 v[48:63], a[132:135], a[112:115], v[48:63]
ds_read_b64_tr_b16 a[152:153], v201 offset:6144
ds_read_b64_tr_b16 a[154:155], v201 offset:6656
s_add_u32 s91, s91, s82
s_lshl_b32 s91, s91, 10
s_add_u32 s91, s91, 0x560000
s_waitcnt lgkmcnt(6)
v_mfma_f32_32x32x16_bf16 v[32:47], a[136:139], a[116:119], v[32:47]
s_add_u32 m0, s74, 0x1d000
ds_read_b64_tr_b16 a[156:157], v203 offset:6144
ds_read_b64_tr_b16 a[158:159], v203 offset:6656
buffer_load_dwordx4 v230, s[48:51], s77 offen lds
v_mfma_f32_32x32x16_bf16 v[48:63], a[140:143], a[116:119], v[48:63]
s_barrier
ds_read_b64_tr_b16 a[128:129], v204 offset:32768
ds_read_b64_tr_b16 a[130:131], v204 offset:33792
s_waitcnt lgkmcnt(6)
v_mfma_f32_32x32x16_bf16 v[32:47], a[144:147], a[120:123], v[32:47]
ds_read_b64_tr_b16 a[132:133], v207 offset:32768
ds_read_b64_tr_b16 a[134:135], v207 offset:33792
v_mfma_f32_32x32x16_bf16 v[48:63], a[148:151], a[120:123], v[48:63]
s_add_u32 m0, s74, 0x1a000
ds_read_b64_tr_b16 a[136:137], v210 offset:32768
ds_read_b64_tr_b16 a[138:139], v210 offset:33792
buffer_load_dwordx4 v227, s[44:47], s77 offen lds
s_waitcnt lgkmcnt(6)
v_mfma_f32_32x32x16_bf16 v[32:47], a[152:155], a[124:127], v[32:47]
ds_read_b64_tr_b16 a[140:141], v213 offset:32768
ds_read_b64_tr_b16 a[142:143], v213 offset:33792
v_mfma_f32_32x32x16_bf16 v[48:63], a[156:159], a[124:127], v[48:63]
ds_read_b64_tr_b16 a[144:145], v216 offset:32768
ds_read_b64_tr_b16 a[146:147], v216 offset:33792
s_waitcnt lgkmcnt(6)
v_mfma_f32_32x32x16_bf16 v[64:79], a[128:131], a[0:3], 0
s_add_u32 m0, s74, 0x1e000
ds_read_b64_tr_b16 a[148:149], v219 offset:32768
ds_read_b64_tr_b16 a[150:151], v219 offset:33792
buffer_load_dwordx4 v231, s[48:51], s77 offen lds
v_mfma_f32_32x32x16_bf16 v[80:95], a[132:135], a[0:3], 0
ds_read_b64_tr_b16 a[152:153], v222 offset:32768
ds_read_b64_tr_b16 a[154:155], v222 offset:33792
v_cvt_pk_bf16_f32 v190, v32, v33
v_cvt_pk_bf16_f32 v191, v34, v35
v_cvt_pk_bf16_f32 v192, v36, v37
s_waitcnt lgkmcnt(6)
v_mfma_f32_32x32x16_bf16 v[96:111], a[136:139], a[0:3], 0
ds_read_b64_tr_b16 a[156:157], v204 offset:36864
ds_read_b64_tr_b16 a[158:159], v204 offset:37888
v_cvt_pk_bf16_f32 v193, v38, v39
v_cvt_pk_bf16_f32 v194, v40, v41
v_cvt_pk_bf16_f32 v195, v42, v43
v_mfma_f32_32x32x16_bf16 v[112:127], a[140:143], a[0:3], 0
s_add_u32 m0, s74, 0x1b000
ds_read_b64_tr_b16 a[128:129], v207 offset:36864
ds_read_b64_tr_b16 a[130:131], v207 offset:37888
buffer_load_dwordx4 v228, s[44:47], s77 offen lds
s_waitcnt lgkmcnt(6)
v_mfma_f32_32x32x16_bf16 v[128:143], a[144:147], a[0:3], 0
ds_read_b64_tr_b16 a[132:133], v210 offset:36864
ds_read_b64_tr_b16 a[134:135], v210 offset:37888
v_cvt_pk_bf16_f32 v196, v44, v45
v_cvt_pk_bf16_f32 v197, v46, v47
v_mfma_f32_32x32x16_bf16 v[32:47], a[160:163], v[190:193], 0
v_cvt_pk_bf16_f32 v190, v48, v49
v_mfma_f32_32x32x16_bf16 v[32:47], a[164:167], v[194:197], v[32:47]
v_cvt_pk_bf16_f32 v191, v50, v51
v_cvt_pk_bf16_f32 v192, v52, v53
v_cvt_pk_bf16_f32 v193, v54, v55
v_cvt_pk_bf16_f32 v194, v56, v57
v_cvt_pk_bf16_f32 v195, v58, v59
v_mfma_f32_32x32x16_bf16 v[144:159], a[148:151], a[0:3], 0
ds_read_b64_tr_b16 a[136:137], v213 offset:36864
ds_read_b64_tr_b16 a[138:139], v213 offset:37888
v_cvt_pk_bf16_f32 v196, v60, v61
v_cvt_pk_bf16_f32 v197, v62, v63
v_mfma_f32_32x32x16_bf16 v[48:63], a[168:171], v[190:193], 0
s_waitcnt lgkmcnt(6)
v_mfma_f32_32x32x16_bf16 v[160:175], a[152:155], a[0:3], 0
s_add_u32 m0, s74, 0x1f000
ds_read_b64_tr_b16 a[140:141], v216 offset:36864
ds_read_b64_tr_b16 a[142:143], v216 offset:37888
buffer_load_dwordx4 v232, s[48:51], s77 offen lds
v_mfma_f32_32x32x16_bf16 v[64:79], a[156:159], a[4:7], v[64:79]
ds_read_b64_tr_b16 a[144:145], v219 offset:36864
ds_read_b64_tr_b16 a[146:147], v219 offset:37888
v_mfma_f32_32x32x16_bf16 v[48:63], a[172:175], v[194:197], v[48:63]
v_max3_f32 v184, v32, v33, v34
v_max3_f32 v185, -v32, -v33, -v34
v_max3_f32 v184, v184, v35, v36
v_max3_f32 v185, v185, -v35, -v36
v_max3_f32 v184, v184, v37, v38
s_waitcnt lgkmcnt(6)
v_mfma_f32_32x32x16_bf16 v[80:95], a[128:131], a[4:7], v[80:95]
ds_read_b64_tr_b16 a[148:149], v222 offset:36864
ds_read_b64_tr_b16 a[150:151], v222 offset:37888
buffer_load_dword v198, v242, s[60:63], 0 offen sc1
v_mfma_f32_32x32x16_bf16 v[96:111], a[132:135], a[4:7], v[96:111]
s_add_u32 s77, s80, s15
s_add_u32 m0, s74, 0
ds_read_b64_tr_b16 a[152:153], v204 offset:40960
ds_read_b64_tr_b16 a[154:155], v204 offset:41984
buffer_load_dwordx4 v225, s[44:47], s77 offen lds
s_waitcnt lgkmcnt(6)
v_mfma_f32_32x32x16_bf16 v[112:127], a[136:139], a[4:7], v[112:127]
ds_read_b64_tr_b16 a[156:157], v207 offset:40960
ds_read_b64_tr_b16 a[158:159], v207 offset:41984
v_max3_f32 v185, v185, -v37, -v38
v_max_f32 v184, v184, v39
v_max_f32 v185, v185, -v39
v_mfma_f32_32x32x16_bf16 v[128:143], a[140:143], a[4:7], v[128:143]
ds_read_b64_tr_b16 a[128:129], v210 offset:40960
ds_read_b64_tr_b16 a[130:131], v210 offset:41984
v_permlane32_swap_b32 v184, v185
v_max_f32 v186, v184, v185
v_mov_b32 v187, v186
s_waitcnt lgkmcnt(6)
v_mfma_f32_32x32x16_bf16 v[144:159], a[144:147], a[4:7], v[144:159]
s_add_u32 m0, s74, 0x4000
ds_read_b64_tr_b16 a[132:133], v213 offset:40960
ds_read_b64_tr_b16 a[134:135], v213 offset:41984
buffer_load_dwordx4 v229, s[48:51], s77 offen lds
v_mfma_f32_32x32x16_bf16 v[160:175], a[148:151], a[4:7], v[160:175]
ds_read_b64_tr_b16 a[136:137], v216 offset:40960
ds_read_b64_tr_b16 a[138:139], v216 offset:41984
v_permlane32_swap_b32 v186, v187
v_mul_f32 v188, v186, v3
v_mul_f32 v189, v187, v3
s_waitcnt lgkmcnt(6)
v_mfma_f32_32x32x16_bf16 v[64:79], a[152:155], a[8:11], v[64:79]
ds_read_b64_tr_b16 a[140:141], v219 offset:40960
ds_read_b64_tr_b16 a[142:143], v219 offset:41984
v_fma_f32 v176, v32, v3, -v188
v_fma_f32 v32, -v32, v3, -v189
v_fma_f32 v177, v33, v3, -v188
v_mfma_f32_32x32x16_bf16 v[80:95], a[156:159], a[8:11], v[80:95]
s_add_u32 m0, s74, 0x1000
ds_read_b64_tr_b16 a[144:145], v222 offset:40960
ds_read_b64_tr_b16 a[146:147], v222 offset:41984
buffer_load_dwordx4 v226, s[44:47], s77 offen lds
s_waitcnt lgkmcnt(6)
v_mfma_f32_32x32x16_bf16 v[96:111], a[128:131], a[8:11], v[96:111]
ds_read_b64_tr_b16 a[148:149], v204 offset:45056
ds_read_b64_tr_b16 a[150:151], v204 offset:46080
v_fma_f32 v33, -v33, v3, -v189
v_fma_f32 v178, v34, v3, -v188
v_fma_f32 v34, -v34, v3, -v189
v_mfma_f32_32x32x16_bf16 v[112:127], a[132:135], a[8:11], v[112:127]
ds_read_b64_tr_b16 a[152:153], v207 offset:45056
ds_read_b64_tr_b16 a[154:155], v207 offset:46080
v_fma_f32 v179, v35, v3, -v188
v_fma_f32 v35, -v35, v3, -v189
v_fma_f32 v180, v36, v3, -v188
s_waitcnt lgkmcnt(6)
v_mfma_f32_32x32x16_bf16 v[128:143], a[136:139], a[8:11], v[128:143]
s_add_u32 m0, s74, 0x5000
ds_read_b64_tr_b16 a[156:157], v210 offset:45056
ds_read_b64_tr_b16 a[158:159], v210 offset:46080
buffer_load_dwordx4 v230, s[48:51], s77 offen lds
v_mfma_f32_32x32x16_bf16 v[144:159], a[140:143], a[8:11], v[144:159]
ds_read_b64_tr_b16 a[128:129], v213 offset:45056
ds_read_b64_tr_b16 a[130:131], v213 offset:46080
v_fma_f32 v36, -v36, v3, -v189
v_fma_f32 v181, v37, v3, -v188
v_fma_f32 v37, -v37, v3, -v189
s_waitcnt lgkmcnt(6)
v_mfma_f32_32x32x16_bf16 v[160:175], a[144:147], a[8:11], v[160:175]
ds_read_b64_tr_b16 a[132:133], v216 offset:45056
ds_read_b64_tr_b16 a[134:135], v216 offset:46080
v_fma_f32 v182, v38, v3, -v188
v_fma_f32 v38, -v38, v3, -v189
v_fma_f32 v183, v39, v3, -v188
v_mfma_f32_32x32x16_bf16 v[64:79], a[148:151], a[12:15], v[64:79]
s_add_u32 m0, s74, 0x2000
ds_read_b64_tr_b16 a[136:137], v219 offset:45056
ds_read_b64_tr_b16 a[138:139], v219 offset:46080
buffer_load_dwordx4 v227, s[44:47], s77 offen lds
s_waitcnt lgkmcnt(6)
v_mfma_f32_32x32x16_bf16 v[80:95], a[152:155], a[12:15], v[80:95]
ds_read_b64_tr_b16 a[140:141], v222 offset:45056
ds_read_b64_tr_b16 a[142:143], v222 offset:46080
v_fma_f32 v39, -v39, v3, -v189
v_exp_f32 v176, v176
v_mfma_f32_32x32x16_bf16 v[96:111], a[156:159], a[12:15], v[96:111]
s_waitcnt vmcnt(14)
s_barrier
ds_read_b64_tr_b16 a[144:145], v205 offset:0
ds_read_b64_tr_b16 a[146:147], v205 offset:1024
v_exp_f32 v32, v32
s_waitcnt lgkmcnt(6)
v_mfma_f32_32x32x16_bf16 v[112:127], a[128:131], a[12:15], v[112:127]
s_add_u32 m0, s74, 0x6000
ds_read_b64_tr_b16 a[148:149], v208 offset:0
ds_read_b64_tr_b16 a[150:151], v208 offset:1024
buffer_load_dwordx4 v231, s[48:51], s77 offen lds
v_mfma_f32_32x32x16_bf16 v[128:143], a[132:135], a[12:15], v[128:143]
ds_read_b64_tr_b16 a[152:153], v211 offset:0
ds_read_b64_tr_b16 a[154:155], v211 offset:1024
v_exp_f32 v177, v177
v_exp_f32 v33, v33
s_waitcnt lgkmcnt(6)
v_mfma_f32_32x32x16_bf16 v[144:159], a[136:139], a[12:15], v[144:159]
ds_read_b64_tr_b16 a[156:157], v214 offset:0
ds_read_b64_tr_b16 a[158:159], v214 offset:1024
v_exp_f32 v178, v178
v_exp_f32 v34, v34
v_mfma_f32_32x32x16_bf16 v[160:175], a[140:143], a[12:15], v[160:175]
s_add_u32 m0, s74, 0x3000
ds_read_b64_tr_b16 a[128:129], v217 offset:0
ds_read_b64_tr_b16 a[130:131], v217 offset:1024
buffer_load_dwordx4 v228, s[44:47], s77 offen lds
s_waitcnt lgkmcnt(6)
v_mfma_f32_32x32x16_bf16 v[64:79], a[144:147], a[16:19], v[64:79]
ds_read_b64_tr_b16 a[132:133], v220 offset:0
ds_read_b64_tr_b16 a[134:135], v220 offset:1024
v_exp_f32 v179, v179
v_exp_f32 v35, v35
v_mfma_f32_32x32x16_bf16 v[80:95], a[148:151], a[16:19], v[80:95]
ds_read_b64_tr_b16 a[136:137], v223 offset:0
ds_read_b64_tr_b16 a[138:139], v223 offset:1024
v_exp_f32 v180, v180
v_exp_f32 v36, v36
s_waitcnt lgkmcnt(6)
v_mfma_f32_32x32x16_bf16 v[96:111], a[152:155], a[16:19], v[96:111]
s_add_u32 m0, s74, 0x7000
ds_read_b64_tr_b16 a[140:141], v205 offset:4096
ds_read_b64_tr_b16 a[142:143], v205 offset:5120
buffer_load_dwordx4 v232, s[48:51], s77 offen lds
v_mfma_f32_32x32x16_bf16 v[112:127], a[156:159], a[16:19], v[112:127]
ds_read_b64_tr_b16 a[144:145], v208 offset:4096
ds_read_b64_tr_b16 a[146:147], v208 offset:5120
v_exp_f32 v181, v181
v_exp_f32 v37, v37
s_waitcnt lgkmcnt(6)
v_mfma_f32_32x32x16_bf16 v[128:143], a[128:131], a[16:19], v[128:143]
ds_read_b64_tr_b16 a[148:149], v211 offset:4096
ds_read_b64_tr_b16 a[150:151], v211 offset:5120
v_exp_f32 v182, v182
v_exp_f32 v38, v38
v_mfma_f32_32x32x16_bf16 v[144:159], a[132:135], a[16:19], v[144:159]
s_add_u32 s77, s80, s16
s_add_u32 m0, s74, 0x20000
ds_read_b64_tr_b16 a[152:153], v214 offset:4096
ds_read_b64_tr_b16 a[154:155], v214 offset:5120
buffer_load_dwordx4 v225, s[44:47], s77 offen lds
s_waitcnt lgkmcnt(6)
v_mfma_f32_32x32x16_bf16 v[160:175], a[136:139], a[16:19], v[160:175]
ds_read_b64_tr_b16 a[156:157], v217 offset:4096
ds_read_b64_tr_b16 a[158:159], v217 offset:5120
v_exp_f32 v183, v183
v_exp_f32 v39, v39
v_mfma_f32_32x32x16_bf16 v[64:79], a[140:143], a[20:23], v[64:79]
ds_read_b64_tr_b16 a[128:129], v220 offset:4096
ds_read_b64_tr_b16 a[130:131], v220 offset:5120
v_add_f32 v184, v176, v177
v_add_f32 v185, v32, v33
v_add_f32 v184, v184, v178
s_waitcnt lgkmcnt(6)
v_mfma_f32_32x32x16_bf16 v[80:95], a[144:147], a[20:23], v[80:95]
s_add_u32 m0, s74, 0x24000
ds_read_b64_tr_b16 a[132:133], v223 offset:4096
ds_read_b64_tr_b16 a[134:135], v223 offset:5120
buffer_load_dwordx4 v229, s[48:51], s77 offen lds
v_mfma_f32_32x32x16_bf16 v[96:111], a[148:151], a[20:23], v[96:111]
ds_read_b64_tr_b16 a[136:137], v205 offset:8192
ds_read_b64_tr_b16 a[138:139], v205 offset:9216
v_add_f32 v185, v185, v34
v_add_f32 v184, v184, v179
v_add_f32 v185, v185, v35
s_waitcnt lgkmcnt(6)
v_mfma_f32_32x32x16_bf16 v[112:127], a[152:155], a[20:23], v[112:127]
ds_read_b64_tr_b16 a[140:141], v208 offset:8192
ds_read_b64_tr_b16 a[142:143], v208 offset:9216
v_add_f32 v184, v184, v180
v_add_f32 v185, v185, v36
v_add_f32 v184, v184, v181
v_mfma_f32_32x32x16_bf16 v[128:143], a[156:159], a[20:23], v[128:143]
s_add_u32 m0, s74, 0x21000
ds_read_b64_tr_b16 a[144:145], v211 offset:8192
ds_read_b64_tr_b16 a[146:147], v211 offset:9216
buffer_load_dwordx4 v226, s[44:47], s77 offen lds
s_waitcnt lgkmcnt(6)
v_mfma_f32_32x32x16_bf16 v[144:159], a[128:131], a[20:23], v[144:159]
ds_read_b64_tr_b16 a[148:149], v214 offset:8192
ds_read_b64_tr_b16 a[150:151], v214 offset:9216
v_add_f32 v185, v185, v37
v_add_f32 v184, v184, v182
v_add_f32 v185, v185, v38
v_mfma_f32_32x32x16_bf16 v[160:175], a[132:135], a[20:23], v[160:175]
ds_read_b64_tr_b16 a[152:153], v217 offset:8192
ds_read_b64_tr_b16 a[154:155], v217 offset:9216
v_add_f32 v184, v184, v183
v_add_f32 v185, v185, v39
v_max3_f32 v251, v40, v41, v42
s_waitcnt lgkmcnt(6)
v_mfma_f32_32x32x16_bf16 v[64:79], a[136:139], a[24:27], v[64:79]
s_add_u32 m0, s74, 0x25000
ds_read_b64_tr_b16 a[156:157], v220 offset:8192
ds_read_b64_tr_b16 a[158:159], v220 offset:9216
buffer_load_dwordx4 v230, s[48:51], s77 offen lds
v_mfma_f32_32x32x16_bf16 v[80:95], a[140:143], a[24:27], v[80:95]
ds_read_b64_tr_b16 a[128:129], v223 offset:8192
ds_read_b64_tr_b16 a[130:131], v223 offset:9216
v_permlane32_swap_b32 v184, v185
v_add_f32 v186, v184, v185
v_mov_b32 v187, v186
s_waitcnt lgkmcnt(6)
v_mfma_f32_32x32x16_bf16 v[96:111], a[144:147], a[24:27], v[96:111]
ds_read_b64_tr_b16 a[132:133], v205 offset:12288
ds_read_b64_tr_b16 a[134:135], v205 offset:13312
v_permlane32_swap_b32 v186, v187
v_rcp_f32 v188, v186
v_mfma_f32_32x32x16_bf16 v[112:127], a[148:151], a[24:27], v[112:127]
s_add_u32 m0, s74, 0x22000
ds_read_b64_tr_b16 a[136:137], v208 offset:12288
ds_read_b64_tr_b16 a[138:139], v208 offset:13312
buffer_load_dwordx4 v227, s[44:47], s77 offen lds
s_waitcnt lgkmcnt(6)
v_mfma_f32_32x32x16_bf16 v[128:143], a[152:155], a[24:27], v[128:143]
ds_read_b64_tr_b16 a[140:141], v211 offset:12288
ds_read_b64_tr_b16 a[142:143], v211 offset:13312
v_rcp_f32 v189, v187
v_mul_f32 v176, v176, v188
v_mfma_f32_32x32x16_bf16 v[144:159], a[156:159], a[24:27], v[144:159]
ds_read_b64_tr_b16 a[144:145], v214 offset:12288
ds_read_b64_tr_b16 a[146:147], v214 offset:13312
v_mul_f32 v32, v32, v189
v_mul_f32 v177, v177, v188
v_mul_f32 v33, v33, v189
s_waitcnt lgkmcnt(6)
v_mfma_f32_32x32x16_bf16 v[160:175], a[128:131], a[24:27], v[160:175]
s_add_u32 m0, s74, 0x26000
ds_read_b64_tr_b16 a[148:149], v217 offset:12288
ds_read_b64_tr_b16 a[150:151], v217 offset:13312
buffer_load_dwordx4 v231, s[48:51], s77 offen lds
v_mfma_f32_32x32x16_bf16 v[64:79], a[132:135], a[28:31], v[64:79]
ds_read_b64_tr_b16 a[152:153], v220 offset:12288
ds_read_b64_tr_b16 a[154:155], v220 offset:13312
v_mul_f32 v178, v178, v188
v_mul_f32 v34, v34, v189
v_mul_f32 v179, v179, v188
s_waitcnt lgkmcnt(6)
v_mfma_f32_32x32x16_bf16 v[80:95], a[136:139], a[28:31], v[80:95]
ds_read_b64_tr_b16 a[156:157], v223 offset:12288
ds_read_b64_tr_b16 a[158:159], v223 offset:13312
v_mul_f32 v35, v35, v189
v_mul_f32 v180, v180, v188
v_mul_f32 v36, v36, v189
v_mfma_f32_32x32x16_bf16 v[96:111], a[140:143], a[28:31], v[96:111]
s_waitcnt vmcnt(15)
s_barrier
s_add_u32 m0, s74, 0x23000
ds_read_b64_tr_b16 a[128:129], v205 offset:32768
ds_read_b64_tr_b16 a[130:131], v205 offset:33792
buffer_load_dwordx4 v228, s[44:47], s77 offen lds
s_waitcnt lgkmcnt(6)
v_mfma_f32_32x32x16_bf16 v[112:127], a[144:147], a[28:31], v[112:127]
ds_read_b64_tr_b16 a[132:133], v208 offset:32768
ds_read_b64_tr_b16 a[134:135], v208 offset:33792
v_mul_f32 v181, v181, v188
v_mul_f32 v37, v37, v189
v_mul_f32 v182, v182, v188
v_mfma_f32_32x32x16_bf16 v[128:143], a[148:151], a[28:31], v[128:143]
ds_read_b64_tr_b16 a[136:137], v211 offset:32768
ds_read_b64_tr_b16 a[138:139], v211 offset:33792
v_mul_f32 v38, v38, v189
v_mul_f32 v183, v183, v188
v_mul_f32 v39, v39, v189
s_waitcnt lgkmcnt(6)
v_mfma_f32_32x32x16_bf16 v[144:159], a[152:155], a[28:31], v[144:159]
s_add_u32 m0, s74, 0x27000
ds_read_b64_tr_b16 a[140:141], v214 offset:32768
ds_read_b64_tr_b16 a[142:143], v214 offset:33792
buffer_load_dwordx4 v232, s[48:51], s77 offen lds
v_mfma_f32_32x32x16_bf16 v[160:175], a[156:159], a[28:31], v[160:175]
ds_read_b64_tr_b16 a[144:145], v217 offset:32768
ds_read_b64_tr_b16 a[146:147], v217 offset:33792
v_cvt_pk_bf16_f32 v32, v32, v33
v_cvt_pk_bf16_f32 v33, v34, v35
v_cvt_pk_bf16_f32 v34, v36, v37
s_waitcnt lgkmcnt(6)
v_mfma_f32_32x32x16_bf16 v[64:79], a[128:131], a[32:35], v[64:79]
ds_read_b64_tr_b16 a[148:149], v220 offset:32768
ds_read_b64_tr_b16 a[150:151], v220 offset:33792
v_cvt_pk_bf16_f32 v35, v38, v39
v_cvt_pk_bf16_f32 v36, v176, v177
v_cvt_pk_bf16_f32 v37, v178, v179
v_mfma_f32_32x32x16_bf16 v[80:95], a[132:135], a[32:35], v[80:95]
s_add_u32 s77, s80, s17
s_add_u32 m0, s74, 0x8000
ds_read_b64_tr_b16 a[152:153], v223 offset:32768
ds_read_b64_tr_b16 a[154:155], v223 offset:33792
buffer_load_dwordx4 v225, s[44:47], s77 offen lds
s_waitcnt lgkmcnt(6)
v_mfma_f32_32x32x16_bf16 v[96:111], a[136:139], a[32:35], v[96:111]
ds_read_b64_tr_b16 a[156:157], v205 offset:36864
ds_read_b64_tr_b16 a[158:159], v205 offset:37888
v_cvt_pk_bf16_f32 v38, v180, v181
v_cvt_pk_bf16_f32 v39, v182, v183
v_max3_f32 v252, -v40, -v41, -v42
v_mfma_f32_32x32x16_bf16 v[112:127], a[140:143], a[32:35], v[112:127]
ds_read_b64_tr_b16 a[128:129], v208 offset:36864
ds_read_b64_tr_b16 a[130:131], v208 offset:37888
v_max3_f32 v251, v251, v43, v44
v_max3_f32 v252, v252, -v43, -v44
v_max3_f32 v251, v251, v45, v46
s_waitcnt lgkmcnt(6)
v_mfma_f32_32x32x16_bf16 v[128:143], a[144:147], a[32:35], v[128:143]
s_add_u32 m0, s74, 0xc000
ds_read_b64_tr_b16 a[132:133], v211 offset:36864
ds_read_b64_tr_b16 a[134:135], v211 offset:37888
buffer_load_dwordx4 v229, s[48:51], s77 offen lds
v_mfma_f32_32x32x16_bf16 v[144:159], a[148:151], a[32:35], v[144:159]
ds_read_b64_tr_b16 a[136:137], v214 offset:36864
ds_read_b64_tr_b16 a[138:139], v214 offset:37888
s_lshr_b32 s0, s2, 3
s_lshl_b32 s0, s0, 2
s_add_u32 s0, s0, s68
s_mul_i32 s27, s0, 0x2b00
v_lshlrev_b32 v16, 7, v1
buffer_load_dword v254, v16, s[52:55], s27 offen
s_waitcnt lgkmcnt(6)
v_mfma_f32_32x32x16_bf16 v[160:175], a[152:155], a[32:35], v[160:175]
ds_read_b64_tr_b16 a[140:141], v217 offset:36864
ds_read_b64_tr_b16 a[142:143], v217 offset:37888
v_max3_f32 v252, v252, -v45, -v46
v_max_f32 v251, v251, v47
v_max_f32 v252, v252, -v47
v_mfma_f32_32x32x16_bf16 v[64:79], a[156:159], a[36:39], v[64:79]
s_add_u32 m0, s74, 0x9000
ds_read_b64_tr_b16 a[144:145], v220 offset:36864
ds_read_b64_tr_b16 a[146:147], v220 offset:37888
buffer_load_dwordx4 v226, s[44:47], s77 offen lds
s_waitcnt lgkmcnt(6)
v_mfma_f32_32x32x16_bf16 v[80:95], a[128:131], a[36:39], v[80:95]
ds_read_b64_tr_b16 a[148:149], v223 offset:36864
ds_read_b64_tr_b16 a[150:151], v223 offset:37888
v_permlane32_swap_b32 v251, v252
v_max_f32 v5, v251, v252
v_mov_b32 v6, v5
v_mfma_f32_32x32x16_bf16 v[96:111], a[132:135], a[36:39], v[96:111]
ds_read_b64_tr_b16 a[152:153], v205 offset:40960
ds_read_b64_tr_b16 a[154:155], v205 offset:41984
v_permlane32_swap_b32 v5, v6
v_mul_f32 v7, v5, v3
v_mul_f32 v23, v6, v3
s_waitcnt lgkmcnt(6)
v_mfma_f32_32x32x16_bf16 v[112:127], a[136:139], a[36:39], v[112:127]
s_add_u32 m0, s74, 0xd000
ds_read_b64_tr_b16 a[156:157], v208 offset:40960
ds_read_b64_tr_b16 a[158:159], v208 offset:41984
buffer_load_dwordx4 v230, s[48:51], s77 offen lds
v_mfma_f32_32x32x16_bf16 v[128:143], a[140:143], a[36:39], v[128:143]
ds_read_b64_tr_b16 a[128:129], v211 offset:40960
ds_read_b64_tr_b16 a[130:131], v211 offset:41984
v_fma_f32 v243, v40, v3, -v7
v_fma_f32 v40, -v40, v3, -v23
v_fma_f32 v244, v41, v3, -v7
s_waitcnt lgkmcnt(6)
v_mfma_f32_32x32x16_bf16 v[144:159], a[144:147], a[36:39], v[144:159]
ds_read_b64_tr_b16 a[132:133], v214 offset:40960
ds_read_b64_tr_b16 a[134:135], v214 offset:41984
v_fma_f32 v41, -v41, v3, -v23
v_fma_f32 v245, v42, v3, -v7
v_fma_f32 v42, -v42, v3, -v23
v_mfma_f32_32x32x16_bf16 v[160:175], a[148:151], a[36:39], v[160:175]
s_add_u32 m0, s74, 0xa000
ds_read_b64_tr_b16 a[136:137], v217 offset:40960
ds_read_b64_tr_b16 a[138:139], v217 offset:41984
buffer_load_dwordx4 v227, s[44:47], s77 offen lds
s_waitcnt lgkmcnt(6)
v_mfma_f32_32x32x16_bf16 v[64:79], a[152:155], a[40:43], v[64:79]
ds_read_b64_tr_b16 a[140:141], v220 offset:40960
ds_read_b64_tr_b16 a[142:143], v220 offset:41984
s_add_u32 s27, s27, 0x2000
v_min_u32 v17, 21, v1
v_lshlrev_b32 v17, 7, v17
buffer_load_dword v255, v17, s[52:55], s27 offen
v_mfma_f32_32x32x16_bf16 v[80:95], a[156:159], a[40:43], v[80:95]
ds_read_b64_tr_b16 a[144:145], v223 offset:40960
ds_read_b64_tr_b16 a[146:147], v223 offset:41984
v_fma_f32 v246, v43, v3, -v7
v_fma_f32 v43, -v43, v3, -v23
v_fma_f32 v247, v44, v3, -v7
s_waitcnt lgkmcnt(6)
v_mfma_f32_32x32x16_bf16 v[96:111], a[128:131], a[40:43], v[96:111]
s_add_u32 m0, s74, 0xe000
ds_read_b64_tr_b16 a[148:149], v205 offset:45056
ds_read_b64_tr_b16 a[150:151], v205 offset:46080
buffer_load_dwordx4 v231, s[48:51], s77 offen lds
v_mfma_f32_32x32x16_bf16 v[112:127], a[132:135], a[40:43], v[112:127]
ds_read_b64_tr_b16 a[152:153], v208 offset:45056
ds_read_b64_tr_b16 a[154:155], v208 offset:46080
v_fma_f32 v44, -v44, v3, -v23
v_fma_f32 v248, v45, v3, -v7
v_fma_f32 v45, -v45, v3, -v23
s_waitcnt lgkmcnt(6)
v_mfma_f32_32x32x16_bf16 v[128:143], a[136:139], a[40:43], v[128:143]
ds_read_b64_tr_b16 a[156:157], v211 offset:45056
ds_read_b64_tr_b16 a[158:159], v211 offset:46080
v_fma_f32 v249, v46, v3, -v7
v_fma_f32 v46, -v46, v3, -v23
v_fma_f32 v250, v47, v3, -v7
v_mfma_f32_32x32x16_bf16 v[144:159], a[140:143], a[40:43], v[144:159]
s_add_u32 m0, s74, 0xb000
ds_read_b64_tr_b16 a[128:129], v214 offset:45056
ds_read_b64_tr_b16 a[130:131], v214 offset:46080
buffer_load_dwordx4 v228, s[44:47], s77 offen lds
s_waitcnt lgkmcnt(6)
v_mfma_f32_32x32x16_bf16 v[160:175], a[144:147], a[40:43], v[160:175]
ds_read_b64_tr_b16 a[132:133], v217 offset:45056
ds_read_b64_tr_b16 a[134:135], v217 offset:46080
v_fma_f32 v47, -v47, v3, -v23
v_exp_f32 v243, v243
v_mfma_f32_32x32x16_bf16 v[64:79], a[148:151], a[44:47], v[64:79]
ds_read_b64_tr_b16 a[136:137], v220 offset:45056
ds_read_b64_tr_b16 a[138:139], v220 offset:46080
v_exp_f32 v40, v40
v_exp_f32 v244, v244
s_waitcnt lgkmcnt(6)
v_mfma_f32_32x32x16_bf16 v[80:95], a[152:155], a[44:47], v[80:95]
s_add_u32 m0, s74, 0xf000
ds_read_b64_tr_b16 a[140:141], v223 offset:45056
ds_read_b64_tr_b16 a[142:143], v223 offset:46080
buffer_load_dwordx4 v232, s[48:51], s77 offen lds
v_mfma_f32_32x32x16_bf16 v[96:111], a[156:159], a[44:47], v[96:111]
s_waitcnt vmcnt(18)
s_barrier
ds_read_b64_tr_b16 a[144:145], v204 offset:0
ds_read_b64_tr_b16 a[146:147], v204 offset:1024
s_lshl_b32 s27, s0, 12
v_and_b32 v17, 31, v1
v_lshlrev_b32 v17, 7, v17
buffer_load_dword v254, v17, s[40:43], s27 offen
s_waitcnt lgkmcnt(6)
v_mfma_f32_32x32x16_bf16 v[112:127], a[128:131], a[44:47], v[112:127]
ds_read_b64_tr_b16 a[148:149], v207 offset:0
ds_read_b64_tr_b16 a[150:151], v207 offset:1024
v_exp_f32 v41, v41
v_exp_f32 v245, v245
v_mfma_f32_32x32x16_bf16 v[128:143], a[132:135], a[44:47], v[128:143]
s_add_u32 s77, s80, s18
s_add_u32 m0, s74, 0x10000
ds_read_b64_tr_b16 a[152:153], v210 offset:0
ds_read_b64_tr_b16 a[154:155], v210 offset:1024
buffer_load_dwordx4 v225, s[44:47], s77 offen lds
s_waitcnt lgkmcnt(6)
v_mfma_f32_32x32x16_bf16 v[144:159], a[136:139], a[44:47], v[144:159]
ds_read_b64_tr_b16 a[156:157], v213 offset:0
ds_read_b64_tr_b16 a[158:159], v213 offset:1024
v_exp_f32 v42, v42
v_exp_f32 v246, v246
v_mfma_f32_32x32x16_bf16 v[160:175], a[140:143], a[44:47], v[160:175]
ds_read_b64_tr_b16 a[128:129], v216 offset:0
ds_read_b64_tr_b16 a[130:131], v216 offset:1024
v_exp_f32 v43, v43
v_exp_f32 v247, v247
s_waitcnt lgkmcnt(6)
v_mfma_f32_32x32x16_bf16 v[64:79], a[144:147], a[48:51], v[64:79]
s_add_u32 m0, s74, 0x14000
ds_read_b64_tr_b16 a[132:133], v219 offset:0
ds_read_b64_tr_b16 a[134:135], v219 offset:1024
buffer_load_dwordx4 v229, s[48:51], s77 offen lds
v_mfma_f32_32x32x16_bf16 v[80:95], a[148:151], a[48:51], v[80:95]
ds_read_b64_tr_b16 a[136:137], v222 offset:0
ds_read_b64_tr_b16 a[138:139], v222 offset:1024
v_exp_f32 v44, v44
v_exp_f32 v248, v248
s_waitcnt lgkmcnt(6)
v_mfma_f32_32x32x16_bf16 v[96:111], a[152:155], a[48:51], v[96:111]
ds_read_b64_tr_b16 a[140:141], v204 offset:4096
ds_read_b64_tr_b16 a[142:143], v204 offset:5120
v_exp_f32 v45, v45
v_exp_f32 v249, v249
v_mfma_f32_32x32x16_bf16 v[112:127], a[156:159], a[48:51], v[112:127]
s_add_u32 m0, s74, 0x11000
ds_read_b64_tr_b16 a[144:145], v207 offset:4096
ds_read_b64_tr_b16 a[146:147], v207 offset:5120
buffer_load_dwordx4 v226, s[44:47], s77 offen lds
s_waitcnt lgkmcnt(6)
v_mfma_f32_32x32x16_bf16 v[128:143], a[128:131], a[48:51], v[128:143]
ds_read_b64_tr_b16 a[148:149], v210 offset:4096
ds_read_b64_tr_b16 a[150:151], v210 offset:5120
v_exp_f32 v46, v46
v_exp_f32 v250, v250
v_mfma_f32_32x32x16_bf16 v[144:159], a[132:135], a[48:51], v[144:159]
ds_read_b64_tr_b16 a[152:153], v213 offset:4096
ds_read_b64_tr_b16 a[154:155], v213 offset:5120
v_exp_f32 v47, v47
v_add_f32 v251, v243, v244
s_waitcnt lgkmcnt(6)
v_mfma_f32_32x32x16_bf16 v[160:175], a[136:139], a[48:51], v[160:175]
s_add_u32 m0, s74, 0x15000
ds_read_b64_tr_b16 a[156:157], v216 offset:4096
ds_read_b64_tr_b16 a[158:159], v216 offset:5120
buffer_load_dwordx4 v230, s[48:51], s77 offen lds
v_mfma_f32_32x32x16_bf16 v[64:79], a[140:143], a[52:55], v[64:79]
ds_read_b64_tr_b16 a[128:129], v219 offset:4096
ds_read_b64_tr_b16 a[130:131], v219 offset:5120
v_add_f32 v252, v40, v41
v_add_f32 v251, v251, v245
v_add_f32 v252, v252, v42
s_waitcnt lgkmcnt(6)
v_mfma_f32_32x32x16_bf16 v[80:95], a[144:147], a[52:55], v[80:95]
ds_read_b64_tr_b16 a[132:133], v222 offset:4096
ds_read_b64_tr_b16 a[134:135], v222 offset:5120
v_add_f32 v251, v251, v246
v_add_f32 v252, v252, v43
v_add_f32 v251, v251, v247
v_mfma_f32_32x32x16_bf16 v[96:111], a[148:151], a[52:55], v[96:111]
s_add_u32 m0, s74, 0x12000
ds_read_b64_tr_b16 a[136:137], v204 offset:8192
ds_read_b64_tr_b16 a[138:139], v204 offset:9216
buffer_load_dwordx4 v227, s[44:47], s77 offen lds
s_waitcnt lgkmcnt(6)
v_mfma_f32_32x32x16_bf16 v[112:127], a[152:155], a[52:55], v[112:127]
ds_read_b64_tr_b16 a[140:141], v207 offset:8192
ds_read_b64_tr_b16 a[142:143], v207 offset:9216
v_add_f32 v252, v252, v44
v_add_f32 v251, v251, v248
v_add_f32 v252, v252, v45
v_mfma_f32_32x32x16_bf16 v[128:143], a[156:159], a[52:55], v[128:143]
ds_read_b64_tr_b16 a[144:145], v210 offset:8192
ds_read_b64_tr_b16 a[146:147], v210 offset:9216
v_add_f32 v251, v251, v249
v_add_f32 v252, v252, v46
v_add_f32 v251, v251, v250
s_waitcnt lgkmcnt(6)
v_mfma_f32_32x32x16_bf16 v[144:159], a[128:131], a[52:55], v[144:159]
s_add_u32 m0, s74, 0x16000
ds_read_b64_tr_b16 a[148:149], v213 offset:8192
ds_read_b64_tr_b16 a[150:151], v213 offset:9216
buffer_load_dwordx4 v231, s[48:51], s77 offen lds
v_mfma_f32_32x32x16_bf16 v[160:175], a[132:135], a[52:55], v[160:175]
ds_read_b64_tr_b16 a[152:153], v216 offset:8192
ds_read_b64_tr_b16 a[154:155], v216 offset:9216
v_add_f32 v252, v252, v47
v_max3_f32 v184, v48, v49, v50
v_max3_f32 v185, -v48, -v49, -v50
s_waitcnt lgkmcnt(6)
v_mfma_f32_32x32x16_bf16 v[64:79], a[136:139], a[56:59], v[64:79]
ds_read_b64_tr_b16 a[156:157], v219 offset:8192
ds_read_b64_tr_b16 a[158:159], v219 offset:9216
v_permlane32_swap_b32 v251, v252
v_add_f32 v5, v251, v252
v_mov_b32 v6, v5
v_mfma_f32_32x32x16_bf16 v[80:95], a[140:143], a[56:59], v[80:95]
s_add_u32 m0, s74, 0x13000
ds_read_b64_tr_b16 a[128:129], v222 offset:8192
ds_read_b64_tr_b16 a[130:131], v222 offset:9216
buffer_load_dwordx4 v228, s[44:47], s77 offen lds
s_waitcnt lgkmcnt(6)
v_mfma_f32_32x32x16_bf16 v[96:111], a[144:147], a[56:59], v[96:111]
ds_read_b64_tr_b16 a[132:133], v204 offset:12288
ds_read_b64_tr_b16 a[134:135], v204 offset:13312
v_permlane32_swap_b32 v5, v6
v_rcp_f32 v7, v5
v_mfma_f32_32x32x16_bf16 v[112:127], a[148:151], a[56:59], v[112:127]
ds_read_b64_tr_b16 a[136:137], v207 offset:12288
ds_read_b64_tr_b16 a[138:139], v207 offset:13312
v_rcp_f32 v23, v6
v_mul_f32 v243, v243, v7
s_waitcnt lgkmcnt(6)
v_mfma_f32_32x32x16_bf16 v[128:143], a[152:155], a[56:59], v[128:143]
s_add_u32 m0, s74, 0x17000
ds_read_b64_tr_b16 a[140:141], v210 offset:12288
ds_read_b64_tr_b16 a[142:143], v210 offset:13312
buffer_load_dwordx4 v232, s[48:51], s77 offen lds
v_mfma_f32_32x32x16_bf16 v[144:159], a[156:159], a[56:59], v[144:159]
ds_read_b64_tr_b16 a[144:145], v213 offset:12288
ds_read_b64_tr_b16 a[146:147], v213 offset:13312
v_mul_f32 v40, v40, v23
v_mul_f32 v244, v244, v7
v_mul_f32 v41, v41, v23
s_waitcnt lgkmcnt(6)
v_mfma_f32_32x32x16_bf16 v[160:175], a[128:131], a[56:59], v[160:175]
ds_read_b64_tr_b16 a[148:149], v216 offset:12288
ds_read_b64_tr_b16 a[150:151], v216 offset:13312
v_mul_f32 v245, v245, v7
v_mul_f32 v42, v42, v23
v_mul_f32 v246, v246, v7
v_mfma_f32_32x32x16_bf16 v[64:79], a[132:135], a[60:63], v[64:79]
ds_read_b64_tr_b16 a[152:153], v219 offset:12288
ds_read_b64_tr_b16 a[154:155], v219 offset:13312
v_mul_f32 v43, v43, v23
v_mul_f32 v247, v247, v7
v_mul_f32 v44, v44, v23
s_waitcnt lgkmcnt(6)
v_mfma_f32_32x32x16_bf16 v[80:95], a[136:139], a[60:63], v[80:95]
ds_read_b64_tr_b16 a[156:157], v222 offset:12288
ds_read_b64_tr_b16 a[158:159], v222 offset:13312
v_mul_f32 v248, v248, v7
v_mul_f32 v45, v45, v23
v_mul_f32 v249, v249, v7
v_mfma_f32_32x32x16_bf16 v[96:111], a[140:143], a[60:63], v[96:111]
s_waitcnt vmcnt(19)
s_barrier
s_add_u32 s77, s80, s19
s_add_u32 m0, s74, 0x18000
ds_read_b64_tr_b16 a[128:129], v206 offset:0
ds_read_b64_tr_b16 a[130:131], v206 offset:1024
buffer_load_dwordx4 v225, s[44:47], s77 offen lds
s_waitcnt lgkmcnt(6)
v_mfma_f32_32x32x16_bf16 v[112:127], a[144:147], a[60:63], v[112:127]
ds_read_b64_tr_b16 a[132:133], v209 offset:0
ds_read_b64_tr_b16 a[134:135], v209 offset:1024
v_mul_f32 v46, v46, v23
v_mul_f32 v250, v250, v7
v_mul_f32 v47, v47, v23
v_mfma_f32_32x32x16_bf16 v[128:143], a[148:151], a[60:63], v[128:143]
ds_read_b64_tr_b16 a[136:137], v212 offset:0
ds_read_b64_tr_b16 a[138:139], v212 offset:1024
v_cvt_pk_bf16_f32 v40, v40, v41
v_cvt_pk_bf16_f32 v41, v42, v43
v_cvt_pk_bf16_f32 v42, v44, v45
s_waitcnt lgkmcnt(6)
v_mfma_f32_32x32x16_bf16 v[144:159], a[152:155], a[60:63], v[144:159]
s_add_u32 m0, s74, 0x1c000
ds_read_b64_tr_b16 a[140:141], v215 offset:0
ds_read_b64_tr_b16 a[142:143], v215 offset:1024
buffer_load_dwordx4 v229, s[48:51], s77 offen lds
v_mfma_f32_32x32x16_bf16 v[160:175], a[156:159], a[60:63], v[160:175]
ds_read_b64_tr_b16 a[144:145], v218 offset:0
ds_read_b64_tr_b16 a[146:147], v218 offset:1024
v_cvt_pk_bf16_f32 v43, v46, v47
v_cvt_pk_bf16_f32 v44, v243, v244
v_cvt_pk_bf16_f32 v45, v245, v246
s_waitcnt lgkmcnt(6)
v_mfma_f32_32x32x16_bf16 v[64:79], a[128:131], a[64:67], v[64:79]
ds_read_b64_tr_b16 a[148:149], v221 offset:0
ds_read_b64_tr_b16 a[150:151], v221 offset:1024
v_cvt_pk_bf16_f32 v46, v247, v248
v_cvt_pk_bf16_f32 v47, v249, v250
v_max3_f32 v184, v184, v51, v52
v_mfma_f32_32x32x16_bf16 v[80:95], a[132:135], a[64:67], v[80:95]
s_add_u32 m0, s74, 0x19000
ds_read_b64_tr_b16 a[152:153], v224 offset:0
ds_read_b64_tr_b16 a[154:155], v224 offset:1024
buffer_load_dwordx4 v226, s[44:47], s77 offen lds
s_waitcnt lgkmcnt(6)
v_mfma_f32_32x32x16_bf16 v[96:111], a[136:139], a[64:67], v[96:111]
ds_read_b64_tr_b16 a[156:157], v206 offset:4096
ds_read_b64_tr_b16 a[158:159], v206 offset:5120
v_max3_f32 v185, v185, -v51, -v52
v_max3_f32 v184, v184, v53, v54
v_max3_f32 v185, v185, -v53, -v54
v_mfma_f32_32x32x16_bf16 v[112:127], a[140:143], a[64:67], v[112:127]
ds_read_b64_tr_b16 a[128:129], v209 offset:4096
ds_read_b64_tr_b16 a[130:131], v209 offset:5120
v_max_f32 v184, v184, v55
v_max_f32 v185, v185, -v55
v_max3_f32 v251, v56, v57, v58
s_waitcnt lgkmcnt(6)
v_mfma_f32_32x32x16_bf16 v[128:143], a[144:147], a[64:67], v[128:143]
s_add_u32 m0, s74, 0x1d000
ds_read_b64_tr_b16 a[132:133], v212 offset:4096
ds_read_b64_tr_b16 a[134:135], v212 offset:5120
buffer_load_dwordx4 v230, s[48:51], s77 offen lds
v_mfma_f32_32x32x16_bf16 v[144:159], a[148:151], a[64:67], v[144:159]
ds_read_b64_tr_b16 a[136:137], v215 offset:4096
ds_read_b64_tr_b16 a[138:139], v215 offset:5120
v_permlane32_swap_b32 v184, v185
v_max_f32 v186, v184, v185
v_mov_b32 v187, v186
s_waitcnt lgkmcnt(6)
v_mfma_f32_32x32x16_bf16 v[160:175], a[152:155], a[64:67], v[160:175]
ds_read_b64_tr_b16 a[140:141], v218 offset:4096
ds_read_b64_tr_b16 a[142:143], v218 offset:5120
v_permlane32_swap_b32 v186, v187
v_mul_f32 v188, v186, v3
v_mul_f32 v189, v187, v3
v_mfma_f32_32x32x16_bf16 v[64:79], a[156:159], a[68:71], v[64:79]
s_add_u32 m0, s74, 0x1a000
ds_read_b64_tr_b16 a[144:145], v221 offset:4096
ds_read_b64_tr_b16 a[146:147], v221 offset:5120
buffer_load_dwordx4 v227, s[44:47], s77 offen lds
s_waitcnt lgkmcnt(6)
v_mfma_f32_32x32x16_bf16 v[80:95], a[128:131], a[68:71], v[80:95]
ds_read_b64_tr_b16 a[148:149], v224 offset:4096
ds_read_b64_tr_b16 a[150:151], v224 offset:5120
v_fma_f32 v176, v48, v3, -v188
v_fma_f32 v48, -v48, v3, -v189
v_fma_f32 v177, v49, v3, -v188
v_mfma_f32_32x32x16_bf16 v[96:111], a[132:135], a[68:71], v[96:111]
ds_read_b64_tr_b16 a[152:153], v206 offset:8192
ds_read_b64_tr_b16 a[154:155], v206 offset:9216
v_fma_f32 v49, -v49, v3, -v189
v_fma_f32 v178, v50, v3, -v188
v_fma_f32 v50, -v50, v3, -v189
s_waitcnt lgkmcnt(6)
v_mfma_f32_32x32x16_bf16 v[112:127], a[136:139], a[68:71], v[112:127]
s_add_u32 m0, s74, 0x1e000
ds_read_b64_tr_b16 a[156:157], v209 offset:8192
ds_read_b64_tr_b16 a[158:159], v209 offset:9216
buffer_load_dwordx4 v231, s[48:51], s77 offen lds
v_mfma_f32_32x32x16_bf16 v[128:143], a[140:143], a[68:71], v[128:143]
ds_read_b64_tr_b16 a[128:129], v212 offset:8192
ds_read_b64_tr_b16 a[130:131], v212 offset:9216
v_fma_f32 v179, v51, v3, -v188
v_fma_f32 v51, -v51, v3, -v189
v_fma_f32 v180, v52, v3, -v188
s_waitcnt lgkmcnt(6)
v_mfma_f32_32x32x16_bf16 v[144:159], a[144:147], a[68:71], v[144:159]
ds_read_b64_tr_b16 a[132:133], v215 offset:8192
ds_read_b64_tr_b16 a[134:135], v215 offset:9216
v_fma_f32 v52, -v52, v3, -v189
v_fma_f32 v181, v53, v3, -v188
v_fma_f32 v53, -v53, v3, -v189
v_mfma_f32_32x32x16_bf16 v[160:175], a[148:151], a[68:71], v[160:175]
s_add_u32 m0, s74, 0x1b000
ds_read_b64_tr_b16 a[136:137], v218 offset:8192
ds_read_b64_tr_b16 a[138:139], v218 offset:9216
buffer_load_dwordx4 v228, s[44:47], s77 offen lds
s_waitcnt lgkmcnt(6)
v_mfma_f32_32x32x16_bf16 v[64:79], a[152:155], a[72:75], v[64:79]
ds_read_b64_tr_b16 a[140:141], v221 offset:8192
ds_read_b64_tr_b16 a[142:143], v221 offset:9216
v_fma_f32 v182, v54, v3, -v188
v_fma_f32 v54, -v54, v3, -v189
v_fma_f32 v183, v55, v3, -v188
v_mfma_f32_32x32x16_bf16 v[80:95], a[156:159], a[72:75], v[80:95]
ds_read_b64_tr_b16 a[144:145], v224 offset:8192
ds_read_b64_tr_b16 a[146:147], v224 offset:9216
v_fma_f32 v55, -v55, v3, -v189
v_exp_f32 v176, v176
s_waitcnt lgkmcnt(6)
v_mfma_f32_32x32x16_bf16 v[96:111], a[128:131], a[72:75], v[96:111]
s_add_u32 m0, s74, 0x1f000
ds_read_b64_tr_b16 a[148:149], v206 offset:12288
ds_read_b64_tr_b16 a[150:151], v206 offset:13312
buffer_load_dwordx4 v232, s[48:51], s77 offen lds
v_mfma_f32_32x32x16_bf16 v[112:127], a[132:135], a[72:75], v[112:127]
ds_read_b64_tr_b16 a[152:153], v209 offset:12288
ds_read_b64_tr_b16 a[154:155], v209 offset:13312
v_exp_f32 v48, v48
v_exp_f32 v177, v177
s_waitcnt lgkmcnt(6)
v_mfma_f32_32x32x16_bf16 v[128:143], a[136:139], a[72:75], v[128:143]
ds_read_b64_tr_b16 a[156:157], v212 offset:12288
ds_read_b64_tr_b16 a[158:159], v212 offset:13312
v_exp_f32 v49, v49
v_exp_f32 v178, v178
v_mfma_f32_32x32x16_bf16 v[144:159], a[140:143], a[72:75], v[144:159]
ds_read_b64_tr_b16 a[128:129], v215 offset:12288
ds_read_b64_tr_b16 a[130:131], v215 offset:13312
v_exp_f32 v50, v50
v_exp_f32 v179, v179
s_waitcnt lgkmcnt(6)
v_mfma_f32_32x32x16_bf16 v[160:175], a[144:147], a[72:75], v[160:175]
ds_read_b64_tr_b16 a[132:133], v218 offset:12288
ds_read_b64_tr_b16 a[134:135], v218 offset:13312
v_exp_f32 v51, v51
v_exp_f32 v180, v180
v_mfma_f32_32x32x16_bf16 v[64:79], a[148:151], a[76:79], v[64:79]
ds_read_b64_tr_b16 a[136:137], v221 offset:12288
ds_read_b64_tr_b16 a[138:139], v221 offset:13312
v_exp_f32 v52, v52
v_exp_f32 v181, v181
s_waitcnt lgkmcnt(6)
v_mfma_f32_32x32x16_bf16 v[80:95], a[152:155], a[76:79], v[80:95]
ds_read_b64_tr_b16 a[140:141], v224 offset:12288
ds_read_b64_tr_b16 a[142:143], v224 offset:13312
v_exp_f32 v53, v53
v_exp_f32 v182, v182
v_mfma_f32_32x32x16_bf16 v[96:111], a[156:159], a[76:79], v[96:111]
s_waitcnt vmcnt(17)
s_barrier
s_add_u32 s78, s88, 0x90000
s_add_u32 m0, s94, 0
ds_read_b64_tr_b16 a[144:145], v204 offset:32768
ds_read_b64_tr_b16 a[146:147], v204 offset:33792
buffer_load_dwordx4 v233, s[52:55], s78 offen lds
s_waitcnt lgkmcnt(6)
v_mfma_f32_32x32x16_bf16 v[112:127], a[128:131], a[76:79], v[112:127]
ds_read_b64_tr_b16 a[148:149], v207 offset:32768
ds_read_b64_tr_b16 a[150:151], v207 offset:33792
v_exp_f32 v54, v54
v_exp_f32 v183, v183
v_mfma_f32_32x32x16_bf16 v[128:143], a[132:135], a[76:79], v[128:143]
s_add_u32 m0, s94, 0x400
ds_read_b64_tr_b16 a[152:153], v210 offset:32768
ds_read_b64_tr_b16 a[154:155], v210 offset:33792
buffer_load_dwordx4 v234, s[52:55], s78 offen lds
s_waitcnt lgkmcnt(6)
v_mfma_f32_32x32x16_bf16 v[144:159], a[136:139], a[76:79], v[144:159]
ds_read_b64_tr_b16 a[156:157], v213 offset:32768
ds_read_b64_tr_b16 a[158:159], v213 offset:33792
v_exp_f32 v55, v55
v_add_f32 v184, v176, v177
v_mfma_f32_32x32x16_bf16 v[160:175], a[140:143], a[76:79], v[160:175]
s_add_u32 s78, s88, 0x13c000
s_add_u32 m0, s94, 0x2000
ds_read_b64_tr_b16 a[128:129], v216 offset:32768
ds_read_b64_tr_b16 a[130:131], v216 offset:33792
buffer_load_dwordx4 v233, s[52:55], s78 offen lds
s_waitcnt lgkmcnt(6)
v_mfma_f32_32x32x16_bf16 v[64:79], a[144:147], a[80:83], v[64:79]
ds_read_b64_tr_b16 a[132:133], v219 offset:32768
ds_read_b64_tr_b16 a[134:135], v219 offset:33792
v_add_f32 v185, v48, v49
v_add_f32 v184, v184, v178
v_add_f32 v185, v185, v50
v_mfma_f32_32x32x16_bf16 v[80:95], a[148:151], a[80:83], v[80:95]
s_add_u32 m0, s94, 0x2400
ds_read_b64_tr_b16 a[136:137], v222 offset:32768
ds_read_b64_tr_b16 a[138:139], v222 offset:33792
buffer_load_dwordx4 v234, s[52:55], s78 offen lds
s_waitcnt lgkmcnt(6)
v_mfma_f32_32x32x16_bf16 v[96:111], a[152:155], a[80:83], v[96:111]
ds_read_b64_tr_b16 a[140:141], v204 offset:36864
ds_read_b64_tr_b16 a[142:143], v204 offset:37888
v_add_f32 v184, v184, v179
v_add_f32 v185, v185, v51
v_add_f32 v184, v184, v180
v_mfma_f32_32x32x16_bf16 v[112:127], a[156:159], a[80:83], v[112:127]
s_add_u32 s78, s88, 0xa0000
s_add_u32 m0, s94, 0x4000
ds_read_b64_tr_b16 a[144:145], v207 offset:36864
ds_read_b64_tr_b16 a[146:147], v207 offset:37888
buffer_load_dwordx4 v233, s[52:55], s78 offen lds
s_waitcnt lgkmcnt(6)
v_mfma_f32_32x32x16_bf16 v[128:143], a[128:131], a[80:83], v[128:143]
ds_read_b64_tr_b16 a[148:149], v210 offset:36864
ds_read_b64_tr_b16 a[150:151], v210 offset:37888
v_add_f32 v185, v185, v52
v_add_f32 v184, v184, v181
v_add_f32 v185, v185, v53
v_mfma_f32_32x32x16_bf16 v[144:159], a[132:135], a[80:83], v[144:159]
s_add_u32 m0, s94, 0x4400
ds_read_b64_tr_b16 a[152:153], v213 offset:36864
ds_read_b64_tr_b16 a[154:155], v213 offset:37888
buffer_load_dwordx4 v234, s[52:55], s78 offen lds
s_waitcnt lgkmcnt(6)
v_mfma_f32_32x32x16_bf16 v[160:175], a[136:139], a[80:83], v[160:175]
ds_read_b64_tr_b16 a[156:157], v216 offset:36864
ds_read_b64_tr_b16 a[158:159], v216 offset:37888
v_add_f32 v184, v184, v182
v_add_f32 v185, v185, v54
v_add_f32 v184, v184, v183
v_mfma_f32_32x32x16_bf16 v[64:79], a[140:143], a[84:87], v[64:79]
s_add_u32 s78, s88, 0x14c000
s_add_u32 m0, s94, 0x6000
ds_read_b64_tr_b16 a[128:129], v219 offset:36864
ds_read_b64_tr_b16 a[130:131], v219 offset:37888
buffer_load_dwordx4 v233, s[52:55], s78 offen lds
s_waitcnt lgkmcnt(6)
v_mfma_f32_32x32x16_bf16 v[80:95], a[144:147], a[84:87], v[80:95]
ds_read_b64_tr_b16 a[132:133], v222 offset:36864
ds_read_b64_tr_b16 a[134:135], v222 offset:37888
v_add_f32 v185, v185, v55
v_max3_f32 v252, -v56, -v57, -v58
v_max3_f32 v251, v251, v59, v60
v_mfma_f32_32x32x16_bf16 v[96:111], a[148:151], a[84:87], v[96:111]
s_add_u32 m0, s94, 0x6400
ds_read_b64_tr_b16 a[136:137], v204 offset:40960
ds_read_b64_tr_b16 a[138:139], v204 offset:41984
buffer_load_dwordx4 v234, s[52:55], s78 offen lds
s_waitcnt lgkmcnt(6)
v_mfma_f32_32x32x16_bf16 v[112:127], a[152:155], a[84:87], v[112:127]
ds_read_b64_tr_b16 a[140:141], v207 offset:40960
ds_read_b64_tr_b16 a[142:143], v207 offset:41984
v_permlane32_swap_b32 v184, v185
v_add_f32 v186, v184, v185
v_mov_b32 v187, v186
v_mfma_f32_32x32x16_bf16 v[128:143], a[156:159], a[84:87], v[128:143]
ds_read_b64_tr_b16 a[144:145], v210 offset:40960
ds_read_b64_tr_b16 a[146:147], v210 offset:41984
v_permlane32_swap_b32 v186, v187
v_rcp_f32 v188, v186
s_waitcnt lgkmcnt(6)
v_mfma_f32_32x32x16_bf16 v[144:159], a[128:131], a[84:87], v[144:159]
ds_read_b64_tr_b16 a[148:149], v213 offset:40960
ds_read_b64_tr_b16 a[150:151], v213 offset:41984
v_rcp_f32 v189, v187
v_mul_f32 v176, v176, v188
v_mfma_f32_32x32x16_bf16 v[160:175], a[132:135], a[84:87], v[160:175]
ds_read_b64_tr_b16 a[152:153], v216 offset:40960
ds_read_b64_tr_b16 a[154:155], v216 offset:41984
v_mul_f32 v48, v48, v189
v_mul_f32 v177, v177, v188
v_mul_f32 v49, v49, v189
s_waitcnt lgkmcnt(6)
v_mfma_f32_32x32x16_bf16 v[64:79], a[136:139], a[88:91], v[64:79]
ds_read_b64_tr_b16 a[156:157], v219 offset:40960
ds_read_b64_tr_b16 a[158:159], v219 offset:41984
v_mul_f32 v178, v178, v188
v_mul_f32 v50, v50, v189
v_mul_f32 v179, v179, v188
v_mfma_f32_32x32x16_bf16 v[80:95], a[140:143], a[88:91], v[80:95]
ds_read_b64_tr_b16 a[128:129], v222 offset:40960
ds_read_b64_tr_b16 a[130:131], v222 offset:41984
v_mul_f32 v51, v51, v189
v_mul_f32 v180, v180, v188
v_mul_f32 v52, v52, v189
s_waitcnt lgkmcnt(6)
v_mfma_f32_32x32x16_bf16 v[96:111], a[144:147], a[88:91], v[96:111]
ds_read_b64_tr_b16 a[132:133], v204 offset:45056
ds_read_b64_tr_b16 a[134:135], v204 offset:46080
v_mul_f32 v181, v181, v188
v_mul_f32 v53, v53, v189
v_mul_f32 v182, v182, v188
v_mfma_f32_32x32x16_bf16 v[112:127], a[148:151], a[88:91], v[112:127]
ds_read_b64_tr_b16 a[136:137], v207 offset:45056
ds_read_b64_tr_b16 a[138:139], v207 offset:46080
v_mul_f32 v54, v54, v189
v_mul_f32 v183, v183, v188
v_mul_f32 v55, v55, v189
s_waitcnt lgkmcnt(6)
v_mfma_f32_32x32x16_bf16 v[128:143], a[152:155], a[88:91], v[128:143]
ds_read_b64_tr_b16 a[140:141], v210 offset:45056
ds_read_b64_tr_b16 a[142:143], v210 offset:46080
v_cvt_pk_bf16_f32 v48, v48, v49
v_cvt_pk_bf16_f32 v49, v50, v51
v_cvt_pk_bf16_f32 v50, v52, v53
v_mfma_f32_32x32x16_bf16 v[144:159], a[156:159], a[88:91], v[144:159]
ds_read_b64_tr_b16 a[144:145], v213 offset:45056
ds_read_b64_tr_b16 a[146:147], v213 offset:46080
v_cvt_pk_bf16_f32 v51, v54, v55
v_cvt_pk_bf16_f32 v52, v176, v177
v_cvt_pk_bf16_f32 v53, v178, v179
s_waitcnt lgkmcnt(6)
v_mfma_f32_32x32x16_bf16 v[160:175], a[128:131], a[88:91], v[160:175]
ds_read_b64_tr_b16 a[148:149], v216 offset:45056
ds_read_b64_tr_b16 a[150:151], v216 offset:46080
v_cvt_pk_bf16_f32 v54, v180, v181
v_cvt_pk_bf16_f32 v55, v182, v183
v_max3_f32 v252, v252, -v59, -v60
v_mfma_f32_32x32x16_bf16 v[64:79], a[132:135], a[92:95], v[64:79]
ds_read_b64_tr_b16 a[152:153], v219 offset:45056
ds_read_b64_tr_b16 a[154:155], v219 offset:46080
v_max3_f32 v251, v251, v61, v62
v_max3_f32 v252, v252, -v61, -v62
v_max_f32 v251, v251, v63
s_waitcnt lgkmcnt(6)
v_mfma_f32_32x32x16_bf16 v[80:95], a[136:139], a[92:95], v[80:95]
ds_read_b64_tr_b16 a[156:157], v222 offset:45056
ds_read_b64_tr_b16 a[158:159], v222 offset:46080
v_max_f32 v252, v252, -v63
v_mfma_f32_32x32x16_bf16 v[96:111], a[140:143], a[92:95], v[96:111]
s_waitcnt vmcnt(16)
s_barrier
s_add_u32 s78, s88, 0x20000
s_add_u32 m0, s94, 0x20000
ds_read_b64_tr_b16 a[128:129], v205 offset:0
ds_read_b64_tr_b16 a[130:131], v205 offset:1024
buffer_load_dwordx4 v233, s[40:43], s78 offen lds
s_waitcnt lgkmcnt(6)
v_mfma_f32_32x32x16_bf16 v[112:127], a[144:147], a[92:95], v[112:127]
ds_read_b64_tr_b16 a[132:133], v208 offset:0
ds_read_b64_tr_b16 a[134:135], v208 offset:1024
v_permlane32_swap_b32 v251, v252
v_max_f32 v5, v251, v252
v_mov_b32 v6, v5
v_mfma_f32_32x32x16_bf16 v[128:143], a[148:151], a[92:95], v[128:143]
s_add_u32 m0, s94, 0x20400
ds_read_b64_tr_b16 a[136:137], v211 offset:0
ds_read_b64_tr_b16 a[138:139], v211 offset:1024
buffer_load_dwordx4 v234, s[40:43], s78 offen lds
s_waitcnt lgkmcnt(6)
v_mfma_f32_32x32x16_bf16 v[144:159], a[152:155], a[92:95], v[144:159]
ds_read_b64_tr_b16 a[140:141], v214 offset:0
ds_read_b64_tr_b16 a[142:143], v214 offset:1024
v_permlane32_swap_b32 v5, v6
v_mul_f32 v7, v5, v3
v_mul_f32 v23, v6, v3
v_mfma_f32_32x32x16_bf16 v[160:175], a[156:159], a[92:95], v[160:175]
s_add_u32 s78, s88, 0x60000
s_add_u32 m0, s94, 0x22000
ds_read_b64_tr_b16 a[144:145], v217 offset:0
ds_read_b64_tr_b16 a[146:147], v217 offset:1024
buffer_load_dwordx4 v233, s[40:43], s78 offen lds
s_waitcnt lgkmcnt(6)
v_mfma_f32_32x32x16_bf16 v[64:79], a[128:131], a[96:99], v[64:79]
ds_read_b64_tr_b16 a[148:149], v220 offset:0
ds_read_b64_tr_b16 a[150:151], v220 offset:1024
v_fma_f32 v243, v56, v3, -v7
v_fma_f32 v56, -v56, v3, -v23
v_fma_f32 v244, v57, v3, -v7
v_mfma_f32_32x32x16_bf16 v[80:95], a[132:135], a[96:99], v[80:95]
s_add_u32 m0, s94, 0x22400
ds_read_b64_tr_b16 a[152:153], v223 offset:0
ds_read_b64_tr_b16 a[154:155], v223 offset:1024
buffer_load_dwordx4 v234, s[40:43], s78 offen lds
s_waitcnt lgkmcnt(6)
v_mfma_f32_32x32x16_bf16 v[96:111], a[136:139], a[96:99], v[96:111]
ds_read_b64_tr_b16 a[156:157], v205 offset:4096
ds_read_b64_tr_b16 a[158:159], v205 offset:5120
v_fma_f32 v57, -v57, v3, -v23
v_fma_f32 v245, v58, v3, -v7
v_fma_f32 v58, -v58, v3, -v23
v_mfma_f32_32x32x16_bf16 v[112:127], a[140:143], a[96:99], v[112:127]
s_add_u32 s78, s88, 0x30000
s_add_u32 m0, s94, 0x24000
ds_read_b64_tr_b16 a[128:129], v208 offset:4096
ds_read_b64_tr_b16 a[130:131], v208 offset:5120
buffer_load_dwordx4 v233, s[40:43], s78 offen lds
s_waitcnt lgkmcnt(6)
v_mfma_f32_32x32x16_bf16 v[128:143], a[144:147], a[96:99], v[128:143]
ds_read_b64_tr_b16 a[132:133], v211 offset:4096
ds_read_b64_tr_b16 a[134:135], v211 offset:5120
v_fma_f32 v246, v59, v3, -v7
v_fma_f32 v59, -v59, v3, -v23
v_fma_f32 v247, v60, v3, -v7
v_mfma_f32_32x32x16_bf16 v[144:159], a[148:151], a[96:99], v[144:159]
s_add_u32 m0, s94, 0x24400
ds_read_b64_tr_b16 a[136:137], v214 offset:4096
ds_read_b64_tr_b16 a[138:139], v214 offset:5120
buffer_load_dwordx4 v234, s[40:43], s78 offen lds
s_waitcnt lgkmcnt(6)
v_mfma_f32_32x32x16_bf16 v[160:175], a[152:155], a[96:99], v[160:175]
ds_read_b64_tr_b16 a[140:141], v217 offset:4096
ds_read_b64_tr_b16 a[142:143], v217 offset:5120
v_fma_f32 v60, -v60, v3, -v23
v_fma_f32 v248, v61, v3, -v7
v_fma_f32 v61, -v61, v3, -v23
v_mfma_f32_32x32x16_bf16 v[64:79], a[156:159], a[100:103], v[64:79]
s_add_u32 s78, s88, 0x70000
s_add_u32 m0, s94, 0x26000
ds_read_b64_tr_b16 a[144:145], v220 offset:4096
ds_read_b64_tr_b16 a[146:147], v220 offset:5120
buffer_load_dwordx4 v233, s[40:43], s78 offen lds
s_waitcnt lgkmcnt(6)
v_mfma_f32_32x32x16_bf16 v[80:95], a[128:131], a[100:103], v[80:95]
ds_read_b64_tr_b16 a[148:149], v223 offset:4096
ds_read_b64_tr_b16 a[150:151], v223 offset:5120
v_fma_f32 v249, v62, v3, -v7
v_fma_f32 v62, -v62, v3, -v23
v_fma_f32 v250, v63, v3, -v7
v_mfma_f32_32x32x16_bf16 v[96:111], a[132:135], a[100:103], v[96:111]
s_add_u32 m0, s94, 0x26400
ds_read_b64_tr_b16 a[152:153], v205 offset:8192
ds_read_b64_tr_b16 a[154:155], v205 offset:9216
buffer_load_dwordx4 v234, s[40:43], s78 offen lds
s_waitcnt lgkmcnt(6)
v_mfma_f32_32x32x16_bf16 v[112:127], a[136:139], a[100:103], v[112:127]
ds_read_b64_tr_b16 a[156:157], v208 offset:8192
ds_read_b64_tr_b16 a[158:159], v208 offset:9216
v_fma_f32 v63, -v63, v3, -v23
v_exp_f32 v243, v243
v_mfma_f32_32x32x16_bf16 v[128:143], a[140:143], a[100:103], v[128:143]
ds_read_b64_tr_b16 a[128:129], v211 offset:8192
ds_read_b64_tr_b16 a[130:131], v211 offset:9216
v_exp_f32 v56, v56
v_exp_f32 v244, v244
s_waitcnt lgkmcnt(6)
v_mfma_f32_32x32x16_bf16 v[144:159], a[144:147], a[100:103], v[144:159]
ds_read_b64_tr_b16 a[132:133], v214 offset:8192
ds_read_b64_tr_b16 a[134:135], v214 offset:9216
v_exp_f32 v57, v57
v_exp_f32 v245, v245
v_mfma_f32_32x32x16_bf16 v[160:175], a[148:151], a[100:103], v[160:175]
ds_read_b64_tr_b16 a[136:137], v217 offset:8192
ds_read_b64_tr_b16 a[138:139], v217 offset:9216
v_exp_f32 v58, v58
v_exp_f32 v246, v246
s_waitcnt lgkmcnt(6)
v_mfma_f32_32x32x16_bf16 v[64:79], a[152:155], a[104:107], v[64:79]
ds_read_b64_tr_b16 a[140:141], v220 offset:8192
ds_read_b64_tr_b16 a[142:143], v220 offset:9216
v_exp_f32 v59, v59
v_exp_f32 v247, v247
v_mfma_f32_32x32x16_bf16 v[80:95], a[156:159], a[104:107], v[80:95]
ds_read_b64_tr_b16 a[144:145], v223 offset:8192
ds_read_b64_tr_b16 a[146:147], v223 offset:9216
v_exp_f32 v60, v60
v_exp_f32 v248, v248
s_waitcnt lgkmcnt(6)
v_mfma_f32_32x32x16_bf16 v[96:111], a[128:131], a[104:107], v[96:111]
ds_read_b64_tr_b16 a[148:149], v205 offset:12288
ds_read_b64_tr_b16 a[150:151], v205 offset:13312
v_exp_f32 v61, v61
v_exp_f32 v249, v249
v_mfma_f32_32x32x16_bf16 v[112:127], a[132:135], a[104:107], v[112:127]
ds_read_b64_tr_b16 a[152:153], v208 offset:12288
ds_read_b64_tr_b16 a[154:155], v208 offset:13312
v_exp_f32 v62, v62
v_exp_f32 v250, v250
s_waitcnt lgkmcnt(6)
v_mfma_f32_32x32x16_bf16 v[128:143], a[136:139], a[104:107], v[128:143]
ds_read_b64_tr_b16 a[156:157], v211 offset:12288
ds_read_b64_tr_b16 a[158:159], v211 offset:13312
v_exp_f32 v63, v63
v_add_f32 v251, v243, v244
v_mfma_f32_32x32x16_bf16 v[144:159], a[140:143], a[104:107], v[144:159]
ds_read_b64_tr_b16 a[128:129], v214 offset:12288
ds_read_b64_tr_b16 a[130:131], v214 offset:13312
v_add_f32 v252, v56, v57
v_add_f32 v251, v251, v245
v_add_f32 v252, v252, v58
s_waitcnt lgkmcnt(6)
v_mfma_f32_32x32x16_bf16 v[160:175], a[144:147], a[104:107], v[160:175]
ds_read_b64_tr_b16 a[132:133], v217 offset:12288
ds_read_b64_tr_b16 a[134:135], v217 offset:13312
v_add_f32 v251, v251, v246
v_add_f32 v252, v252, v59
v_add_f32 v251, v251, v247
v_mfma_f32_32x32x16_bf16 v[64:79], a[148:151], a[108:111], v[64:79]
ds_read_b64_tr_b16 a[136:137], v220 offset:12288
ds_read_b64_tr_b16 a[138:139], v220 offset:13312
v_add_f32 v252, v252, v60
v_add_f32 v251, v251, v248
v_add_f32 v252, v252, v61
s_waitcnt lgkmcnt(6)
v_mfma_f32_32x32x16_bf16 v[80:95], a[152:155], a[108:111], v[80:95]
ds_read_b64_tr_b16 a[140:141], v223 offset:12288
ds_read_b64_tr_b16 a[142:143], v223 offset:13312
v_add_f32 v251, v251, v249
v_add_f32 v252, v252, v62
v_add_f32 v251, v251, v250
v_mfma_f32_32x32x16_bf16 v[96:111], a[156:159], a[108:111], v[96:111]
s_waitcnt vmcnt(16)
s_barrier
s_add_u32 s78, s88, 0
s_add_u32 m0, s94, 0x8000
ds_read_b64_tr_b16 a[144:145], v205 offset:32768
ds_read_b64_tr_b16 a[146:147], v205 offset:33792
buffer_load_dwordx4 v233, s[40:43], s78 offen lds
s_waitcnt lgkmcnt(6)
v_mfma_f32_32x32x16_bf16 v[112:127], a[128:131], a[108:111], v[112:127]
ds_read_b64_tr_b16 a[148:149], v208 offset:32768
ds_read_b64_tr_b16 a[150:151], v208 offset:33792
v_add_f32 v252, v252, v63
s_and_b32 s26, s69, 3
s_lshl_b32 s26, s26, 1
v_mfma_f32_32x32x16_bf16 v[128:143], a[132:135], a[108:111], v[128:143]
s_add_u32 m0, s94, 0x8400
ds_read_b64_tr_b16 a[152:153], v211 offset:32768
ds_read_b64_tr_b16 a[154:155], v211 offset:33792
buffer_load_dwordx4 v234, s[40:43], s78 offen lds
s_waitcnt lgkmcnt(6)
v_mfma_f32_32x32x16_bf16 v[144:159], a[136:139], a[108:111], v[144:159]
ds_read_b64_tr_b16 a[156:157], v214 offset:32768
ds_read_b64_tr_b16 a[158:159], v214 offset:33792
v_permlane32_swap_b32 v251, v252
v_add_f32 v5, v251, v252
v_mov_b32 v6, v5
v_mfma_f32_32x32x16_bf16 v[160:175], a[140:143], a[108:111], v[160:175]
s_add_u32 s78, s88, 0x40000
s_add_u32 m0, s94, 0xa000
ds_read_b64_tr_b16 a[128:129], v217 offset:32768
ds_read_b64_tr_b16 a[130:131], v217 offset:33792
buffer_load_dwordx4 v233, s[40:43], s78 offen lds
s_waitcnt lgkmcnt(6)
v_mfma_f32_32x32x16_bf16 v[64:79], a[144:147], a[112:115], v[64:79]
ds_read_b64_tr_b16 a[132:133], v220 offset:32768
ds_read_b64_tr_b16 a[134:135], v220 offset:33792
v_permlane32_swap_b32 v5, v6
v_rcp_f32 v7, v5
v_mfma_f32_32x32x16_bf16 v[80:95], a[148:151], a[112:115], v[80:95]
s_add_u32 m0, s94, 0xa400
ds_read_b64_tr_b16 a[136:137], v223 offset:32768
ds_read_b64_tr_b16 a[138:139], v223 offset:33792
buffer_load_dwordx4 v234, s[40:43], s78 offen lds
s_waitcnt lgkmcnt(6)
v_mfma_f32_32x32x16_bf16 v[96:111], a[152:155], a[112:115], v[96:111]
ds_read_b64_tr_b16 a[140:141], v205 offset:36864
ds_read_b64_tr_b16 a[142:143], v205 offset:37888
v_rcp_f32 v23, v6
v_mul_f32 v243, v243, v7
v_mfma_f32_32x32x16_bf16 v[112:127], a[156:159], a[112:115], v[112:127]
s_add_u32 s78, s88, 0x10000
s_add_u32 m0, s94, 0xc000
ds_read_b64_tr_b16 a[144:145], v208 offset:36864
ds_read_b64_tr_b16 a[146:147], v208 offset:37888
buffer_load_dwordx4 v233, s[40:43], s78 offen lds
s_waitcnt lgkmcnt(6)
v_mfma_f32_32x32x16_bf16 v[128:143], a[128:131], a[112:115], v[128:143]
ds_read_b64_tr_b16 a[148:149], v211 offset:36864
ds_read_b64_tr_b16 a[150:151], v211 offset:37888
v_mul_f32 v56, v56, v23
v_mul_f32 v244, v244, v7
v_mul_f32 v57, v57, v23
v_mfma_f32_32x32x16_bf16 v[144:159], a[132:135], a[112:115], v[144:159]
s_add_u32 m0, s94, 0xc400
ds_read_b64_tr_b16 a[152:153], v214 offset:36864
ds_read_b64_tr_b16 a[154:155], v214 offset:37888
buffer_load_dwordx4 v234, s[40:43], s78 offen lds
s_waitcnt lgkmcnt(6)
v_mfma_f32_32x32x16_bf16 v[160:175], a[136:139], a[112:115], v[160:175]
ds_read_b64_tr_b16 a[156:157], v217 offset:36864
ds_read_b64_tr_b16 a[158:159], v217 offset:37888
v_mul_f32 v245, v245, v7
v_mul_f32 v58, v58, v23
v_mul_f32 v246, v246, v7
v_mfma_f32_32x32x16_bf16 v[64:79], a[140:143], a[116:119], v[64:79]
s_add_u32 s78, s88, 0x50000
s_add_u32 m0, s94, 0xe000
ds_read_b64_tr_b16 a[128:129], v220 offset:36864
ds_read_b64_tr_b16 a[130:131], v220 offset:37888
buffer_load_dwordx4 v233, s[40:43], s78 offen lds
s_waitcnt lgkmcnt(6)
v_mfma_f32_32x32x16_bf16 v[80:95], a[144:147], a[116:119], v[80:95]
ds_read_b64_tr_b16 a[132:133], v223 offset:36864
ds_read_b64_tr_b16 a[134:135], v223 offset:37888
v_mul_f32 v59, v59, v23
v_mul_f32 v247, v247, v7
v_mul_f32 v60, v60, v23
v_mfma_f32_32x32x16_bf16 v[96:111], a[148:151], a[116:119], v[96:111]
s_add_u32 m0, s94, 0xe400
ds_read_b64_tr_b16 a[136:137], v205 offset:40960
ds_read_b64_tr_b16 a[138:139], v205 offset:41984
buffer_load_dwordx4 v234, s[40:43], s78 offen lds
s_waitcnt lgkmcnt(6)
v_mfma_f32_32x32x16_bf16 v[112:127], a[152:155], a[116:119], v[112:127]
ds_read_b64_tr_b16 a[140:141], v208 offset:40960
ds_read_b64_tr_b16 a[142:143], v208 offset:41984
v_mul_f32 v248, v248, v7
v_mul_f32 v61, v61, v23
v_mul_f32 v249, v249, v7
v_mfma_f32_32x32x16_bf16 v[128:143], a[156:159], a[116:119], v[128:143]
ds_read_b64_tr_b16 a[144:145], v211 offset:40960
ds_read_b64_tr_b16 a[146:147], v211 offset:41984
v_mul_f32 v62, v62, v23
v_mul_f32 v250, v250, v7
v_mul_f32 v63, v63, v23
s_waitcnt lgkmcnt(6)
v_mfma_f32_32x32x16_bf16 v[144:159], a[128:131], a[116:119], v[144:159]
ds_read_b64_tr_b16 a[148:149], v214 offset:40960
ds_read_b64_tr_b16 a[150:151], v214 offset:41984
v_cvt_pk_bf16_f32 v56, v56, v57
v_cvt_pk_bf16_f32 v57, v58, v59
v_cvt_pk_bf16_f32 v58, v60, v61
v_mfma_f32_32x32x16_bf16 v[160:175], a[132:135], a[116:119], v[160:175]
ds_read_b64_tr_b16 a[152:153], v217 offset:40960
ds_read_b64_tr_b16 a[154:155], v217 offset:41984
v_cvt_pk_bf16_f32 v59, v62, v63
v_cvt_pk_bf16_f32 v60, v243, v244
v_cvt_pk_bf16_f32 v61, v245, v246
s_waitcnt lgkmcnt(6)
v_mfma_f32_32x32x16_bf16 v[64:79], a[136:139], a[120:123], v[64:79]
ds_read_b64_tr_b16 a[156:157], v220 offset:40960
ds_read_b64_tr_b16 a[158:159], v220 offset:41984
v_cvt_pk_bf16_f32 v62, v247, v248
v_cvt_pk_bf16_f32 v63, v249, v250
s_add_u32 s26, s26, s73
v_mfma_f32_32x32x16_bf16 v[80:95], a[140:143], a[120:123], v[80:95]
ds_read_b64_tr_b16 a[128:129], v223 offset:40960
ds_read_b64_tr_b16 a[130:131], v223 offset:41984
s_cmp_ge_u32 s26, 9
s_cselect_b32 s25, 9, 0
s_sub_u32 s26, s26, s25
s_waitcnt lgkmcnt(6)
v_mfma_f32_32x32x16_bf16 v[96:111], a[144:147], a[120:123], v[96:111]
ds_read_b64_tr_b16 a[132:133], v205 offset:45056
ds_read_b64_tr_b16 a[134:135], v205 offset:46080
s_add_u32 s20, s26, 0
s_cmp_ge_u32 s20, 9
s_cselect_b32 s25, 9, 0
v_mfma_f32_32x32x16_bf16 v[112:127], a[148:151], a[120:123], v[112:127]
ds_read_b64_tr_b16 a[136:137], v208 offset:45056
ds_read_b64_tr_b16 a[138:139], v208 offset:46080
s_sub_u32 s20, s20, s25
s_lshl_b32 s25, s20, 16
s_add_u32 s4, s88, s25
s_waitcnt lgkmcnt(6)
v_mfma_f32_32x32x16_bf16 v[128:143], a[152:155], a[120:123], v[128:143]
ds_read_b64_tr_b16 a[140:141], v211 offset:45056
ds_read_b64_tr_b16 a[142:143], v211 offset:46080
s_lshl_b32 s25, s20, 12
s_add_u32 s13, s90, s25
s_add_u32 s20, s26, 1
v_mfma_f32_32x32x16_bf16 v[144:159], a[156:159], a[120:123], v[144:159]
ds_read_b64_tr_b16 a[144:145], v214 offset:45056
ds_read_b64_tr_b16 a[146:147], v214 offset:46080
s_cmp_ge_u32 s20, 9
s_cselect_b32 s25, 9, 0
s_sub_u32 s20, s20, s25
s_waitcnt lgkmcnt(6)
v_mfma_f32_32x32x16_bf16 v[160:175], a[128:131], a[120:123], v[160:175]
ds_read_b64_tr_b16 a[148:149], v217 offset:45056
ds_read_b64_tr_b16 a[150:151], v217 offset:46080
s_lshl_b32 s25, s20, 16
s_add_u32 s5, s88, s25
s_lshl_b32 s25, s20, 12
v_mfma_f32_32x32x16_bf16 v[64:79], a[132:135], a[124:127], v[64:79]
ds_read_b64_tr_b16 a[152:153], v220 offset:45056
ds_read_b64_tr_b16 a[154:155], v220 offset:46080
s_add_u32 s14, s90, s25
s_add_u32 s20, s26, 2
s_cmp_ge_u32 s20, 9
s_cselect_b32 s25, 9, 0
s_waitcnt lgkmcnt(6)
v_mfma_f32_32x32x16_bf16 v[80:95], a[136:139], a[124:127], v[80:95]
ds_read_b64_tr_b16 a[156:157], v223 offset:45056
ds_read_b64_tr_b16 a[158:159], v223 offset:46080
s_sub_u32 s20, s20, s25
s_lshl_b32 s25, s20, 16
s_add_u32 s6, s88, s25
v_mfma_f32_32x32x16_bf16 v[96:111], a[140:143], a[124:127], v[96:111]
s_lshl_b32 s25, s20, 12
s_add_u32 s15, s90, s25
s_add_u32 s20, s26, 3
s_cmp_ge_u32 s20, 9
s_cselect_b32 s25, 9, 0
s_waitcnt lgkmcnt(4)
v_mfma_f32_32x32x16_bf16 v[112:127], a[144:147], a[124:127], v[112:127]
s_sub_u32 s20, s20, s25
s_lshl_b32 s25, s20, 16
s_add_u32 s7, s88, s25
s_lshl_b32 s25, s20, 12
s_add_u32 s16, s90, s25
v_mfma_f32_32x32x16_bf16 v[128:143], a[148:151], a[124:127], v[128:143]
s_add_u32 s20, s26, 4
s_cmp_ge_u32 s20, 9
s_cselect_b32 s25, 9, 0
s_sub_u32 s20, s20, s25
s_lshl_b32 s25, s20, 16
s_waitcnt lgkmcnt(0)
v_mfma_f32_32x32x16_bf16 v[144:159], a[152:155], a[124:127], v[144:159]
s_add_u32 s8, s88, s25
s_lshl_b32 s25, s20, 12
s_add_u32 s17, s90, s25
s_add_u32 s20, s26, 5
s_cmp_ge_u32 s20, 9
s_cselect_b32 s25, 9, 0
v_mfma_f32_32x32x16_bf16 v[160:175], a[156:159], a[124:127], v[160:175]
s_sub_u32 s20, s20, s25
s_lshl_b32 s25, s20, 16
s_add_u32 s9, s88, s25
s_lshl_b32 s25, s20, 12
s_add_u32 s18, s90, s25
s_add_u32 s20, s26, 6
s_cmp_ge_u32 s20, 9
s_cselect_b32 s25, 9, 0
s_sub_u32 s20, s20, s25
s_lshl_b32 s25, s20, 16
s_add_u32 s10, s88, s25
s_lshl_b32 s25, s20, 12
s_add_u32 s19, s90, s25
s_add_u32 s20, s26, 7
s_cmp_ge_u32 s20, 9
s_cselect_b32 s25, 9, 0
s_sub_u32 s20, s20, s25
s_lshl_b32 s25, s20, 16
s_add_u32 s11, s88, s25
s_lshl_b32 s25, s20, 12
s_add_u32 s0, s90, s25
s_add_u32 s20, s26, 8
s_cmp_ge_u32 s20, 9
s_cselect_b32 s25, 9, 0
s_sub_u32 s20, s20, s25
s_lshl_b32 s25, s20, 16
s_add_u32 s12, s88, s25
s_lshl_b32 s25, s20, 12
s_add_u32 s1, s90, s25
v_readfirstlane_b32 s83, v198
s_nop 3
s_cmp_ge_u32 s83, 16
s_cbranch_scc1 L_gateok_4
s_mov_b32 s84, 0
L_poll_5:
buffer_load_dword v198, v242, s[60:63], 0 offen sc1
s_waitcnt vmcnt(0)
v_readfirstlane_b32 s81, v198
s_nop 3
s_cmp_ge_u32 s81, 16
s_cbranch_scc1 L_pdone_6
s_add_u32 s84, s84, 1
s_cmp_lt_u32 s84, 0x30d40
s_cbranch_scc1 L_poll_5
L_pdone_6:
L_gateok_4:
v_max_f32 v64, 0, v64
v_max_f32 v65, 0, v65
v_max_f32 v66, 0, v66
v_max_f32 v67, 0, v67
v_max_f32 v68, 0, v68
v_max_f32 v69, 0, v69
v_max_f32 v70, 0, v70
v_max_f32 v71, 0, v71
v_mul_f32 v64, v64, v72
v_mul_f32 v65, v65, v73
v_mul_f32 v66, v66, v74
v_mul_f32 v67, v67, v75
v_mul_f32 v68, v68, v76
v_mul_f32 v69, v69, v77
v_mul_f32 v70, v70, v78
v_mul_f32 v71, v71, v79
v_cvt_pk_bf16_f32 v190, v64, v65
v_cvt_pk_bf16_f32 v191, v66, v67
v_cvt_pk_bf16_f32 v192, v68, v69
v_cvt_pk_bf16_f32 v193, v70, v71
buffer_store_dwordx4 v[190:193], v241, s[64:67], s85 offen sc1
v_max_f32 v80, 0, v80
v_max_f32 v81, 0, v81
v_max_f32 v82, 0, v82
v_max_f32 v83, 0, v83
v_max_f32 v84, 0, v84
v_max_f32 v85, 0, v85
v_max_f32 v86, 0, v86
v_max_f32 v87, 0, v87
v_mul_f32 v80, v80, v88
v_mul_f32 v81, v81, v89
v_mul_f32 v82, v82, v90
v_mul_f32 v83, v83, v91
v_mul_f32 v84, v84, v92
v_mul_f32 v85, v85, v93
v_mul_f32 v86, v86, v94
v_mul_f32 v87, v87, v95
v_cvt_pk_bf16_f32 v194, v80, v81
v_cvt_pk_bf16_f32 v195, v82, v83
v_cvt_pk_bf16_f32 v196, v84, v85
v_cvt_pk_bf16_f32 v197, v86, v87
buffer_store_dwordx4 v[194:197], v241, s[64:67], s85 offen offset:1024 sc1
v_max_f32 v96, 0, v96
v_max_f32 v97, 0, v97
v_max_f32 v98, 0, v98
v_max_f32 v99, 0, v99
v_max_f32 v100, 0, v100
v_max_f32 v101, 0, v101
v_max_f32 v102, 0, v102
v_max_f32 v103, 0, v103
v_mul_f32 v96, v96, v104
v_mul_f32 v97, v97, v105
v_mul_f32 v98, v98, v106
v_mul_f32 v99, v99, v107
v_mul_f32 v100, v100, v108
v_mul_f32 v101, v101, v109
v_mul_f32 v102, v102, v110
v_mul_f32 v103, v103, v111
v_cvt_pk_bf16_f32 v190, v96, v97
v_cvt_pk_bf16_f32 v191, v98, v99
v_cvt_pk_bf16_f32 v192, v100, v101
v_cvt_pk_bf16_f32 v193, v102, v103
buffer_store_dwordx4 v[190:193], v241, s[64:67], s85 offen offset:2048 sc1
v_max_f32 v112, 0, v112
v_max_f32 v113, 0, v113
v_max_f32 v114, 0, v114
v_max_f32 v115, 0, v115
v_max_f32 v116, 0, v116
v_max_f32 v117, 0, v117
v_max_f32 v118, 0, v118
v_max_f32 v119, 0, v119
v_mul_f32 v112, v112, v120
v_mul_f32 v113, v113, v121
v_mul_f32 v114, v114, v122
v_mul_f32 v115, v115, v123
v_mul_f32 v116, v116, v124
v_mul_f32 v117, v117, v125
v_mul_f32 v118, v118, v126
v_mul_f32 v119, v119, v127
v_cvt_pk_bf16_f32 v194, v112, v113
v_cvt_pk_bf16_f32 v195, v114, v115
v_cvt_pk_bf16_f32 v196, v116, v117
v_cvt_pk_bf16_f32 v197, v118, v119
buffer_store_dwordx4 v[194:197], v241, s[64:67], s85 offen offset:3072 sc1
v_max_f32 v128, 0, v128
v_max_f32 v129, 0, v129
v_max_f32 v130, 0, v130
v_max_f32 v131, 0, v131
v_max_f32 v132, 0, v132
v_max_f32 v133, 0, v133
v_max_f32 v134, 0, v134
v_max_f32 v135, 0, v135
v_mul_f32 v128, v128, v136
v_mul_f32 v129, v129, v137
v_mul_f32 v130, v130, v138
v_mul_f32 v131, v131, v139
v_mul_f32 v132, v132, v140
v_mul_f32 v133, v133, v141
v_mul_f32 v134, v134, v142
v_mul_f32 v135, v135, v143
v_cvt_pk_bf16_f32 v190, v128, v129
v_cvt_pk_bf16_f32 v191, v130, v131
v_cvt_pk_bf16_f32 v192, v132, v133
v_cvt_pk_bf16_f32 v193, v134, v135
buffer_store_dwordx4 v[190:193], v241, s[64:67], s86 offen sc1
v_max_f32 v144, 0, v144
v_max_f32 v145, 0, v145
v_max_f32 v146, 0, v146
v_max_f32 v147, 0, v147
v_max_f32 v148, 0, v148
v_max_f32 v149, 0, v149
v_max_f32 v150, 0, v150
v_max_f32 v151, 0, v151
v_mul_f32 v144, v144, v152
v_mul_f32 v145, v145, v153
v_mul_f32 v146, v146, v154
v_mul_f32 v147, v147, v155
v_mul_f32 v148, v148, v156
v_mul_f32 v149, v149, v157
v_mul_f32 v150, v150, v158
v_mul_f32 v151, v151, v159
v_cvt_pk_bf16_f32 v194, v144, v145
v_cvt_pk_bf16_f32 v195, v146, v147
v_cvt_pk_bf16_f32 v196, v148, v149
v_cvt_pk_bf16_f32 v197, v150, v151
buffer_store_dwordx4 v[194:197], v241, s[64:67], s86 offen offset:1024 sc1
v_max_f32 v160, 0, v160
v_max_f32 v161, 0, v161
v_max_f32 v162, 0, v162
v_max_f32 v163, 0, v163
v_max_f32 v164, 0, v164
v_max_f32 v165, 0, v165
v_max_f32 v166, 0, v166
v_max_f32 v167, 0, v167
v_mul_f32 v160, v160, v168
v_mul_f32 v161, v161, v169
v_mul_f32 v162, v162, v170
v_mul_f32 v163, v163, v171
v_mul_f32 v164, v164, v172
v_mul_f32 v165, v165, v173
v_mul_f32 v166, v166, v174
v_mul_f32 v167, v167, v175
v_cvt_pk_bf16_f32 v190, v160, v161
v_cvt_pk_bf16_f32 v191, v162, v163
v_cvt_pk_bf16_f32 v192, v164, v165
v_cvt_pk_bf16_f32 v193, v166, v167
s_cmp_ge_u32 s70, 6
s_cbranch_scc1 L_nost_7
buffer_store_dwordx4 v[190:193], v241, s[64:67], s86 offen offset:2048 sc1
L_nost_7:
s_barrier
s_waitcnt vmcnt(0)
s_barrier
s_lshl_b32 s82, s69, 7
s_add_u32 s82, s82, 0x780000
s_cmp_lg_u32 s68, 0
s_cbranch_scc1 L_noflag_8
s_mov_b64 exec, 1
v_mov_b32 v8, 0
v_mov_b32 v9, 1
buffer_atomic_add v9, v8, s[64:67], s82 offen sc1
s_mov_b64 exec, -1
L_noflag_8:
ds_read_b64_tr_b16 v[140:141], v235 offset:0
ds_read_b64_tr_b16 v[142:143], v235 offset:1024
s_add_u32 s78, s8, 0
s_add_u32 m0, s94, 0x10000
ds_read_b64_tr_b16 v[144:145], v238 offset:0
buffer_load_dwordx4 v233, s[52:55], s78 offen lds
ds_read_b64_tr_b16 v[146:147], v238 offset:1024
ds_read_b64_tr_b16 v[148:149], v235 offset:2048
ds_read_b64_tr_b16 v[150:151], v235 offset:3072
ds_read_b64_tr_b16 v[152:153], v238 offset:2048
s_add_u32 m0, s94, 0x10400
ds_read_b64_tr_b16 v[154:155], v238 offset:3072
buffer_load_dwordx4 v234, s[52:55], s78 offen lds
ds_read_b64_tr_b16 v[156:157], v235 offset:4096
ds_read_b64_tr_b16 v[158:159], v235 offset:5120
ds_read_b64_tr_b16 v[160:161], v238 offset:4096
ds_read_b64_tr_b16 v[162:163], v238 offset:5120
s_add_u32 s78, s8, 0xac000
s_add_u32 m0, s94, 0x12000
ds_read_b64_tr_b16 v[164:165], v235 offset:6144
buffer_load_dwordx4 v233, s[52:55], s78 offen lds
ds_read_b64_tr_b16 v[166:167], v235 offset:7168
ds_read_b64_tr_b16 v[168:169], v238 offset:6144
ds_read_b64_tr_b16 v[170:171], v238 offset:7168
ds_read_b64_tr_b16 v[172:173], v235 offset:16384
s_add_u32 m0, s94, 0x12400
ds_read_b64_tr_b16 v[174:175], v235 offset:17408
buffer_load_dwordx4 v234, s[52:55], s78 offen lds
ds_read_b64_tr_b16 v[176:177], v238 offset:16384
ds_read_b64_tr_b16 v[178:179], v238 offset:17408
ds_read_b64_tr_b16 v[180:181], v235 offset:18432
ds_read_b64_tr_b16 v[182:183], v235 offset:19456
s_add_u32 s78, s9, 0
s_add_u32 m0, s94, 0x14000
ds_read_b64_tr_b16 v[184:185], v238 offset:18432
buffer_load_dwordx4 v233, s[52:55], s78 offen lds
ds_read_b64_tr_b16 v[186:187], v238 offset:19456
ds_read_b64_tr_b16 v[188:189], v235 offset:20480
ds_read_b64_tr_b16 v[190:191], v235 offset:21504
ds_read_b64_tr_b16 v[192:193], v238 offset:20480
s_add_u32 m0, s94, 0x14400
ds_read_b64_tr_b16 v[194:195], v238 offset:21504
buffer_load_dwordx4 v234, s[52:55], s78 offen lds
ds_read_b64_tr_b16 a[160:161], v235 offset:32768
ds_read_b64_tr_b16 a[162:163], v235 offset:33792
ds_read_b64_tr_b16 a[164:165], v238 offset:32768
ds_read_b64_tr_b16 a[166:167], v238 offset:33792
s_add_u32 s78, s9, 0xac000
s_add_u32 m0, s94, 0x16000
ds_read_b64_tr_b16 a[168:169], v235 offset:34816
buffer_load_dwordx4 v233, s[52:55], s78 offen lds
ds_read_b64_tr_b16 a[170:171], v235 offset:35840
ds_read_b64_tr_b16 a[172:173], v238 offset:34816
ds_read_b64_tr_b16 a[174:175], v238 offset:35840
ds_read_b64_tr_b16 a[176:177], v235 offset:36864
s_add_u32 m0, s94, 0x16400
ds_read_b64_tr_b16 a[178:179], v235 offset:37888
buffer_load_dwordx4 v234, s[52:55], s78 offen lds
ds_read_b64_tr_b16 a[180:181], v238 offset:36864
ds_read_b64_tr_b16 a[182:183], v238 offset:37888
ds_read_b64_tr_b16 a[184:185], v235 offset:38912
ds_read_b64_tr_b16 a[186:187], v235 offset:39936
s_add_u32 s78, s10, 0
s_add_u32 m0, s94, 0x18000
ds_read_b64_tr_b16 a[188:189], v238 offset:38912
buffer_load_dwordx4 v233, s[52:55], s78 offen lds
ds_read_b64_tr_b16 a[190:191], v238 offset:39936
ds_read_b64_tr_b16 a[192:193], v235 offset:49152
ds_read_b64_tr_b16 a[194:195], v235 offset:50176
ds_read_b64_tr_b16 a[196:197], v238 offset:49152
s_add_u32 m0, s94, 0x18400
ds_read_b64_tr_b16 a[198:199], v238 offset:50176
buffer_load_dwordx4 v234, s[52:55], s78 offen lds
ds_read_b64_tr_b16 a[200:201], v235 offset:51200
ds_read_b64_tr_b16 a[202:203], v235 offset:52224
ds_read_b64_tr_b16 a[204:205], v238 offset:51200
ds_read_b64_tr_b16 a[206:207], v238 offset:52224
s_add_u32 s78, s10, 0xac000
s_add_u32 m0, s94, 0x1a000
ds_read_b64_tr_b16 a[208:209], v235 offset:53248
buffer_load_dwordx4 v233, s[52:55], s78 offen lds
ds_read_b64_tr_b16 a[210:211], v235 offset:54272
ds_read_b64_tr_b16 a[212:213], v238 offset:53248
ds_read_b64_tr_b16 a[214:215], v238 offset:54272
ds_read_b64_tr_b16 a[216:217], v235 offset:55296
s_add_u32 m0, s94, 0x1a400
ds_read_b64_tr_b16 a[218:219], v235 offset:56320
buffer_load_dwordx4 v234, s[52:55], s78 offen lds
ds_read_b64_tr_b16 a[220:221], v238 offset:55296
ds_read_b64_tr_b16 a[222:223], v238 offset:56320
ds_read_b64_tr_b16 a[224:225], v237 offset:0
ds_read_b64_tr_b16 a[226:227], v237 offset:1024
s_add_u32 s78, s11, 0
s_add_u32 m0, s94, 0x1c000
ds_read_b64_tr_b16 a[228:229], v240 offset:0
buffer_load_dwordx4 v233, s[52:55], s78 offen lds
ds_read_b64_tr_b16 a[230:231], v240 offset:1024
ds_read_b64_tr_b16 a[232:233], v237 offset:2048
ds_read_b64_tr_b16 a[234:235], v237 offset:3072
ds_read_b64_tr_b16 a[236:237], v240 offset:2048
s_add_u32 m0, s94, 0x1c400
ds_read_b64_tr_b16 a[238:239], v240 offset:3072
buffer_load_dwordx4 v234, s[52:55], s78 offen lds
ds_read_b64_tr_b16 a[240:241], v237 offset:4096
ds_read_b64_tr_b16 a[242:243], v237 offset:5120
ds_read_b64_tr_b16 a[244:245], v240 offset:4096
ds_read_b64_tr_b16 a[246:247], v240 offset:5120
s_add_u32 s78, s11, 0xac000
s_add_u32 m0, s94, 0x1e000
ds_read_b64_tr_b16 a[248:249], v237 offset:6144
buffer_load_dwordx4 v233, s[52:55], s78 offen lds
ds_read_b64_tr_b16 a[250:251], v237 offset:7168
ds_read_b64_tr_b16 a[252:253], v240 offset:6144
ds_read_b64_tr_b16 a[254:255], v240 offset:7168
ds_read_b64_tr_b16 a[96:97], v237 offset:16384
s_add_u32 m0, s94, 0x1e400
ds_read_b64_tr_b16 a[98:99], v237 offset:17408
buffer_load_dwordx4 v234, s[52:55], s78 offen lds
ds_read_b64_tr_b16 a[100:101], v240 offset:16384
ds_read_b64_tr_b16 a[102:103], v240 offset:17408
ds_read_b64_tr_b16 a[104:105], v237 offset:18432
ds_read_b64_tr_b16 a[106:107], v237 offset:19456
ds_read_b64_tr_b16 a[108:109], v240 offset:18432
ds_read_b64_tr_b16 a[110:111], v240 offset:19456
ds_read_b64_tr_b16 a[112:113], v237 offset:20480
ds_read_b64_tr_b16 a[114:115], v237 offset:21504
ds_read_b64_tr_b16 a[116:117], v240 offset:20480
ds_read_b64_tr_b16 a[118:119], v240 offset:21504
ds_read_b64_tr_b16 a[120:121], v237 offset:22528
ds_read_b64_tr_b16 a[122:123], v237 offset:23552
ds_read_b64_tr_b16 a[124:125], v240 offset:22528
ds_read_b64_tr_b16 a[126:127], v240 offset:23552
s_waitcnt lgkmcnt(0)
s_lshl_b32 s82, s70, 7
s_add_u32 s82, s82, 0x781000
s_cmp_lg_u32 s68, 0
s_cbranch_scc1 L_pdone_10
s_mov_b32 s84, 0
L_poll_9:
buffer_load_dword v198, v242, s[64:67], s82 offen sc1
s_waitcnt vmcnt(0)
v_readfirstlane_b32 s81, v198
s_nop 3
s_cmp_ge_u32 s81, 16
s_cbranch_scc1 L_pdone_10
s_add_u32 s84, s84, 1
s_cmp_lt_u32 s84, 0x30d40
s_cbranch_scc1 L_poll_9
L_pdone_10:
s_barrier
s_lshl_b32 s81, s70, 2
s_add_u32 s81, s81, s68
s_lshl_b32 s81, s81, 12
s_add_u32 s81, s81, 0x760000
v_lshlrev_b32 v8, 2, v1
buffer_load_dword v64, v8, s[64:67], s81 offen sc1
buffer_load_dword v66, v8, s[64:67], s81 offen offset:256 sc1
buffer_load_dword v68, v8, s[64:67], s81 offen offset:512 sc1
buffer_load_dword v70, v8, s[64:67], s81 offen offset:768 sc1
buffer_load_dword v72, v8, s[64:67], s81 offen offset:1024 sc1
buffer_load_dword v74, v8, s[64:67], s81 offen offset:1280 sc1
buffer_load_dword v76, v8, s[64:67], s81 offen offset:1536 sc1
buffer_load_dword v78, v8, s[64:67], s81 offen offset:1792 sc1
buffer_load_dword v88, v8, s[64:67], s81 offen offset:2048 sc1
s_add_u32 s78, s4, 0
s_add_u32 m0, s94, 0
s_nop 0
buffer_load_dwordx4 v233, s[52:55], s78 offen lds
s_add_u32 m0, s94, 0x400
s_nop 0
buffer_load_dwordx4 v234, s[52:55], s78 offen lds
s_add_u32 s78, s4, 0xac000
s_add_u32 m0, s94, 0x2000
s_nop 0
buffer_load_dwordx4 v233, s[52:55], s78 offen lds
s_add_u32 m0, s94, 0x2400
s_nop 0
buffer_load_dwordx4 v234, s[52:55], s78 offen lds
s_add_u32 s78, s5, 0
s_add_u32 m0, s94, 0x4000
s_nop 0
buffer_load_dwordx4 v233, s[52:55], s78 offen lds
s_add_u32 m0, s94, 0x4400
s_nop 0
buffer_load_dwordx4 v234, s[52:55], s78 offen lds
s_waitcnt vmcnt(6)
v_mov_b32_dpp v65, v88 row_newbcast:0 row_mask:0xf bank_mask:0xf
v_mov_b32_dpp v67, v88 row_newbcast:1 row_mask:0xf bank_mask:0xf
v_mov_b32_dpp v69, v88 row_newbcast:2 row_mask:0xf bank_mask:0xf
v_mov_b32_dpp v71, v88 row_newbcast:3 row_mask:0xf bank_mask:0xf
v_mov_b32_dpp v73, v88 row_newbcast:4 row_mask:0xf bank_mask:0xf
v_mov_b32_dpp v75, v88 row_newbcast:5 row_mask:0xf bank_mask:0xf
v_mov_b32_dpp v77, v88 row_newbcast:6 row_mask:0xf bank_mask:0xf
v_mov_b32_dpp v79, v88 row_newbcast:7 row_mask:0xf bank_mask:0xf
v_permlane16_swap_b32 v64, v65
v_permlane16_swap_b32 v66, v67
v_permlane16_swap_b32 v68, v69
v_permlane16_swap_b32 v70, v71
v_permlane16_swap_b32 v72, v73
v_permlane16_swap_b32 v74, v75
v_permlane16_swap_b32 v76, v77
v_permlane16_swap_b32 v78, v79
v_cvt_pk_bf16_f32 v80, v64, v65
v_cvt_pk_bf16_f32 v81, v66, v67
v_cvt_pk_bf16_f32 v82, v68, v69
v_cvt_pk_bf16_f32 v83, v70, v71
v_cvt_pk_bf16_f32 v84, v72, v73
v_cvt_pk_bf16_f32 v85, v74, v75
v_cvt_pk_bf16_f32 v86, v76, v77
v_cvt_pk_bf16_f32 v87, v78, v79
s_lshl_b32 s82, s68, 11
v_add_u32 v9, s82, v241
v_add_u32 v9, 0x24400, v9
ds_write_b128 v9, v[80:83] offset:0
ds_write_b128 v9, v[84:87] offset:1024
s_waitcnt lgkmcnt(0)
s_barrier
v_add_u32 v10, 0x24400, v241
ds_read_b128 a[0:3], v10 offset:0
ds_read_b128 a[4:7], v10 offset:1024
ds_read_b128 a[8:11], v10 offset:2048
ds_read_b128 a[12:15], v10 offset:3072
ds_read_b128 a[16:19], v10 offset:4096
ds_read_b128 a[20:23], v10 offset:5120
ds_read_b128 a[24:27], v10 offset:6144
ds_read_b128 a[28:31], v10 offset:7168
s_lshl_b32 s81, s69, 2
s_add_u32 s81, s81, s68
s_lshl_b32 s81, s81, 5
s_lshl_b32 s82, s70, 2
s_add_u32 s81, s81, s82
s_lshl_b32 s97, s81, 10
s_add_u32 s97, s97, 0x560000
s_add_u32 s78, s5, 0xac000
s_add_u32 m0, s94, 0x6000
s_nop 0
buffer_load_dwordx4 v233, s[52:55], s78 offen lds
s_add_u32 m0, s94, 0x6400
s_nop 0
buffer_load_dwordx4 v234, s[52:55], s78 offen lds
s_waitcnt lgkmcnt(7)
v_mfma_f32_32x32x16_bf16 v[96:111], a[0:3], v[36:39], 0
s_waitcnt lgkmcnt(6)
v_mfma_f32_32x32x16_bf16 v[96:111], a[4:7], v[32:35], v[96:111]
s_waitcnt lgkmcnt(5)
v_mfma_f32_32x32x16_bf16 v[112:127], a[8:11], v[44:47], 0
s_waitcnt lgkmcnt(4)
v_mfma_f32_32x32x16_bf16 v[112:127], a[12:15], v[40:43], v[112:127]
s_nop 7
v_add_f32 v104, 0x358637bd, v104
v_rcp_f32 v104, v104
s_nop 0
v_mul_f32 v96, v96, v104
v_mul_f32 v97, v97, v104
v_mul_f32 v98, v98, v104
v_mul_f32 v99, v99, v104
v_mul_f32 v100, v100, v104
v_mul_f32 v101, v101, v104
v_mul_f32 v102, v102, v104
v_mul_f32 v103, v103, v104
v_cvt_pk_bf16_f32 v128, v96, v97
v_cvt_pk_bf16_f32 v129, v98, v99
v_cvt_pk_bf16_f32 v130, v100, v101
v_cvt_pk_bf16_f32 v131, v102, v103
s_waitcnt lgkmcnt(3)
v_mfma_f32_32x32x16_bf16 v[96:111], a[16:19], v[52:55], 0
s_waitcnt lgkmcnt(2)
v_mfma_f32_32x32x16_bf16 v[96:111], a[20:23], v[48:51], v[96:111]
s_lshl_b32 s82, s69, 7
s_add_u32 s82, s82, 0x780000
buffer_load_dword v199, v242, s[64:67], s82 offen sc1
buffer_store_dwordx4 v[128:131], v241, s[64:67], s97 offen sc1
v_add_f32 v120, 0x358637bd, v120
v_rcp_f32 v120, v120
s_nop 0
v_mul_f32 v112, v112, v120
v_mul_f32 v113, v113, v120
v_mul_f32 v114, v114, v120
v_mul_f32 v115, v115, v120
v_mul_f32 v116, v116, v120
v_mul_f32 v117, v117, v120
v_mul_f32 v118, v118, v120
v_mul_f32 v119, v119, v120
v_cvt_pk_bf16_f32 v132, v112, v113
v_cvt_pk_bf16_f32 v133, v114, v115
v_cvt_pk_bf16_f32 v134, v116, v117
v_cvt_pk_bf16_f32 v135, v118, v119
s_waitcnt lgkmcnt(1)
v_mfma_f32_32x32x16_bf16 v[112:127], a[24:27], v[60:63], 0
s_waitcnt lgkmcnt(0)
v_mfma_f32_32x32x16_bf16 v[112:127], a[28:31], v[56:59], v[112:127]
buffer_store_dwordx4 v[132:135], v241, s[64:67], s97 offen offset:1024 sc1
v_add_f32 v104, 0x358637bd, v104
v_rcp_f32 v104, v104
s_nop 0
v_mul_f32 v96, v96, v104
v_mul_f32 v97, v97, v104
v_mul_f32 v98, v98, v104
v_mul_f32 v99, v99, v104
v_mul_f32 v100, v100, v104
v_mul_f32 v101, v101, v104
v_mul_f32 v102, v102, v104
v_mul_f32 v103, v103, v104
v_cvt_pk_bf16_f32 v128, v96, v97
v_cvt_pk_bf16_f32 v129, v98, v99
v_cvt_pk_bf16_f32 v130, v100, v101
v_cvt_pk_bf16_f32 v131, v102, v103
buffer_store_dwordx4 v[128:131], v241, s[64:67], s97 offen offset:2048 sc1
v_add_f32 v120, 0x358637bd, v120
v_rcp_f32 v120, v120
s_nop 0
v_mul_f32 v112, v112, v120
v_mul_f32 v113, v113, v120
v_mul_f32 v114, v114, v120
v_mul_f32 v115, v115, v120
v_mul_f32 v116, v116, v120
v_mul_f32 v117, v117, v120
v_mul_f32 v118, v118, v120
v_mul_f32 v119, v119, v120
v_cvt_pk_bf16_f32 v132, v112, v113
v_cvt_pk_bf16_f32 v133, v114, v115
v_cvt_pk_bf16_f32 v134, v116, v117
v_cvt_pk_bf16_f32 v135, v118, v119
buffer_store_dwordx4 v[132:135], v241, s[64:67], s97 offen offset:3072 sc1
s_branch L_p2
L_kvpath:
s_add_u32 s3, s75, s0
s_add_u32 m0, s99, 0
s_nop 0
buffer_load_dwordx4 v4, s[28:31], s3 offen lds
v_and_b32 v8, 31, v1
v_lshrrev_b32 v9, 5, v1
v_and_b32 v10, 15, v8
v_lshlrev_b32 v11, 8, v8
v_add_u32 v11, s99, v11
v_add_u32 v12, 0, v9
v_xor_b32 v12, v12, v10
v_lshlrev_b32 v12, 4, v12
v_add_u32 v24, v11, v12
s_add_u32 m0, s99, 0x400
v_add_u32 v12, 2, v9
buffer_load_dwordx4 v5, s[28:31], s3 offen lds
v_xor_b32 v12, v12, v10
v_lshlrev_b32 v12, 4, v12
v_add_u32 v25, v11, v12
v_add_u32 v12, 4, v9
v_xor_b32 v12, v12, v10
v_lshlrev_b32 v12, 4, v12
v_add_u32 v26, v11, v12
v_add_u32 v12, 6, v9
s_add_u32 m0, s99, 0x800
v_xor_b32 v12, v12, v10
buffer_load_dwordx4 v6, s[28:31], s3 offen lds
v_lshlrev_b32 v12, 4, v12
v_add_u32 v27, v11, v12
v_add_u32 v12, 8, v9
v_xor_b32 v12, v12, v10
v_lshlrev_b32 v12, 4, v12
v_add_u32 v28, v11, v12
v_add_u32 v12, 10, v9
v_xor_b32 v12, v12, v10
s_add_u32 m0, s99, 0xc00
v_lshlrev_b32 v12, 4, v12
buffer_load_dwordx4 v7, s[28:31], s3 offen lds
v_add_u32 v29, v11, v12
v_add_u32 v12, 12, v9
v_xor_b32 v12, v12, v10
v_lshlrev_b32 v12, 4, v12
v_add_u32 v30, v11, v12
v_add_u32 v12, 14, v9
v_xor_b32 v12, v12, v10
v_lshlrev_b32 v12, 4, v12
s_add_u32 s3, s76, s0
s_add_u32 m0, s99, 0x1000
v_add_u32 v31, v11, v12
buffer_load_dwordx4 v4, s[28:31], s3 offen lds
v_mov_b32 v32, 0x3f803f80
s_mov_b32 s32, s6
s_mov_b32 s33, s7
s_mov_b32 s34, 0x180000
s_mov_b32 s35, 0x20000
s_lshl_b32 s82, s70, 7
s_cmp_eq_u32 s71, 0
s_cselect_b32 s83, 0x400, 0
s_add_u32 m0, s99, 0x1400
s_nop 0
buffer_load_dwordx4 v5, s[28:31], s3 offen lds
s_add_u32 s79, s82, s83
s_add_u32 s87, s82, 0x800
v_lshrrev_b32 v8, 3, v1
v_and_b32 v9, 7, v1
v_bfe_u32 v10, v8, 1, 1
v_lshlrev_b32 v10, 2, v10
v_xor_b32 v10, v10, v9
v_lshlrev_b32 v10, 4, v10
s_lshl_b32 s82, s68, 3
s_add_u32 m0, s99, 0x1800
v_add_u32 v11, s82, v8
buffer_load_dwordx4 v6, s[28:31], s3 offen lds
s_mov_b32 s83, 0xc00
v_mul_lo_u32 v11, v11, s83
v_add_u32 v20, v10, v11
v_add_u32 v21, 0x18000, v20
s_mov_b32 s64, s24
s_mov_b32 s65, s25
s_mov_b32 s66, 0x782000
s_mov_b32 s67, 0x20000
s_add_u32 m0, s99, 0x1c00
s_nop 0
buffer_load_dwordx4 v7, s[28:31], s3 offen lds
s_mov_b32 s36, s8
s_mov_b32 s37, s9
s_mov_b32 s38, 0x4000
s_mov_b32 s39, 0x20000
s_mov_b32 s40, s10
s_mov_b32 s41, s11
s_mov_b32 s42, 0x80000
s_mov_b32 s43, 0x20000
s_mov_b32 s44, s14
s_add_u32 s3, s75, s1
s_add_u32 m0, s99, 0x2000
s_nop 0
buffer_load_dwordx4 v4, s[28:31], s3 offen lds
s_mov_b32 s45, s15
s_mov_b32 s46, 0x158000
s_mov_b32 s47, 0x20000
s_mov_b32 s48, s16
s_mov_b32 s49, s17
s_mov_b32 s50, 0x158000
s_mov_b32 s51, 0x20000
s_mov_b32 s52, s18
s_mov_b32 s53, s19
s_add_u32 m0, s99, 0x2400
s_nop 0
buffer_load_dwordx4 v5, s[28:31], s3 offen lds
s_mov_b32 s54, 0x158000
s_mov_b32 s55, 0x20000
s_mov_b32 s56, s20
s_mov_b32 s57, s21
s_mov_b32 s58, 0x200000
s_mov_b32 s59, 0x20000
s_mov_b32 s60, s22
s_mov_b32 s61, s23
s_mov_b32 s62, 0x100
s_add_u32 m0, s99, 0x2800
s_nop 0
buffer_load_dwordx4 v6, s[28:31], s3 offen lds
s_mov_b32 s63, 0x20000
v_lshlrev_b32 v22, 4, v1
s_lshl_b32 s81, s26, 1
s_add_u32 s81, s81, 0
s_and_b32 s81, s81, 7
s_mul_i32 s4, s81, 0x30000
s_mul_i32 s12, s81, 0x2b000
s_lshl_b32 s81, s26, 1
s_add_u32 s81, s81, 1
s_add_u32 m0, s99, 0x2c00
s_nop 0
buffer_load_dwordx4 v7, s[28:31], s3 offen lds
s_and_b32 s81, s81, 7
s_mul_i32 s5, s81, 0x30000
s_mul_i32 s13, s81, 0x2b000
s_lshl_b32 s81, s26, 1
s_add_u32 s81, s81, 2
s_and_b32 s81, s81, 7
s_mul_i32 s6, s81, 0x30000
s_mul_i32 s14, s81, 0x2b000
s_lshl_b32 s81, s26, 1
s_add_u32 s3, s76, s1
s_add_u32 m0, s99, 0x3000
s_nop 0
buffer_load_dwordx4 v4, s[28:31], s3 offen lds
s_add_u32 s81, s81, 3
s_and_b32 s81, s81, 7
s_mul_i32 s7, s81, 0x30000
s_mul_i32 s15, s81, 0x2b000
s_lshl_b32 s81, s26, 1
s_add_u32 s81, s81, 4
s_and_b32 s81, s81, 7
s_mul_i32 s8, s81, 0x30000
s_mul_i32 s16, s81, 0x2b000
s_add_u32 m0, s99, 0x3400
s_nop 0
buffer_load_dwordx4 v5, s[28:31], s3 offen lds
s_lshl_b32 s81, s26, 1
s_add_u32 s81, s81, 5
s_and_b32 s81, s81, 7
s_mul_i32 s9, s81, 0x30000
s_mul_i32 s17, s81, 0x2b000
s_lshl_b32 s81, s26, 1
s_add_u32 s81, s81, 6
s_and_b32 s81, s81, 7
s_mul_i32 s10, s81, 0x30000
s_add_u32 m0, s99, 0x3800
s_nop 0
buffer_load_dwordx4 v6, s[28:31], s3 offen lds
s_mul_i32 s18, s81, 0x2b000
s_lshl_b32 s81, s26, 1
s_add_u32 s81, s81, 7
s_and_b32 s81, s81, 7
s_mul_i32 s11, s81, 0x30000
s_mul_i32 s19, s81, 0x2b000
v_and_b32 v8, 31, v1
v_lshrrev_b32 v9, 5, v1
v_lshlrev_b32 v12, 2, v9
s_add_u32 m0, s99, 0x3c00
v_sub_u32 v12, v8, v12
buffer_load_dwordx4 v7, s[28:31], s3 offen lds
v_mov_b32 v14, 0x3f80
v_mov_b32 v15, 0x3f800000
v_cmp_eq_u32 vcc, 0, v12
s_nop 1
v_cndmask_b32 v36, 0, v14, vcc
v_cmp_eq_u32 vcc, 1, v12
s_nop 1
v_cndmask_b32 v36, v36, v15, vcc
v_cmp_eq_u32 vcc, 2, v12
s_nop 1
v_cndmask_b32 v37, 0, v14, vcc
s_add_u32 s3, s75, s100
s_add_u32 m0, s99, 0x4000
v_cmp_eq_u32 vcc, 3, v12
buffer_load_dwordx4 v4, s[28:31], s3 offen lds
s_nop 0
v_cndmask_b32 v37, v37, v15, vcc
v_cmp_eq_u32 vcc, 8, v12
s_nop 1
v_cndmask_b32 v38, 0, v14, vcc
v_cmp_eq_u32 vcc, 9, v12
s_nop 1
v_cndmask_b32 v38, v38, v15, vcc
v_cmp_eq_u32 vcc, 10, v12
s_nop 1
v_cndmask_b32 v39, 0, v14, vcc
v_cmp_eq_u32 vcc, 11, v12
s_add_u32 m0, s99, 0x4400
s_nop 0
v_cndmask_b32 v39, v39, v15, vcc
buffer_load_dwordx4 v5, s[28:31], s3 offen lds
v_cmp_eq_u32 vcc, 16, v12
s_nop 1
v_cndmask_b32 v40, 0, v14, vcc
v_cmp_eq_u32 vcc, 17, v12
s_nop 1
v_cndmask_b32 v40, v40, v15, vcc
v_cmp_eq_u32 vcc, 18, v12
s_nop 1
v_cndmask_b32 v41, 0, v14, vcc
v_cmp_eq_u32 vcc, 19, v12
s_nop 1
v_cndmask_b32 v41, v41, v15, vcc
s_add_u32 m0, s99, 0x4800
v_cmp_eq_u32 vcc, 24, v12
buffer_load_dwordx4 v6, s[28:31], s3 offen lds
s_nop 0
v_cndmask_b32 v42, 0, v14, vcc
v_cmp_eq_u32 vcc, 25, v12
s_nop 1
v_cndmask_b32 v42, v42, v15, vcc
v_cmp_eq_u32 vcc, 26, v12
s_nop 1
v_cndmask_b32 v43, 0, v14, vcc
v_cmp_eq_u32 vcc, 27, v12
s_nop 1
v_cndmask_b32 v43, v43, v15, vcc
v_mov_b32 v44, 0
s_add_u32 m0, s99, 0x4c00
v_mov_b32 v45, 0
buffer_load_dwordx4 v7, s[28:31], s3 offen lds
v_mov_b32 v46, 0
v_mov_b32 v47, 0
v_add_u32 v13, 0x26800, v22
ds_write_b128 v13, v[44:47] offset:0
ds_write_b128 v13, v[44:47] offset:1024
s_lshl_b32 s80, s70, 7
s_lshl_b32 s82, s69, 2
s_add_u32 s82, s82, s68
s_add_u32 s3, s76, s100
s_add_u32 m0, s99, 0x5000
s_nop 0
buffer_load_dwordx4 v4, s[28:31], s3 offen lds
s_mul_i32 s82, s82, 0x56
s_lshl_b32 s81, s70, 2
s_add_u32 s82, s82, s81
s_lshl_b32 s85, s82, 10
v_lshrrev_b32 v8, 3, v1
v_and_b32 v9, 7, v1
v_bfe_u32 v10, v8, 1, 1
v_lshlrev_b32 v10, 1, v10
v_xor_b32 v9, v9, v10
s_add_u32 m0, s99, 0x5400
s_nop 0
buffer_load_dwordx4 v5, s[28:31], s3 offen lds
s_lshl_b32 s81, s68, 3
v_add_u32 v11, s81, v8
s_mov_b32 s82, 0xac0
v_mul_lo_u32 v11, v11, s82
v_xor_b32 v10, 0, v9
v_lshlrev_b32 v10, 4, v10
v_add_u32 v214, v10, v11
v_add_u32 v215, 0x15800, v214
v_xor_b32 v10, 4, v9
s_add_u32 m0, s99, 0x5800
v_lshlrev_b32 v10, 4, v10
buffer_load_dwordx4 v6, s[28:31], s3 offen lds
v_add_u32 v216, v10, v11
v_add_u32 v217, 0x15800, v216
v_and_b32 v12, 15, v1
v_lshrrev_b32 v8, 2, v12
v_and_b32 v9, 3, v12
v_bfe_u32 v10, v1, 4, 1
v_lshrrev_b32 v11, 5, v1
v_lshrrev_b32 v12, 1, v9
s_add_u32 m0, s99, 0x5c00
v_lshlrev_b32 v12, 4, v12
buffer_load_dwordx4 v7, s[28:31], s3 offen lds
v_and_b32 v14, 1, v9
v_lshlrev_b32 v14, 3, v14
v_add_u32 v12, v12, v14
v_lshlrev_b32 v14, 5, v10
v_add_u32 v12, v12, v14
v_mul_u32_u24 v14, 8, v11
v_add_u32 v14, v14, v8
v_lshlrev_b32 v14, 7, v14
s_add_u32 s3, s75, s101
s_add_u32 m0, s99, 0x6000
v_add_u32 v12, v12, v14
buffer_load_dwordx4 v4, s[28:31], s3 offen lds
v_bfe_u32 v13, v8, 1, 1
v_xor_b32 v14, 0, v13
v_lshlrev_b32 v14, 6, v14
v_add_u32 v200, v12, v14
v_add_u32 v201, 0x10000, v200
v_add_u32 v202, 0x20000, v200
v_xor_b32 v14, 1, v13
v_lshlrev_b32 v14, 6, v14
s_add_u32 m0, s99, 0x6400
v_add_u32 v203, v12, v14
buffer_load_dwordx4 v5, s[28:31], s3 offen lds
v_add_u32 v204, 0x10000, v203
v_add_u32 v205, 0x20000, v203
v_lshlrev_b32 v13, 2, v11
v_add_u32 v13, v13, v8
v_lshlrev_b32 v13, 5, v13
v_lshlrev_b32 v14, 3, v9
v_add_u32 v13, v13, v14
v_add_u32 v13, 0x26000, v13
s_add_u32 m0, s99, 0x6800
v_mov_b32 v15, 0x26800
buffer_load_dwordx4 v6, s[28:31], s3 offen lds
v_cmp_eq_u32 vcc, 0, v10
s_nop 1
v_cndmask_b32 v18, v15, v13, vcc
v_cmp_eq_u32 vcc, 1, v10
s_nop 1
v_cndmask_b32 v19, v15, v13, vcc
v_mov_b32 v242, 0
v_lshlrev_b32 v241, 4, v1
s_waitcnt vmcnt(19)
ds_read_b128 v[64:67], v24 offset:0
s_add_u32 m0, s99, 0x6c00
ds_read_b128 v[68:71], v25 offset:0
buffer_load_dwordx4 v7, s[28:31], s3 offen lds
ds_read_b128 v[72:75], v26 offset:0
ds_read_b128 v[76:79], v27 offset:0
ds_read_b128 v[80:83], v28 offset:0
ds_read_b128 v[84:87], v29 offset:0
ds_read_b128 v[88:91], v30 offset:0
ds_read_b128 v[92:95], v31 offset:0
ds_read_b128 a[0:3], v24 offset:0
ds_read_b128 a[4:7], v25 offset:0
s_add_u32 s3, s76, s101
s_add_u32 m0, s99, 0x7000
ds_read_b128 a[8:11], v26 offset:0
buffer_load_dwordx4 v4, s[28:31], s3 offen lds
ds_read_b128 a[12:15], v27 offset:0
ds_read_b128 a[16:19], v28 offset:0
ds_read_b128 a[20:23], v29 offset:0
ds_read_b128 a[24:27], v30 offset:0
ds_read_b128 a[28:31], v31 offset:0
s_waitcnt vmcnt(13)
ds_read_b128 v[96:99], v24 offset:8192
ds_read_b128 v[100:103], v25 offset:8192
s_add_u32 m0, s99, 0x7400
ds_read_b128 v[104:107], v26 offset:8192
buffer_load_dwordx4 v5, s[28:31], s3 offen lds
ds_read_b128 v[108:111], v27 offset:8192
ds_read_b128 v[112:115], v28 offset:8192
ds_read_b128 v[116:119], v29 offset:8192
ds_read_b128 v[120:123], v30 offset:8192
ds_read_b128 v[124:127], v31 offset:8192
ds_read_b128 a[32:35], v24 offset:8192
ds_read_b128 a[36:39], v25 offset:8192
ds_read_b128 a[40:43], v26 offset:8192
s_add_u32 m0, s99, 0x7800
ds_read_b128 a[44:47], v27 offset:8192
buffer_load_dwordx4 v6, s[28:31], s3 offen lds
ds_read_b128 a[48:51], v28 offset:8192
ds_read_b128 a[52:55], v29 offset:8192
ds_read_b128 a[56:59], v30 offset:8192
ds_read_b128 a[60:63], v31 offset:8192
s_waitcnt lgkmcnt(15)
v_dot2c_f32_bf16 v44, v32, v64
v_dot2c_f32_bf16 v46, v64, v64
v_dot2c_f32_bf16 v45, v32, v65
v_dot2c_f32_bf16 v47, v65, v65
s_add_u32 m0, s99, 0x7c00
v_dot2c_f32_bf16 v44, v32, v66
buffer_load_dwordx4 v7, s[28:31], s3 offen lds
v_dot2c_f32_bf16 v46, v66, v66
v_dot2c_f32_bf16 v45, v32, v67
v_dot2c_f32_bf16 v47, v67, v67
v_dot2c_f32_bf16 v44, v32, v68
v_dot2c_f32_bf16 v46, v68, v68
v_dot2c_f32_bf16 v45, v32, v69
v_dot2c_f32_bf16 v47, v69, v69
v_dot2c_f32_bf16 v44, v32, v70
s_cmp_ge_u32 s2, 16
s_cbranch_scc1 L_nozero_11
v_mov_b32 v128, 0
v_mov_b32 v129, 0
v_mov_b32 v130, 0
v_mov_b32 v131, 0
s_lshl_b32 s100, s2, 13
s_lshl_b32 s101, s68, 11
s_add_u32 s100, s100, s101
s_add_u32 s100, s100, 0x760000
buffer_store_dwordx4 v[128:131], v22, s[64:67], s100 offen sc1
buffer_store_dwordx4 v[128:131], v22, s[64:67], s100 offen offset:1024 sc1
v_lshrrev_b32 v132, 3, v1
v_min_u32 v132, 2, v132
v_lshlrev_b32 v132, 11, v132
v_and_b32 v133, 7, v1
v_lshlrev_b32 v133, 4, v133
v_add_u32 v132, v132, v133
s_lshl_b32 s101, s2, 7
s_add_u32 s101, s101, 0x780000
buffer_store_dwordx4 v[128:131], v132, s[64:67], s101 offen sc1
L_nozero_11:
v_dot2c_f32_bf16 v46, v70, v70
v_dot2c_f32_bf16 v45, v32, v71
v_dot2c_f32_bf16 v47, v71, v71
v_dot2c_f32_bf16 v44, v32, v72
v_dot2c_f32_bf16 v46, v72, v72
v_dot2c_f32_bf16 v45, v32, v73
v_dot2c_f32_bf16 v47, v73, v73
v_dot2c_f32_bf16 v44, v32, v74
v_dot2c_f32_bf16 v46, v74, v74
s_add_u32 s77, s79, s4
s_add_u32 m0, s74, 0x20000
v_dot2c_f32_bf16 v45, v32, v75
buffer_load_dwordx4 v20, s[32:35], s77 offen lds
v_dot2c_f32_bf16 v47, v75, v75
v_dot2c_f32_bf16 v44, v32, v76
v_dot2c_f32_bf16 v46, v76, v76
v_dot2c_f32_bf16 v45, v32, v77
v_dot2c_f32_bf16 v47, v77, v77
v_dot2c_f32_bf16 v44, v32, v78
v_dot2c_f32_bf16 v46, v78, v78
v_dot2c_f32_bf16 v45, v32, v79
s_add_u32 m0, s74, 0x21000
v_dot2c_f32_bf16 v47, v79, v79
buffer_load_dwordx4 v21, s[32:35], s77 offen lds
v_dot2c_f32_bf16 v44, v32, v80
v_dot2c_f32_bf16 v46, v80, v80
v_dot2c_f32_bf16 v45, v32, v81
v_dot2c_f32_bf16 v47, v81, v81
v_dot2c_f32_bf16 v44, v32, v82
v_dot2c_f32_bf16 v46, v82, v82
v_dot2c_f32_bf16 v45, v32, v83
v_dot2c_f32_bf16 v47, v83, v83
s_add_u32 s77, s79, s5
s_add_u32 m0, s74, 0x22000
v_dot2c_f32_bf16 v44, v32, v84
buffer_load_dwordx4 v20, s[32:35], s77 offen lds
v_dot2c_f32_bf16 v46, v84, v84
v_dot2c_f32_bf16 v45, v32, v85
v_dot2c_f32_bf16 v47, v85, v85
v_dot2c_f32_bf16 v44, v32, v86
v_dot2c_f32_bf16 v46, v86, v86
v_dot2c_f32_bf16 v45, v32, v87
v_dot2c_f32_bf16 v47, v87, v87
v_dot2c_f32_bf16 v44, v32, v88
s_add_u32 m0, s74, 0x23000
v_dot2c_f32_bf16 v46, v88, v88
buffer_load_dwordx4 v21, s[32:35], s77 offen lds
v_dot2c_f32_bf16 v45, v32, v89
v_dot2c_f32_bf16 v47, v89, v89
v_dot2c_f32_bf16 v44, v32, v90
v_dot2c_f32_bf16 v46, v90, v90
v_dot2c_f32_bf16 v45, v32, v91
v_dot2c_f32_bf16 v47, v91, v91
v_dot2c_f32_bf16 v44, v32, v92
v_dot2c_f32_bf16 v46, v92, v92
s_add_u32 s77, s79, s6
s_add_u32 m0, s74, 0x24000
v_dot2c_f32_bf16 v45, v32, v93
buffer_load_dwordx4 v20, s[32:35], s77 offen lds
v_dot2c_f32_bf16 v47, v93, v93
v_dot2c_f32_bf16 v44, v32, v94
v_dot2c_f32_bf16 v46, v94, v94
v_dot2c_f32_bf16 v45, v32, v95
v_dot2c_f32_bf16 v47, v95, v95
s_waitcnt vmcnt(13)
ds_read_b128 v[64:67], v24 offset:16384
ds_read_b128 v[68:71], v25 offset:16384
s_add_u32 m0, s74, 0x25000
ds_read_b128 v[72:75], v26 offset:16384
buffer_load_dwordx4 v21, s[32:35], s77 offen lds
ds_read_b128 v[76:79], v27 offset:16384
ds_read_b128 v[80:83], v28 offset:16384
ds_read_b128 v[84:87], v29 offset:16384
ds_read_b128 v[88:91], v30 offset:16384
ds_read_b128 v[92:95], v31 offset:16384
ds_read_b128 a[64:67], v24 offset:16384
ds_read_b128 a[68:71], v25 offset:16384
ds_read_b128 a[72:75], v26 offset:16384
s_and_b32 s3, s68, 1
s_lshl_b32 s3, s3, 10
s_lshl_b32 s98, s70, 11
s_add_u32 s98, s98, s3
s_add_u32 m0, s3, 0x26000
ds_read_b128 a[76:79], v27 offset:16384
buffer_load_dwordx4 v22, s[36:39], s98 offen lds
ds_read_b128 a[80:83], v28 offset:16384
ds_read_b128 a[84:87], v29 offset:16384
ds_read_b128 a[88:91], v30 offset:16384
ds_read_b128 a[92:95], v31 offset:16384
v_dot2c_f32_bf16 v44, v32, v96
v_dot2c_f32_bf16 v46, v96, v96
v_dot2c_f32_bf16 v45, v32, v97
v_dot2c_f32_bf16 v47, v97, v97
s_lshl_b32 s0, s2, 2
s_add_u32 s0, s0, s68
s_mul_i32 s1, s0, 0x580
v_min_u32 v134, 10, v1
v_lshlrev_b32 v134, 7, v134
buffer_load_dword v255, v134, s[44:47], s1 offen
v_dot2c_f32_bf16 v44, v32, v98
v_dot2c_f32_bf16 v46, v98, v98
v_dot2c_f32_bf16 v45, v32, v99
v_dot2c_f32_bf16 v47, v99, v99
s_waitcnt lgkmcnt(15)
v_dot2c_f32_bf16 v44, v32, v100
v_dot2c_f32_bf16 v46, v100, v100
v_dot2c_f32_bf16 v45, v32, v101
v_dot2c_f32_bf16 v47, v101, v101
v_dot2c_f32_bf16 v44, v32, v102
s_mul_i32 s1, s0, 0x580
v_min_u32 v134, 10, v1
v_lshlrev_b32 v134, 7, v134
buffer_load_dword v255, v134, s[48:51], s1 offen
v_dot2c_f32_bf16 v46, v102, v102
v_dot2c_f32_bf16 v45, v32, v103
v_dot2c_f32_bf16 v47, v103, v103
v_dot2c_f32_bf16 v44, v32, v104
v_dot2c_f32_bf16 v46, v104, v104
v_dot2c_f32_bf16 v45, v32, v105
v_dot2c_f32_bf16 v47, v105, v105
v_dot2c_f32_bf16 v44, v32, v106
v_dot2c_f32_bf16 v46, v106, v106
s_mul_i32 s1, s0, 0x600
v_min_u32 v134, 11, v1
v_lshlrev_b32 v134, 7, v134
buffer_load_dword v255, v134, s[32:35], s1 offen
v_dot2c_f32_bf16 v45, v32, v107
v_dot2c_f32_bf16 v47, v107, v107
v_dot2c_f32_bf16 v44, v32, v108
v_dot2c_f32_bf16 v46, v108, v108
v_dot2c_f32_bf16 v45, v32, v109
v_dot2c_f32_bf16 v47, v109, v109
v_dot2c_f32_bf16 v44, v32, v110
v_dot2c_f32_bf16 v46, v110, v110
v_dot2c_f32_bf16 v45, v32, v111
s_mul_i32 s1, s0, 0x580
v_min_u32 v134, 10, v1
v_lshlrev_b32 v134, 7, v134
buffer_load_dword v255, v134, s[52:55], s1 offen
v_dot2c_f32_bf16 v47, v111, v111
v_dot2c_f32_bf16 v44, v32, v112
v_dot2c_f32_bf16 v46, v112, v112
v_dot2c_f32_bf16 v45, v32, v113
v_dot2c_f32_bf16 v47, v113, v113
v_dot2c_f32_bf16 v44, v32, v114
v_dot2c_f32_bf16 v46, v114, v114
v_dot2c_f32_bf16 v45, v32, v115
v_dot2c_f32_bf16 v47, v115, v115
s_mul_i32 s1, s0, 0x200
v_min_u32 v134, 3, v1
v_lshlrev_b32 v134, 7, v134
buffer_load_dword v255, v134, s[40:43], s1 offen
v_dot2c_f32_bf16 v44, v32, v116
v_dot2c_f32_bf16 v46, v116, v116
v_dot2c_f32_bf16 v45, v32, v117
v_dot2c_f32_bf16 v47, v117, v117
v_dot2c_f32_bf16 v44, v32, v118
v_dot2c_f32_bf16 v46, v118, v118
v_dot2c_f32_bf16 v45, v32, v119
v_dot2c_f32_bf16 v47, v119, v119
v_dot2c_f32_bf16 v44, v32, v120
s_getpc_b64 s[100:101]
L_pc_12:
s_sub_u32 s100, s100, L_pc_12-recurrent_scan__linear_kernel_hedgehog__glu_gated_reglu__prompt_kernel
s_subb_u32 s101, s101, 0
s_lshr_b32 s98, s2, 3
s_lshl_b32 s98, s98, 11
v_lshlrev_b32 v23, 3, v0
v_add_u32 v23, s98, v23
s_mov_b32 s98, L_codeend-recurrent_scan__linear_kernel_hedgehog__glu_gated_reglu__prompt_kernel-8
v_min_u32 v23, s98, v23
global_load_dwordx2 v[254:255], v23, s[100:101]
v_dot2c_f32_bf16 v46, v120, v120
v_dot2c_f32_bf16 v45, v32, v121
v_dot2c_f32_bf16 v47, v121, v121
v_dot2c_f32_bf16 v44, v32, v122
v_dot2c_f32_bf16 v46, v122, v122
v_dot2c_f32_bf16 v45, v32, v123
v_dot2c_f32_bf16 v47, v123, v123
v_dot2c_f32_bf16 v44, v32, v124
v_dot2c_f32_bf16 v46, v124, v124
v_dot2c_f32_bf16 v45, v32, v125
v_dot2c_f32_bf16 v47, v125, v125
v_dot2c_f32_bf16 v44, v32, v126
v_dot2c_f32_bf16 v46, v126, v126
v_dot2c_f32_bf16 v45, v32, v127
v_dot2c_f32_bf16 v47, v127, v127
s_waitcnt vmcnt(13)
ds_read_b128 v[96:99], v24 offset:24576
ds_read_b128 v[100:103], v25 offset:24576
ds_read_b128 v[104:107], v26 offset:24576
ds_read_b128 v[108:111], v27 offset:24576
ds_read_b128 v[112:115], v28 offset:24576
ds_read_b128 v[116:119], v29 offset:24576
ds_read_b128 v[120:123], v30 offset:24576
ds_read_b128 v[124:127], v31 offset:24576
ds_read_b128 a[96:99], v24 offset:24576
ds_read_b128 a[100:103], v25 offset:24576
ds_read_b128 a[104:107], v26 offset:24576
ds_read_b128 a[108:111], v27 offset:24576
ds_read_b128 a[112:115], v28 offset:24576
ds_read_b128 a[116:119], v29 offset:24576
ds_read_b128 a[120:123], v30 offset:24576
ds_read_b128 a[124:127], v31 offset:24576
v_dot2c_f32_bf16 v44, v32, v64
v_dot2c_f32_bf16 v46, v64, v64
v_dot2c_f32_bf16 v45, v32, v65
v_dot2c_f32_bf16 v47, v65, v65
v_dot2c_f32_bf16 v44, v32, v66
v_dot2c_f32_bf16 v46, v66, v66
v_dot2c_f32_bf16 v45, v32, v67
v_dot2c_f32_bf16 v47, v67, v67
s_waitcnt lgkmcnt(15)
v_dot2c_f32_bf16 v44, v32, v68
v_dot2c_f32_bf16 v46, v68, v68
v_dot2c_f32_bf16 v45, v32, v69
v_dot2c_f32_bf16 v47, v69, v69
v_dot2c_f32_bf16 v44, v32, v70
v_dot2c_f32_bf16 v46, v70, v70
v_dot2c_f32_bf16 v45, v32, v71
v_dot2c_f32_bf16 v47, v71, v71
v_dot2c_f32_bf16 v44, v32, v72
v_dot2c_f32_bf16 v46, v72, v72
v_dot2c_f32_bf16 v45, v32, v73
v_dot2c_f32_bf16 v47, v73, v73
v_dot2c_f32_bf16 v44, v32, v74
v_dot2c_f32_bf16 v46, v74, v74
v_dot2c_f32_bf16 v45, v32, v75
v_dot2c_f32_bf16 v47, v75, v75
v_dot2c_f32_bf16 v44, v32, v76
v_dot2c_f32_bf16 v46, v76, v76
v_dot2c_f32_bf16 v45, v32, v77
v_dot2c_f32_bf16 v47, v77, v77
v_dot2c_f32_bf16 v44, v32, v78
v_dot2c_f32_bf16 v46, v78, v78
v_dot2c_f32_bf16 v45, v32, v79
v_dot2c_f32_bf16 v47, v79, v79
v_dot2c_f32_bf16 v44, v32, v80
v_dot2c_f32_bf16 v46, v80, v80
v_dot2c_f32_bf16 v45, v32, v81
v_dot2c_f32_bf16 v47, v81, v81
v_dot2c_f32_bf16 v44, v32, v82
v_dot2c_f32_bf16 v46, v82, v82
v_dot2c_f32_bf16 v45, v32, v83
v_dot2c_f32_bf16 v47, v83, v83
v_dot2c_f32_bf16 v44, v32, v84
v_dot2c_f32_bf16 v46, v84, v84
v_dot2c_f32_bf16 v45, v32, v85
v_dot2c_f32_bf16 v47, v85, v85
v_dot2c_f32_bf16 v44, v32, v86
v_dot2c_f32_bf16 v46, v86, v86
v_dot2c_f32_bf16 v45, v32, v87
v_dot2c_f32_bf16 v47, v87, v87
v_dot2c_f32_bf16 v44, v32, v88
v_dot2c_f32_bf16 v46, v88, v88
v_dot2c_f32_bf16 v45, v32, v89
v_dot2c_f32_bf16 v47, v89, v89
v_dot2c_f32_bf16 v44, v32, v90
v_dot2c_f32_bf16 v46, v90, v90
v_dot2c_f32_bf16 v45, v32, v91
v_dot2c_f32_bf16 v47, v91, v91
v_dot2c_f32_bf16 v44, v32, v92
v_dot2c_f32_bf16 v46, v92, v92
v_dot2c_f32_bf16 v45, v32, v93
v_dot2c_f32_bf16 v47, v93, v93
v_dot2c_f32_bf16 v44, v32, v94
v_dot2c_f32_bf16 v46, v94, v94
v_dot2c_f32_bf16 v45, v32, v95
v_dot2c_f32_bf16 v47, v95, v95
v_dot2c_f32_bf16 v44, v32, v96
v_dot2c_f32_bf16 v46, v96, v96
v_dot2c_f32_bf16 v45, v32, v97
v_dot2c_f32_bf16 v47, v97, v97
v_dot2c_f32_bf16 v44, v32, v98
v_dot2c_f32_bf16 v46, v98, v98
v_dot2c_f32_bf16 v45, v32, v99
v_dot2c_f32_bf16 v47, v99, v99
s_waitcnt lgkmcnt(14)
v_dot2c_f32_bf16 v44, v32, v100
v_dot2c_f32_bf16 v46, v100, v100
v_dot2c_f32_bf16 v45, v32, v101
v_dot2c_f32_bf16 v47, v101, v101
v_dot2c_f32_bf16 v44, v32, v102
v_dot2c_f32_bf16 v46, v102, v102
v_dot2c_f32_bf16 v45, v32, v103
v_dot2c_f32_bf16 v47, v103, v103
s_waitcnt lgkmcnt(13)
v_dot2c_f32_bf16 v44, v32, v104
v_dot2c_f32_bf16 v46, v104, v104
v_dot2c_f32_bf16 v45, v32, v105
v_dot2c_f32_bf16 v47, v105, v105
v_dot2c_f32_bf16 v44, v32, v106
v_dot2c_f32_bf16 v46, v106, v106
v_dot2c_f32_bf16 v45, v32, v107
v_dot2c_f32_bf16 v47, v107, v107
s_waitcnt lgkmcnt(12)
v_dot2c_f32_bf16 v44, v32, v108
v_dot2c_f32_bf16 v46, v108, v108
v_dot2c_f32_bf16 v45, v32, v109
v_dot2c_f32_bf16 v47, v109, v109
v_dot2c_f32_bf16 v44, v32, v110
v_dot2c_f32_bf16 v46, v110, v110
v_dot2c_f32_bf16 v45, v32, v111
v_dot2c_f32_bf16 v47, v111, v111
s_waitcnt lgkmcnt(11)
v_dot2c_f32_bf16 v44, v32, v112
v_dot2c_f32_bf16 v46, v112, v112
v_dot2c_f32_bf16 v45, v32, v113
v_dot2c_f32_bf16 v47, v113, v113
v_dot2c_f32_bf16 v44, v32, v114
v_dot2c_f32_bf16 v46, v114, v114
v_dot2c_f32_bf16 v45, v32, v115
v_dot2c_f32_bf16 v47, v115, v115
s_waitcnt lgkmcnt(10)
v_dot2c_f32_bf16 v44, v32, v116
v_dot2c_f32_bf16 v46, v116, v116
v_dot2c_f32_bf16 v45, v32, v117
v_dot2c_f32_bf16 v47, v117, v117
v_dot2c_f32_bf16 v44, v32, v118
v_dot2c_f32_bf16 v46, v118, v118
v_dot2c_f32_bf16 v45, v32, v119
v_dot2c_f32_bf16 v47, v119, v119
s_waitcnt lgkmcnt(9)
v_dot2c_f32_bf16 v44, v32, v120
v_dot2c_f32_bf16 v46, v120, v120
v_dot2c_f32_bf16 v45, v32, v121
v_dot2c_f32_bf16 v47, v121, v121
v_dot2c_f32_bf16 v44, v32, v122
v_dot2c_f32_bf16 v46, v122, v122
v_dot2c_f32_bf16 v45, v32, v123
v_dot2c_f32_bf16 v47, v123, v123
s_waitcnt lgkmcnt(8)
v_dot2c_f32_bf16 v44, v32, v124
v_dot2c_f32_bf16 v46, v124, v124
v_dot2c_f32_bf16 v45, v32, v125
v_dot2c_f32_bf16 v47, v125, v125
v_dot2c_f32_bf16 v44, v32, v126
v_dot2c_f32_bf16 v46, v126, v126
v_dot2c_f32_bf16 v45, v32, v127
v_dot2c_f32_bf16 v47, v127, v127
s_waitcnt vmcnt(6)
s_waitcnt lgkmcnt(0)
s_barrier
s_cmp_ge_u32 s2, 16
s_cbranch_scc1 L_nogate_13
s_cmp_lg_u32 s68, 0
s_cbranch_scc1 L_nogate_13
s_mov_b64 exec, 1
v_mov_b32 v8, 0
v_mov_b32 v9, 1
buffer_atomic_add v9, v8, s[60:63], 0 offen sc1
s_mov_b64 exec, -1
L_nogate_13:
ds_read_b64_tr_b16 a[160:161], v18 offset:0
ds_read_b64_tr_b16 a[162:163], v18 offset:256
ds_read_b64_tr_b16 a[164:165], v19 offset:512
ds_read_b64_tr_b16 a[166:167], v19 offset:768
ds_read_b64_tr_b16 a[168:169], v18 offset:1024
ds_read_b64_tr_b16 a[170:171], v18 offset:1280
ds_read_b64_tr_b16 a[172:173], v19 offset:1536
ds_read_b64_tr_b16 a[174:175], v19 offset:1792
v_add_f32 v64, v44, v45
v_add_f32 v65, v46, v47
s_nop 1
v_permlane32_swap_b32 v64, v65
v_add_f32 v66, v64, v65
s_add_u32 s77, s79, s7
s_add_u32 m0, s74, 0
s_nop 0
buffer_load_dwordx4 v20, s[32:35], s77 offen lds
v_mov_b32 v67, v66
s_nop 1
v_permlane32_swap_b32 v66, v67
v_mul_f32 v48, 0xbb000000, v66
v_mul_f32 v67, 0x3b000000, v67
v_mul_f32 v64, v48, v48
v_mov_b32 v49, v48
v_mov_b32 v50, v48
v_mov_b32 v51, v48
v_mov_b32 v52, v48
v_mov_b32 v53, v48
v_mov_b32 v54, v48
v_mov_b32 v55, v48
v_mov_b32 v56, v48
v_mov_b32 v57, v48
v_mov_b32 v58, v48
v_mov_b32 v59, v48
v_mov_b32 v60, v48
v_mov_b32 v61, v48
v_mov_b32 v62, v48
v_mov_b32 v63, v48
v_sub_f32 v67, v67, v64
v_max_f32 v67, 0, v67
v_add_f32 v67, 0x3727c5ac, v67
v_rsq_f32 v2, v67
s_nop 0
v_mul_f32 v3, 0x3fb8aa3b, v2
v_mul_f32 v4, v2, v2
v_mfma_f32_32x32x16_bf16 v[64:79], v[36:39], a[0:3], v[48:63]
v_mfma_f32_32x32x16_bf16 v[64:79], v[40:43], a[4:7], v[64:79]
v_mfma_f32_32x32x16_bf16 v[80:95], v[36:39], a[8:11], v[48:63]
v_mfma_f32_32x32x16_bf16 v[80:95], v[40:43], a[12:15], v[80:95]
s_add_u32 m0, s74, 0x1000
s_nop 0
buffer_load_dwordx4 v21, s[32:35], s77 offen lds
v_mfma_f32_32x32x16_bf16 v[96:111], v[36:39], a[16:19], v[48:63]
s_nop 5
v_cvt_pk_bf16_f32 v112, v64, v65
v_cvt_pk_bf16_f32 v113, v66, v67
v_cvt_pk_bf16_f32 v114, v68, v69
v_cvt_pk_bf16_f32 v115, v70, v71
v_cvt_pk_bf16_f32 v116, v72, v73
v_cvt_pk_bf16_f32 v117, v74, v75
v_cvt_pk_bf16_f32 v118, v76, v77
v_cvt_pk_bf16_f32 v119, v78, v79
v_mfma_f32_32x32x16_bf16 v[96:111], v[40:43], a[20:23], v[96:111]
v_accvgpr_write_b32 a0, v112
v_accvgpr_write_b32 a1, v113
v_accvgpr_write_b32 a2, v114
v_accvgpr_write_b32 a3, v115
v_accvgpr_write_b32 a4, v116
v_accvgpr_write_b32 a5, v117
v_accvgpr_write_b32 a6, v118
v_accvgpr_write_b32 a7, v119
v_mfma_f32_32x32x16_bf16 v[64:79], v[36:39], a[24:27], v[48:63]
v_cvt_pk_bf16_f32 v112, v80, v81
v_cvt_pk_bf16_f32 v113, v82, v83
v_cvt_pk_bf16_f32 v114, v84, v85
v_cvt_pk_bf16_f32 v115, v86, v87
v_cvt_pk_bf16_f32 v116, v88, v89
v_cvt_pk_bf16_f32 v117, v90, v91
v_cvt_pk_bf16_f32 v118, v92, v93
v_cvt_pk_bf16_f32 v119, v94, v95
v_mfma_f32_32x32x16_bf16 v[64:79], v[40:43], a[28:31], v[64:79]
v_accvgpr_write_b32 a8, v112
v_accvgpr_write_b32 a9, v113
v_accvgpr_write_b32 a10, v114
v_accvgpr_write_b32 a11, v115
v_accvgpr_write_b32 a12, v116
v_accvgpr_write_b32 a13, v117
v_accvgpr_write_b32 a14, v118
v_accvgpr_write_b32 a15, v119
s_add_u32 s77, s79, s8
s_add_u32 m0, s74, 0x2000
s_nop 0
buffer_load_dwordx4 v20, s[32:35], s77 offen lds
v_mfma_f32_32x32x16_bf16 v[80:95], v[36:39], a[32:35], v[48:63]
v_cvt_pk_bf16_f32 v112, v96, v97
v_cvt_pk_bf16_f32 v113, v98, v99
v_cvt_pk_bf16_f32 v114, v100, v101
v_cvt_pk_bf16_f32 v115, v102, v103
v_cvt_pk_bf16_f32 v116, v104, v105
v_cvt_pk_bf16_f32 v117, v106, v107
v_cvt_pk_bf16_f32 v118, v108, v109
v_cvt_pk_bf16_f32 v119, v110, v111
v_mfma_f32_32x32x16_bf16 v[80:95], v[40:43], a[36:39], v[80:95]
v_accvgpr_write_b32 a16, v112
v_accvgpr_write_b32 a17, v113
v_accvgpr_write_b32 a18, v114
v_accvgpr_write_b32 a19, v115
v_accvgpr_write_b32 a20, v116
v_accvgpr_write_b32 a21, v117
v_accvgpr_write_b32 a22, v118
v_accvgpr_write_b32 a23, v119
v_mfma_f32_32x32x16_bf16 v[96:111], v[36:39], a[40:43], v[48:63]
v_cvt_pk_bf16_f32 v112, v64, v65
v_cvt_pk_bf16_f32 v113, v66, v67
v_cvt_pk_bf16_f32 v114, v68, v69
v_cvt_pk_bf16_f32 v115, v70, v71
v_cvt_pk_bf16_f32 v116, v72, v73
v_cvt_pk_bf16_f32 v117, v74, v75
v_cvt_pk_bf16_f32 v118, v76, v77
v_cvt_pk_bf16_f32 v119, v78, v79
v_mfma_f32_32x32x16_bf16 v[96:111], v[40:43], a[44:47], v[96:111]
v_accvgpr_write_b32 a24, v112
v_accvgpr_write_b32 a25, v113
v_accvgpr_write_b32 a26, v114
v_accvgpr_write_b32 a27, v115
v_accvgpr_write_b32 a28, v116
v_accvgpr_write_b32 a29, v117
v_accvgpr_write_b32 a30, v118
v_accvgpr_write_b32 a31, v119
s_add_u32 m0, s74, 0x3000
s_nop 0
buffer_load_dwordx4 v21, s[32:35], s77 offen lds
v_mfma_f32_32x32x16_bf16 v[64:79], v[36:39], a[48:51], v[48:63]
v_cvt_pk_bf16_f32 v112, v80, v81
v_cvt_pk_bf16_f32 v113, v82, v83
v_cvt_pk_bf16_f32 v114, v84, v85
v_cvt_pk_bf16_f32 v115, v86, v87
v_cvt_pk_bf16_f32 v116, v88, v89
v_cvt_pk_bf16_f32 v117, v90, v91
v_cvt_pk_bf16_f32 v118, v92, v93
v_cvt_pk_bf16_f32 v119, v94, v95
v_mfma_f32_32x32x16_bf16 v[64:79], v[40:43], a[52:55], v[64:79]
v_accvgpr_write_b32 a32, v112
v_accvgpr_write_b32 a33, v113
v_accvgpr_write_b32 a34, v114
v_accvgpr_write_b32 a35, v115
v_accvgpr_write_b32 a36, v116
v_accvgpr_write_b32 a37, v117
v_accvgpr_write_b32 a38, v118
v_accvgpr_write_b32 a39, v119
v_mfma_f32_32x32x16_bf16 v[80:95], v[36:39], a[56:59], v[48:63]
v_cvt_pk_bf16_f32 v112, v96, v97
v_cvt_pk_bf16_f32 v113, v98, v99
v_cvt_pk_bf16_f32 v114, v100, v101
v_cvt_pk_bf16_f32 v115, v102, v103
v_cvt_pk_bf16_f32 v116, v104, v105
v_cvt_pk_bf16_f32 v117, v106, v107
v_cvt_pk_bf16_f32 v118, v108, v109
v_cvt_pk_bf16_f32 v119, v110, v111
v_mfma_f32_32x32x16_bf16 v[80:95], v[40:43], a[60:63], v[80:95]
v_accvgpr_write_b32 a40, v112
v_accvgpr_write_b32 a41, v113
v_accvgpr_write_b32 a42, v114
v_accvgpr_write_b32 a43, v115
v_accvgpr_write_b32 a44, v116
v_accvgpr_write_b32 a45, v117
v_accvgpr_write_b32 a46, v118
v_accvgpr_write_b32 a47, v119
s_add_u32 s77, s79, s9
s_add_u32 m0, s74, 0x4000
s_nop 0
buffer_load_dwordx4 v20, s[32:35], s77 offen lds
v_mfma_f32_32x32x16_bf16 v[96:111], v[36:39], a[64:67], v[48:63]
v_cvt_pk_bf16_f32 v112, v64, v65
v_cvt_pk_bf16_f32 v113, v66, v67
v_cvt_pk_bf16_f32 v114, v68, v69
v_cvt_pk_bf16_f32 v115, v70, v71
v_cvt_pk_bf16_f32 v116, v72, v73
v_cvt_pk_bf16_f32 v117, v74, v75
v_cvt_pk_bf16_f32 v118, v76, v77
v_cvt_pk_bf16_f32 v119, v78, v79
v_mfma_f32_32x32x16_bf16 v[96:111], v[40:43], a[68:71], v[96:111]
v_accvgpr_write_b32 a48, v112
v_accvgpr_write_b32 a49, v113
v_accvgpr_write_b32 a50, v114
v_accvgpr_write_b32 a51, v115
v_accvgpr_write_b32 a52, v116
v_accvgpr_write_b32 a53, v117
v_accvgpr_write_b32 a54, v118
v_accvgpr_write_b32 a55, v119
v_mfma_f32_32x32x16_bf16 v[64:79], v[36:39], a[72:75], v[48:63]
v_cvt_pk_bf16_f32 v112, v80, v81
v_cvt_pk_bf16_f32 v113, v82, v83
v_cvt_pk_bf16_f32 v114, v84, v85
v_cvt_pk_bf16_f32 v115, v86, v87
v_cvt_pk_bf16_f32 v116, v88, v89
v_cvt_pk_bf16_f32 v117, v90, v91
v_cvt_pk_bf16_f32 v118, v92, v93
v_cvt_pk_bf16_f32 v119, v94, v95
v_mfma_f32_32x32x16_bf16 v[64:79], v[40:43], a[76:79], v[64:79]
v_accvgpr_write_b32 a56, v112
v_accvgpr_write_b32 a57, v113
v_accvgpr_write_b32 a58, v114
v_accvgpr_write_b32 a59, v115
v_accvgpr_write_b32 a60, v116
v_accvgpr_write_b32 a61, v117
v_accvgpr_write_b32 a62, v118
v_accvgpr_write_b32 a63, v119
s_add_u32 m0, s74, 0x5000
s_nop 0
buffer_load_dwordx4 v21, s[32:35], s77 offen lds
v_mfma_f32_32x32x16_bf16 v[80:95], v[36:39], a[80:83], v[48:63]
v_cvt_pk_bf16_f32 v112, v96, v97
v_cvt_pk_bf16_f32 v113, v98, v99
v_cvt_pk_bf16_f32 v114, v100, v101
v_cvt_pk_bf16_f32 v115, v102, v103
v_cvt_pk_bf16_f32 v116, v104, v105
v_cvt_pk_bf16_f32 v117, v106, v107
v_cvt_pk_bf16_f32 v118, v108, v109
v_cvt_pk_bf16_f32 v119, v110, v111
v_mfma_f32_32x32x16_bf16 v[80:95], v[40:43], a[84:87], v[80:95]
v_accvgpr_write_b32 a64, v112
v_accvgpr_write_b32 a65, v113
v_accvgpr_write_b32 a66, v114
v_accvgpr_write_b32 a67, v115
v_accvgpr_write_b32 a68, v116
v_accvgpr_write_b32 a69, v117
v_accvgpr_write_b32 a70, v118
v_accvgpr_write_b32 a71, v119
v_mfma_f32_32x32x16_bf16 v[96:111], v[36:39], a[88:91], v[48:63]
v_cvt_pk_bf16_f32 v112, v64, v65
v_cvt_pk_bf16_f32 v113, v66, v67
v_cvt_pk_bf16_f32 v114, v68, v69
v_cvt_pk_bf16_f32 v115, v70, v71
v_cvt_pk_bf16_f32 v116, v72, v73
v_cvt_pk_bf16_f32 v117, v74, v75
v_cvt_pk_bf16_f32 v118, v76, v77
v_cvt_pk_bf16_f32 v119, v78, v79
v_mfma_f32_32x32x16_bf16 v[96:111], v[40:43], a[92:95], v[96:111]
v_accvgpr_write_b32 a72, v112
v_accvgpr_write_b32 a73, v113
v_accvgpr_write_b32 a74, v114
v_accvgpr_write_b32 a75, v115
v_accvgpr_write_b32 a76, v116
v_accvgpr_write_b32 a77, v117
v_accvgpr_write_b32 a78, v118
v_accvgpr_write_b32 a79, v119
s_add_u32 s77, s79, s10
s_add_u32 m0, s74, 0x6000
s_nop 0
buffer_load_dwordx4 v20, s[32:35], s77 offen lds
v_mfma_f32_32x32x16_bf16 v[64:79], v[36:39], a[96:99], v[48:63]
v_cvt_pk_bf16_f32 v112, v80, v81
v_cvt_pk_bf16_f32 v113, v82, v83
v_cvt_pk_bf16_f32 v114, v84, v85
v_cvt_pk_bf16_f32 v115, v86, v87
v_cvt_pk_bf16_f32 v116, v88, v89
v_cvt_pk_bf16_f32 v117, v90, v91
v_cvt_pk_bf16_f32 v118, v92, v93
v_cvt_pk_bf16_f32 v119, v94, v95
v_mfma_f32_32x32x16_bf16 v[64:79], v[40:43], a[100:103], v[64:79]
v_accvgpr_write_b32 a80, v112
v_accvgpr_write_b32 a81, v113
v_accvgpr_write_b32 a82, v114
v_accvgpr_write_b32 a83, v115
v_accvgpr_write_b32 a84, v116
v_accvgpr_write_b32 a85, v117
v_accvgpr_write_b32 a86, v118
v_accvgpr_write_b32 a87, v119
v_mfma_f32_32x32x16_bf16 v[80:95], v[36:39], a[104:107], v[48:63]
v_cvt_pk_bf16_f32 v112, v96, v97
v_cvt_pk_bf16_f32 v113, v98, v99
v_cvt_pk_bf16_f32 v114, v100, v101
v_cvt_pk_bf16_f32 v115, v102, v103
v_cvt_pk_bf16_f32 v116, v104, v105
v_cvt_pk_bf16_f32 v117, v106, v107
v_cvt_pk_bf16_f32 v118, v108, v109
v_cvt_pk_bf16_f32 v119, v110, v111
v_mfma_f32_32x32x16_bf16 v[80:95], v[40:43], a[108:111], v[80:95]
v_accvgpr_write_b32 a88, v112
v_accvgpr_write_b32 a89, v113
v_accvgpr_write_b32 a90, v114
v_accvgpr_write_b32 a91, v115
v_accvgpr_write_b32 a92, v116
v_accvgpr_write_b32 a93, v117
v_accvgpr_write_b32 a94, v118
v_accvgpr_write_b32 a95, v119
s_add_u32 m0, s74, 0x7000
s_nop 0
buffer_load_dwordx4 v21, s[32:35], s77 offen lds
v_mfma_f32_32x32x16_bf16 v[96:111], v[36:39], a[112:115], v[48:63]
v_cvt_pk_bf16_f32 v112, v64, v65
v_cvt_pk_bf16_f32 v113, v66, v67
v_cvt_pk_bf16_f32 v114, v68, v69
v_cvt_pk_bf16_f32 v115, v70, v71
v_cvt_pk_bf16_f32 v116, v72, v73
v_cvt_pk_bf16_f32 v117, v74, v75
v_cvt_pk_bf16_f32 v118, v76, v77
v_cvt_pk_bf16_f32 v119, v78, v79
v_mfma_f32_32x32x16_bf16 v[96:111], v[40:43], a[116:119], v[96:111]
v_accvgpr_write_b32 a96, v112
v_accvgpr_write_b32 a97, v113
v_accvgpr_write_b32 a98, v114
v_accvgpr_write_b32 a99, v115
v_accvgpr_write_b32 a100, v116
v_accvgpr_write_b32 a101, v117
v_accvgpr_write_b32 a102, v118
v_accvgpr_write_b32 a103, v119
v_mfma_f32_32x32x16_bf16 v[64:79], v[36:39], a[120:123], v[48:63]
v_cvt_pk_bf16_f32 v112, v80, v81
v_cvt_pk_bf16_f32 v113, v82, v83
v_cvt_pk_bf16_f32 v114, v84, v85
v_cvt_pk_bf16_f32 v115, v86, v87
v_cvt_pk_bf16_f32 v116, v88, v89
v_cvt_pk_bf16_f32 v117, v90, v91
v_cvt_pk_bf16_f32 v118, v92, v93
v_cvt_pk_bf16_f32 v119, v94, v95
v_mfma_f32_32x32x16_bf16 v[64:79], v[40:43], a[124:127], v[64:79]
v_accvgpr_write_b32 a104, v112
v_accvgpr_write_b32 a105, v113
v_accvgpr_write_b32 a106, v114
v_accvgpr_write_b32 a107, v115
v_accvgpr_write_b32 a108, v116
v_accvgpr_write_b32 a109, v117
v_accvgpr_write_b32 a110, v118
v_accvgpr_write_b32 a111, v119
s_add_u32 s77, s87, s4
s_add_u32 m0, s74, 0x10000
s_nop 0
buffer_load_dwordx4 v20, s[32:35], s77 offen lds
v_cvt_pk_bf16_f32 v112, v96, v97
v_cvt_pk_bf16_f32 v113, v98, v99
v_cvt_pk_bf16_f32 v114, v100, v101
v_cvt_pk_bf16_f32 v115, v102, v103
v_cvt_pk_bf16_f32 v116, v104, v105
v_cvt_pk_bf16_f32 v117, v106, v107
v_cvt_pk_bf16_f32 v118, v108, v109
v_cvt_pk_bf16_f32 v119, v110, v111
v_accvgpr_write_b32 a112, v112
v_accvgpr_write_b32 a113, v113
v_accvgpr_write_b32 a114, v114
v_accvgpr_write_b32 a115, v115
v_accvgpr_write_b32 a116, v116
v_accvgpr_write_b32 a117, v117
v_accvgpr_write_b32 a118, v118
v_accvgpr_write_b32 a119, v119
v_cvt_pk_bf16_f32 v112, v64, v65
v_cvt_pk_bf16_f32 v113, v66, v67
v_cvt_pk_bf16_f32 v114, v68, v69
v_cvt_pk_bf16_f32 v115, v70, v71
v_cvt_pk_bf16_f32 v116, v72, v73
v_cvt_pk_bf16_f32 v117, v74, v75
v_cvt_pk_bf16_f32 v118, v76, v77
v_cvt_pk_bf16_f32 v119, v78, v79
s_add_u32 m0, s74, 0x11000
s_nop 0
buffer_load_dwordx4 v21, s[32:35], s77 offen lds
v_accvgpr_write_b32 a120, v112
v_accvgpr_write_b32 a121, v113
v_accvgpr_write_b32 a122, v114
v_accvgpr_write_b32 a123, v115
v_accvgpr_write_b32 a124, v116
v_accvgpr_write_b32 a125, v117
v_accvgpr_write_b32 a126, v118
v_accvgpr_write_b32 a127, v119
s_waitcnt lgkmcnt(0)
s_add_u32 s77, s87, s5
s_add_u32 m0, s74, 0x12000
ds_read_b64_tr_b16 a[128:129], v202 offset:0
ds_read_b64_tr_b16 a[130:131], v202 offset:512
ds_read_b64_tr_b16 a[132:133], v205 offset:0
ds_read_b64_tr_b16 a[134:135], v205 offset:512
ds_read_b64_tr_b16 a[136:137], v202 offset:2048
ds_read_b64_tr_b16 a[138:139], v202 offset:2560
ds_read_b64_tr_b16 a[140:141], v205 offset:2048
ds_read_b64_tr_b16 a[142:143], v205 offset:2560
ds_read_b64_tr_b16 a[144:145], v202 offset:4096
ds_read_b64_tr_b16 a[146:147], v202 offset:4608
buffer_load_dwordx4 v20, s[32:35], s77 offen lds
s_waitcnt lgkmcnt(6)
v_mfma_f32_32x32x16_bf16 v[32:47], a[128:131], a[0:3], 0
ds_read_b64_tr_b16 a[148:149], v205 offset:4096
ds_read_b64_tr_b16 a[150:151], v205 offset:4608
v_and_b32 v12, 15, v1
v_lshrrev_b32 v8, 2, v12
v_and_b32 v9, 3, v12
v_bfe_u32 v10, v1, 4, 1
v_mfma_f32_32x32x16_bf16 v[48:63], a[132:135], a[0:3], 0
ds_read_b64_tr_b16 a[152:153], v202 offset:6144
ds_read_b64_tr_b16 a[154:155], v202 offset:6656
v_lshrrev_b32 v11, 5, v1
v_lshrrev_b32 v12, 1, v9
v_lshlrev_b32 v12, 4, v12
v_and_b32 v13, 1, v9
s_waitcnt lgkmcnt(6)
v_mfma_f32_32x32x16_bf16 v[32:47], a[136:139], a[4:7], v[32:47]
s_add_u32 m0, s74, 0x13000
ds_read_b64_tr_b16 a[156:157], v205 offset:6144
ds_read_b64_tr_b16 a[158:159], v205 offset:6656
buffer_load_dwordx4 v21, s[32:35], s77 offen lds
v_mfma_f32_32x32x16_bf16 v[48:63], a[140:143], a[4:7], v[48:63]
ds_read_b64_tr_b16 a[128:129], v202 offset:8192
ds_read_b64_tr_b16 a[130:131], v202 offset:8704
v_lshlrev_b32 v13, 3, v13
v_add_u32 v12, v12, v13
v_lshlrev_b32 v13, 3, v11
v_add_u32 v13, v13, v8
s_waitcnt lgkmcnt(6)
v_mfma_f32_32x32x16_bf16 v[32:47], a[144:147], a[8:11], v[32:47]
ds_read_b64_tr_b16 a[132:133], v205 offset:8192
ds_read_b64_tr_b16 a[134:135], v205 offset:8704
v_lshlrev_b32 v13, 7, v13
v_add_u32 v12, v12, v13
v_lshlrev_b32 v13, 13, v10
v_add_u32 v12, v12, v13
v_mfma_f32_32x32x16_bf16 v[48:63], a[148:151], a[8:11], v[48:63]
s_add_u32 s77, s87, s6
s_add_u32 m0, s74, 0x14000
ds_read_b64_tr_b16 a[136:137], v202 offset:10240
ds_read_b64_tr_b16 a[138:139], v202 offset:10752
buffer_load_dwordx4 v20, s[32:35], s77 offen lds
s_waitcnt lgkmcnt(6)
v_mfma_f32_32x32x16_bf16 v[32:47], a[152:155], a[12:15], v[32:47]
ds_read_b64_tr_b16 a[140:141], v205 offset:10240
ds_read_b64_tr_b16 a[142:143], v205 offset:10752
v_bfe_u32 v14, v8, 1, 1
v_lshlrev_b32 v13, 1, v10
v_xor_b32 v14, v14, v13
v_xor_b32 v13, 0, v14
v_mfma_f32_32x32x16_bf16 v[48:63], a[156:159], a[12:15], v[48:63]
ds_read_b64_tr_b16 a[144:145], v202 offset:12288
ds_read_b64_tr_b16 a[146:147], v202 offset:12800
v_lshlrev_b32 v13, 5, v13
v_add_u32 v206, v12, v13
v_add_u32 v207, 0x10000, v206
v_xor_b32 v13, 1, v14
s_waitcnt lgkmcnt(6)
v_mfma_f32_32x32x16_bf16 v[32:47], a[128:131], a[16:19], v[32:47]
s_add_u32 m0, s74, 0x15000
ds_read_b64_tr_b16 a[148:149], v205 offset:12288
ds_read_b64_tr_b16 a[150:151], v205 offset:12800
buffer_load_dwordx4 v21, s[32:35], s77 offen lds
v_mfma_f32_32x32x16_bf16 v[48:63], a[132:135], a[16:19], v[48:63]
ds_read_b64_tr_b16 a[152:153], v202 offset:14336
ds_read_b64_tr_b16 a[154:155], v202 offset:14848
v_lshlrev_b32 v13, 5, v13
v_add_u32 v208, v12, v13
v_add_u32 v209, 0x10000, v208
v_xor_b32 v13, 2, v14
s_waitcnt lgkmcnt(6)
v_mfma_f32_32x32x16_bf16 v[32:47], a[136:139], a[20:23], v[32:47]
ds_read_b64_tr_b16 a[156:157], v205 offset:14336
ds_read_b64_tr_b16 a[158:159], v205 offset:14848
v_lshlrev_b32 v13, 5, v13
v_add_u32 v210, v12, v13
v_add_u32 v211, 0x10000, v210
v_xor_b32 v13, 3, v14
v_mfma_f32_32x32x16_bf16 v[48:63], a[140:143], a[20:23], v[48:63]
ds_read_b64_tr_b16 a[128:129], v202 offset:16384
ds_read_b64_tr_b16 a[130:131], v202 offset:16896
v_lshlrev_b32 v13, 5, v13
v_add_u32 v212, v12, v13
v_add_u32 v213, 0x10000, v212
s_add_u32 s81, s68, 1
s_waitcnt lgkmcnt(6)
v_mfma_f32_32x32x16_bf16 v[32:47], a[144:147], a[24:27], v[32:47]
ds_read_b64_tr_b16 a[132:133], v205 offset:16384
ds_read_b64_tr_b16 a[134:135], v205 offset:16896
s_and_b32 s81, s81, 3
s_lshl_b32 s81, s81, 13
s_lshr_b32 s82, s68, 1
s_mul_i32 s82, s82, 0x2200
v_mfma_f32_32x32x16_bf16 v[48:63], a[148:151], a[24:27], v[48:63]
ds_read_b64_tr_b16 a[136:137], v202 offset:18432
ds_read_b64_tr_b16 a[138:139], v202 offset:18944
s_add_u32 s82, s82, 0x8000
s_and_b32 s83, s68, 1
s_lshl_b32 s83, s83, 7
v_lshlrev_b32 v12, 1, v11
s_waitcnt lgkmcnt(6)
v_mfma_f32_32x32x16_bf16 v[32:47], a[152:155], a[28:31], v[32:47]
ds_read_b64_tr_b16 a[140:141], v205 offset:18432
ds_read_b64_tr_b16 a[142:143], v205 offset:18944
v_add_u32 v12, 0, v12
v_xor_b32 v13, v12, v9
v_lshlrev_b32 v13, 3, v13
v_lshlrev_b32 v12, 8, v12
v_mfma_f32_32x32x16_bf16 v[48:63], a[156:159], a[28:31], v[48:63]
ds_read_b64_tr_b16 a[144:145], v202 offset:20480
ds_read_b64_tr_b16 a[146:147], v202 offset:20992
v_add_u32 v13, v13, v12
v_lshlrev_b32 v12, 5, v8
v_add_u32 v13, v13, v12
v_lshlrev_b32 v12, 7, v10
s_waitcnt lgkmcnt(6)
v_mfma_f32_32x32x16_bf16 v[32:47], a[128:131], a[32:35], v[32:47]
ds_read_b64_tr_b16 a[148:149], v205 offset:20480
ds_read_b64_tr_b16 a[150:151], v205 offset:20992
v_add_u32 v12, v12, v13
v_add_u32 v12, s81, v12
v_add_u32 v221, 0x20000, v12
v_add_u32 v13, s83, v13
v_mfma_f32_32x32x16_bf16 v[48:63], a[132:135], a[32:35], v[48:63]
ds_read_b64_tr_b16 a[152:153], v202 offset:22528
ds_read_b64_tr_b16 a[154:155], v202 offset:23040
v_lshlrev_b32 v12, 3, v9
v_add_u32 v12, 0x400, v12
v_cmp_eq_u32 vcc, 0, v10
s_waitcnt lgkmcnt(6)
v_mfma_f32_32x32x16_bf16 v[32:47], a[136:139], a[36:39], v[32:47]
ds_read_b64_tr_b16 a[156:157], v205 offset:22528
ds_read_b64_tr_b16 a[158:159], v205 offset:23040
v_cndmask_b32 v13, v12, v13, vcc
v_add_u32 v223, s82, v13
v_lshlrev_b32 v12, 1, v11
v_add_u32 v12, 1, v12
v_mfma_f32_32x32x16_bf16 v[48:63], a[140:143], a[36:39], v[48:63]
s_waitcnt vmcnt(6)
s_barrier
s_add_u32 s77, s79, s11
s_add_u32 m0, s74, 0x20000
ds_read_b64_tr_b16 a[128:129], v200 offset:0
ds_read_b64_tr_b16 a[130:131], v200 offset:512
buffer_load_dwordx4 v20, s[32:35], s77 offen lds
s_waitcnt lgkmcnt(6)
v_mfma_f32_32x32x16_bf16 v[32:47], a[144:147], a[40:43], v[32:47]
ds_read_b64_tr_b16 a[132:133], v203 offset:0
ds_read_b64_tr_b16 a[134:135], v203 offset:512
v_xor_b32 v13, v12, v9
v_lshlrev_b32 v13, 3, v13
v_lshlrev_b32 v12, 8, v12
v_add_u32 v13, v13, v12
v_mfma_f32_32x32x16_bf16 v[48:63], a[148:151], a[40:43], v[48:63]
ds_read_b64_tr_b16 a[136:137], v200 offset:2048
ds_read_b64_tr_b16 a[138:139], v200 offset:2560
v_lshlrev_b32 v12, 5, v8
v_add_u32 v13, v13, v12
v_lshlrev_b32 v12, 7, v10
v_add_u32 v12, v12, v13
s_waitcnt lgkmcnt(6)
v_mfma_f32_32x32x16_bf16 v[32:47], a[152:155], a[44:47], v[32:47]
s_add_u32 m0, s74, 0x21000
ds_read_b64_tr_b16 a[140:141], v203 offset:2048
ds_read_b64_tr_b16 a[142:143], v203 offset:2560
buffer_load_dwordx4 v21, s[32:35], s77 offen lds
v_mfma_f32_32x32x16_bf16 v[48:63], a[156:159], a[44:47], v[48:63]
ds_read_b64_tr_b16 a[144:145], v200 offset:4096
ds_read_b64_tr_b16 a[146:147], v200 offset:4608
v_add_u32 v12, s81, v12
v_add_u32 v222, 0x20000, v12
v_add_u32 v13, s83, v13
v_lshlrev_b32 v12, 3, v9
s_waitcnt lgkmcnt(6)
v_mfma_f32_32x32x16_bf16 v[32:47], a[128:131], a[48:51], v[32:47]
ds_read_b64_tr_b16 a[148:149], v203 offset:4096
ds_read_b64_tr_b16 a[150:151], v203 offset:4608
v_add_u32 v12, 0x400, v12
v_cmp_eq_u32 vcc, 0, v10
s_lshl_b32 s81, s68, 11
s_mov_b32 s83, 0x2200
v_mfma_f32_32x32x16_bf16 v[48:63], a[132:135], a[48:51], v[48:63]
s_add_u32 s77, s87, s7
s_add_u32 m0, s74, 0x16000
ds_read_b64_tr_b16 a[152:153], v200 offset:6144
ds_read_b64_tr_b16 a[154:155], v200 offset:6656
buffer_load_dwordx4 v20, s[32:35], s77 offen lds
s_waitcnt lgkmcnt(6)
v_mfma_f32_32x32x16_bf16 v[32:47], a[136:139], a[52:55], v[32:47]
ds_read_b64_tr_b16 a[156:157], v203 offset:6144
ds_read_b64_tr_b16 a[158:159], v203 offset:6656
v_cndmask_b32 v13, v12, v13, vcc
v_add_u32 v224, s82, v13
v_and_b32 v12, 31, v1
v_bfe_u32 v13, v12, 2, 2
v_mfma_f32_32x32x16_bf16 v[48:63], a[140:143], a[52:55], v[48:63]
ds_read_b64_tr_b16 a[128:129], v200 offset:8192
ds_read_b64_tr_b16 a[130:131], v200 offset:8704
v_xor_b32 v13, v13, v11
v_lshlrev_b32 v13, 3, v13
v_and_b32 v14, 3, v12
v_lshlrev_b32 v14, 5, v14
s_waitcnt lgkmcnt(6)
v_mfma_f32_32x32x16_bf16 v[32:47], a[144:147], a[56:59], v[32:47]
s_add_u32 m0, s74, 0x17000
ds_read_b64_tr_b16 a[132:133], v203 offset:8192
ds_read_b64_tr_b16 a[134:135], v203 offset:8704
buffer_load_dwordx4 v21, s[32:35], s77 offen lds
v_mfma_f32_32x32x16_bf16 v[48:63], a[148:151], a[56:59], v[48:63]
ds_read_b64_tr_b16 a[136:137], v200 offset:10240
ds_read_b64_tr_b16 a[138:139], v200 offset:10752
v_lshrrev_b32 v15, 2, v12
v_lshlrev_b32 v16, 8, v15
v_add_u32 v16, v16, v14
s_mul_i32 s82, s68, 0x880
s_waitcnt lgkmcnt(6)
v_mfma_f32_32x32x16_bf16 v[32:47], a[152:155], a[60:63], v[32:47]
ds_read_b64_tr_b16 a[140:141], v203 offset:10240
ds_read_b64_tr_b16 a[142:143], v203 offset:10752
s_add_u32 s82, s82, 0x8000
v_lshrrev_b32 v17, 4, v12
v_lshlrev_b32 v17, 6, v17
v_add_u32 v17, v17, v16
v_mfma_f32_32x32x16_bf16 v[48:63], a[156:159], a[60:63], v[48:63]
s_add_u32 s77, s87, s8
s_add_u32 m0, s74, 0x8000
ds_read_b64_tr_b16 a[144:145], v200 offset:12288
ds_read_b64_tr_b16 a[146:147], v200 offset:12800
buffer_load_dwordx4 v20, s[32:35], s77 offen lds
s_waitcnt lgkmcnt(6)
v_mfma_f32_32x32x16_bf16 v[32:47], a[128:131], a[64:67], v[32:47]
ds_read_b64_tr_b16 a[148:149], v203 offset:12288
ds_read_b64_tr_b16 a[150:151], v203 offset:12800
v_xor_b32 v18, 0, v13
v_add_u32 v19, v16, v18
v_add_u32 v19, s81, v19
v_add_u32 v225, 0x20000, v19
v_mfma_f32_32x32x16_bf16 v[48:63], a[132:135], a[64:67], v[48:63]
ds_read_b64_tr_b16 a[152:153], v200 offset:14336
ds_read_b64_tr_b16 a[154:155], v200 offset:14848
v_add_u32 v19, v17, v18
v_add_u32 v229, s82, v19
v_xor_b32 v18, 16, v13
v_add_u32 v19, v16, v18
s_waitcnt lgkmcnt(6)
v_mfma_f32_32x32x16_bf16 v[32:47], a[136:139], a[68:71], v[32:47]
s_add_u32 m0, s74, 0x9000
ds_read_b64_tr_b16 a[156:157], v203 offset:14336
ds_read_b64_tr_b16 a[158:159], v203 offset:14848
buffer_load_dwordx4 v21, s[32:35], s77 offen lds
v_mfma_f32_32x32x16_bf16 v[48:63], a[140:143], a[68:71], v[48:63]
ds_read_b64_tr_b16 a[128:129], v200 offset:16384
ds_read_b64_tr_b16 a[130:131], v200 offset:16896
v_add_u32 v19, s81, v19
v_add_u32 v226, 0x20000, v19
v_add_u32 v19, v17, v18
v_add_u32 v230, s82, v19
s_waitcnt lgkmcnt(6)
v_mfma_f32_32x32x16_bf16 v[32:47], a[144:147], a[72:75], v[32:47]
ds_read_b64_tr_b16 a[132:133], v203 offset:16384
ds_read_b64_tr_b16 a[134:135], v203 offset:16896
s_lshl_b32 s82, s68, 1
v_lshrrev_b32 v15, 5, v1
v_mul_lo_u32 v15, v15, s83
v_bfe_u32 v16, v1, 4, 1
v_mfma_f32_32x32x16_bf16 v[48:63], a[148:151], a[72:75], v[48:63]
s_add_u32 s77, s87, s9
s_add_u32 m0, s74, 0xa000
ds_read_b64_tr_b16 a[136:137], v200 offset:18432
ds_read_b64_tr_b16 a[138:139], v200 offset:18944
buffer_load_dwordx4 v20, s[32:35], s77 offen lds
s_waitcnt lgkmcnt(6)
v_mfma_f32_32x32x16_bf16 v[32:47], a[152:155], a[76:79], v[32:47]
ds_read_b64_tr_b16 a[140:141], v203 offset:18432
ds_read_b64_tr_b16 a[142:143], v203 offset:18944
v_add_u32 v16, s82, v16
s_mov_b32 s83, 0x440
v_mul_lo_u32 v16, v16, s83
v_and_b32 v17, 15, v1
v_mfma_f32_32x32x16_bf16 v[48:63], a[156:159], a[76:79], v[48:63]
ds_read_b64_tr_b16 a[144:145], v200 offset:20480
ds_read_b64_tr_b16 a[146:147], v200 offset:20992
v_lshlrev_b32 v17, 2, v17
v_add_u32 v15, v15, v16
v_add_u32 v15, v15, v17
v_add_u32 v220, 0x8400, v15
s_waitcnt lgkmcnt(6)
v_mfma_f32_32x32x16_bf16 v[32:47], a[128:131], a[80:83], v[32:47]
s_add_u32 m0, s74, 0xb000
ds_read_b64_tr_b16 a[148:149], v203 offset:20480
ds_read_b64_tr_b16 a[150:151], v203 offset:20992
buffer_load_dwordx4 v21, s[32:35], s77 offen lds
v_mfma_f32_32x32x16_bf16 v[48:63], a[132:135], a[80:83], v[48:63]
ds_read_b64_tr_b16 a[152:153], v200 offset:22528
ds_read_b64_tr_b16 a[154:155], v200 offset:23040
s_lshr_b32 s95, s68, 1
s_and_b32 s96, s68, 1
s_lshl_b32 s94, s68, 11
v_mov_b32 v15, s95
s_waitcnt lgkmcnt(6)
v_mfma_f32_32x32x16_bf16 v[32:47], a[136:139], a[84:87], v[32:47]
ds_read_b64_tr_b16 a[156:157], v203 offset:22528
ds_read_b64_tr_b16 a[158:159], v203 offset:23040
v_lshrrev_b32 v12, 1, v9
v_lshlrev_b32 v12, 4, v12
v_and_b32 v14, 1, v9
v_lshlrev_b32 v14, 3, v14
v_mfma_f32_32x32x16_bf16 v[48:63], a[140:143], a[84:87], v[48:63]
s_add_u32 s77, s87, s10
s_add_u32 m0, s74, 0xc000
ds_read_b64_tr_b16 a[128:129], v200 offset:24576
ds_read_b64_tr_b16 a[130:131], v200 offset:25088
buffer_load_dwordx4 v20, s[32:35], s77 offen lds
s_waitcnt lgkmcnt(6)
v_mfma_f32_32x32x16_bf16 v[32:47], a[144:147], a[88:91], v[32:47]
ds_read_b64_tr_b16 a[132:133], v203 offset:24576
ds_read_b64_tr_b16 a[134:135], v203 offset:25088
v_add_u32 v12, v12, v14
v_lshlrev_b32 v14, 5, v10
v_add_u32 v12, v12, v14
v_mul_u32_u24 v14, 4, v11
v_mfma_f32_32x32x16_bf16 v[48:63], a[148:151], a[88:91], v[48:63]
ds_read_b64_tr_b16 a[136:137], v200 offset:26624
ds_read_b64_tr_b16 a[138:139], v200 offset:27136
v_add_u32 v14, v14, v8
v_lshlrev_b32 v14, 7, v14
v_add_u32 v12, v12, v14
v_bfe_u32 v13, v8, 1, 1
s_waitcnt lgkmcnt(6)
v_mfma_f32_32x32x16_bf16 v[32:47], a[152:155], a[92:95], v[32:47]
s_add_u32 m0, s74, 0xd000
ds_read_b64_tr_b16 a[140:141], v203 offset:26624
ds_read_b64_tr_b16 a[142:143], v203 offset:27136
buffer_load_dwordx4 v21, s[32:35], s77 offen lds
v_mfma_f32_32x32x16_bf16 v[48:63], a[156:159], a[92:95], v[48:63]
ds_read_b64_tr_b16 a[144:145], v200 offset:28672
ds_read_b64_tr_b16 a[146:147], v200 offset:29184
v_xor_b32 v13, v15, v13
v_xor_b32 v14, 0, v13
v_lshlrev_b32 v14, 6, v14
v_add_u32 v235, v12, v14
s_waitcnt lgkmcnt(6)
v_mfma_f32_32x32x16_bf16 v[32:47], a[128:131], a[96:99], v[32:47]
ds_read_b64_tr_b16 a[148:149], v203 offset:28672
ds_read_b64_tr_b16 a[150:151], v203 offset:29184
v_add_u32 v236, 0x10000, v235
v_add_u32 v237, 0x20000, v235
v_xor_b32 v14, 1, v13
v_lshlrev_b32 v14, 6, v14
v_mfma_f32_32x32x16_bf16 v[48:63], a[132:135], a[96:99], v[48:63]
s_add_u32 s77, s87, s11
s_add_u32 m0, s74, 0xe000
ds_read_b64_tr_b16 a[152:153], v200 offset:30720
ds_read_b64_tr_b16 a[154:155], v200 offset:31232
buffer_load_dwordx4 v20, s[32:35], s77 offen lds
s_waitcnt lgkmcnt(6)
v_mfma_f32_32x32x16_bf16 v[32:47], a[136:139], a[100:103], v[32:47]
ds_read_b64_tr_b16 a[156:157], v203 offset:30720
ds_read_b64_tr_b16 a[158:159], v203 offset:31232
v_add_u32 v238, v12, v14
v_add_u32 v239, 0x10000, v238
v_add_u32 v240, 0x20000, v238
s_lshl_b32 s81, s95, 13
v_mfma_f32_32x32x16_bf16 v[48:63], a[140:143], a[100:103], v[48:63]
s_waitcnt vmcnt(9)
s_barrier
ds_read_b64_tr_b16 a[128:129], v202 offset:0
ds_read_b64_tr_b16 a[130:131], v202 offset:512
v_add_u32 v235, s81, v235
v_add_u32 v236, s81, v236
s_waitcnt lgkmcnt(6)
v_mfma_f32_32x32x16_bf16 v[32:47], a[144:147], a[104:107], v[32:47]
s_add_u32 m0, s74, 0xf000
ds_read_b64_tr_b16 a[132:133], v205 offset:0
ds_read_b64_tr_b16 a[134:135], v205 offset:512
buffer_load_dwordx4 v21, s[32:35], s77 offen lds
v_mfma_f32_32x32x16_bf16 v[48:63], a[148:151], a[104:107], v[48:63]
ds_read_b64_tr_b16 a[136:137], v202 offset:2048
ds_read_b64_tr_b16 a[138:139], v202 offset:2560
v_add_u32 v237, s81, v237
v_add_u32 v238, s81, v238
v_add_u32 v239, s81, v239
v_add_u32 v240, s81, v240
s_waitcnt lgkmcnt(6)
v_mfma_f32_32x32x16_bf16 v[32:47], a[152:155], a[108:111], v[32:47]
ds_read_b64_tr_b16 a[140:141], v205 offset:2048
ds_read_b64_tr_b16 a[142:143], v205 offset:2560
v_lshrrev_b32 v12, 3, v1
v_and_b32 v13, 7, v1
v_bfe_u32 v14, v12, 1, 1
v_lshlrev_b32 v14, 2, v14
v_mfma_f32_32x32x16_bf16 v[48:63], a[156:159], a[108:111], v[48:63]
s_add_u32 s77, s80, s12
s_add_u32 m0, s74, 0x18000
ds_read_b64_tr_b16 a[144:145], v202 offset:4096
ds_read_b64_tr_b16 a[146:147], v202 offset:4608
buffer_load_dwordx4 v214, s[44:47], s77 offen lds
s_waitcnt lgkmcnt(6)
v_mfma_f32_32x32x16_bf16 v[32:47], a[128:131], a[112:115], v[32:47]
ds_read_b64_tr_b16 a[148:149], v205 offset:4096
ds_read_b64_tr_b16 a[150:151], v205 offset:4608
v_xor_b32 v14, v14, v13
v_lshlrev_b32 v14, 4, v14
s_lshl_b32 s81, s68, 4
v_add_u32 v15, s81, v12
v_mfma_f32_32x32x16_bf16 v[48:63], a[132:135], a[112:115], v[48:63]
ds_read_b64_tr_b16 a[152:153], v202 offset:6144
ds_read_b64_tr_b16 a[154:155], v202 offset:6656
v_lshlrev_b32 v15, 10, v15
v_add_u32 v233, v14, v15
v_add_u32 v234, 0x2000, v233
s_lshl_b32 s88, s73, 7
s_waitcnt lgkmcnt(6)
v_mfma_f32_32x32x16_bf16 v[32:47], a[136:139], a[116:119], v[32:47]
s_add_u32 m0, s74, 0x1a000
ds_read_b64_tr_b16 a[156:157], v205 offset:6144
ds_read_b64_tr_b16 a[158:159], v205 offset:6656
buffer_load_dwordx4 v216, s[48:51], s77 offen lds
v_mfma_f32_32x32x16_bf16 v[48:63], a[140:143], a[116:119], v[48:63]
s_waitcnt vmcnt(10)
s_barrier
ds_read_b64_tr_b16 a[128:129], v201 offset:0
ds_read_b64_tr_b16 a[130:131], v201 offset:512
s_lshl_b32 s81, s69, 2
s_lshl_b32 s82, s72, 1
s_waitcnt lgkmcnt(6)
v_mfma_f32_32x32x16_bf16 v[32:47], a[144:147], a[120:123], v[32:47]
ds_read_b64_tr_b16 a[132:133], v204 offset:0
ds_read_b64_tr_b16 a[134:135], v204 offset:512
s_add_u32 s81, s81, s82
s_add_u32 s81, s81, s96
s_mul_i32 s90, s81, 0x56
s_mul_i32 s82, s95, 43
v_mfma_f32_32x32x16_bf16 v[48:63], a[148:151], a[120:123], v[48:63]
s_add_u32 m0, s74, 0x19000
ds_read_b64_tr_b16 a[136:137], v201 offset:2048
ds_read_b64_tr_b16 a[138:139], v201 offset:2560
buffer_load_dwordx4 v215, s[44:47], s77 offen lds
s_waitcnt lgkmcnt(6)
v_mfma_f32_32x32x16_bf16 v[32:47], a[152:155], a[124:127], v[32:47]
ds_read_b64_tr_b16 a[140:141], v204 offset:2048
ds_read_b64_tr_b16 a[142:143], v204 offset:2560
s_add_u32 s90, s90, s82
s_lshl_b32 s90, s90, 10
s_lshl_b32 s91, s81, 5
s_lshl_b32 s82, s95, 4
v_mfma_f32_32x32x16_bf16 v[48:63], a[156:159], a[124:127], v[48:63]
ds_read_b64_tr_b16 a[144:145], v201 offset:4096
ds_read_b64_tr_b16 a[146:147], v201 offset:4608
s_add_u32 s91, s91, s82
s_lshl_b32 s91, s91, 10
s_add_u32 s91, s91, 0x560000
v_cvt_pk_bf16_f32 v190, v32, v33
v_cvt_pk_bf16_f32 v191, v34, v35
v_cvt_pk_bf16_f32 v192, v36, v37
v_cvt_pk_bf16_f32 v193, v38, v39
v_cvt_pk_bf16_f32 v194, v40, v41
v_cvt_pk_bf16_f32 v195, v42, v43
v_cvt_pk_bf16_f32 v196, v44, v45
v_cvt_pk_bf16_f32 v197, v46, v47
v_mfma_f32_32x32x16_bf16 v[32:47], a[160:163], v[190:193], 0
v_cvt_pk_bf16_f32 v190, v48, v49
v_mfma_f32_32x32x16_bf16 v[32:47], a[164:167], v[194:197], v[32:47]
v_cvt_pk_bf16_f32 v191, v50, v51
v_cvt_pk_bf16_f32 v192, v52, v53
v_cvt_pk_bf16_f32 v193, v54, v55
v_cvt_pk_bf16_f32 v194, v56, v57
v_cvt_pk_bf16_f32 v195, v58, v59
v_cvt_pk_bf16_f32 v196, v60, v61
v_cvt_pk_bf16_f32 v197, v62, v63
v_mfma_f32_32x32x16_bf16 v[48:63], a[168:171], v[190:193], 0
s_nop 0
v_mfma_f32_32x32x16_bf16 v[48:63], a[172:175], v[194:197], v[48:63]
s_nop 1
v_max3_f32 v184, v32, v33, v34
v_max3_f32 v185, -v32, -v33, -v34
v_max3_f32 v184, v184, v35, v36
v_max3_f32 v185, v185, -v35, -v36
v_max3_f32 v184, v184, v37, v38
v_max3_f32 v185, v185, -v37, -v38
v_max_f32 v184, v184, v39
v_max_f32 v185, v185, -v39
v_max3_f32 v251, v40, v41, v42
v_max3_f32 v252, -v40, -v41, -v42
v_permlane32_swap_b32 v184, v185
v_max_f32 v186, v184, v185
v_mov_b32 v187, v186
v_max3_f32 v251, v251, v43, v44
v_max3_f32 v252, v252, -v43, -v44
v_permlane32_swap_b32 v186, v187
v_mul_f32 v188, v186, v3
v_mul_f32 v189, v187, v3
v_fma_f32 v176, v32, v3, -v188
v_fma_f32 v32, -v32, v3, -v189
v_fma_f32 v177, v33, v3, -v188
v_fma_f32 v33, -v33, v3, -v189
v_fma_f32 v178, v34, v3, -v188
v_fma_f32 v34, -v34, v3, -v189
v_fma_f32 v179, v35, v3, -v188
v_fma_f32 v35, -v35, v3, -v189
v_fma_f32 v180, v36, v3, -v188
v_fma_f32 v36, -v36, v3, -v189
v_fma_f32 v181, v37, v3, -v188
v_fma_f32 v37, -v37, v3, -v189
v_fma_f32 v182, v38, v3, -v188
v_fma_f32 v38, -v38, v3, -v189
v_fma_f32 v183, v39, v3, -v188
v_fma_f32 v39, -v39, v3, -v189
v_exp_f32 v176, v176
v_exp_f32 v32, v32
v_exp_f32 v177, v177
v_exp_f32 v33, v33
v_exp_f32 v178, v178
v_exp_f32 v34, v34
v_exp_f32 v179, v179
v_exp_f32 v35, v35
v_exp_f32 v180, v180
v_exp_f32 v36, v36
v_exp_f32 v181, v181
v_exp_f32 v37, v37
v_exp_f32 v182, v182
v_exp_f32 v38, v38
v_exp_f32 v183, v183
v_exp_f32 v39, v39
v_add_f32 v184, v176, v177
v_add_f32 v185, v32, v33
v_add_f32 v184, v184, v178
v_add_f32 v185, v185, v34
v_add_f32 v184, v184, v179
v_add_f32 v185, v185, v35
v_add_f32 v184, v184, v180
v_add_f32 v185, v185, v36
v_add_f32 v184, v184, v181
v_add_f32 v185, v185, v37
v_add_f32 v184, v184, v182
v_add_f32 v185, v185, v38
v_add_f32 v184, v184, v183
v_add_f32 v185, v185, v39
v_max3_f32 v251, v251, v45, v46
v_max3_f32 v252, v252, -v45, -v46
v_permlane32_swap_b32 v184, v185
v_add_f32 v186, v184, v185
v_mov_b32 v187, v186
v_max_f32 v251, v251, v47
v_max_f32 v252, v252, -v47
v_permlane32_swap_b32 v186, v187
v_rcp_f32 v188, v186
v_rcp_f32 v189, v187
v_mul_f32 v176, v176, v188
v_mul_f32 v32, v32, v189
v_mul_f32 v177, v177, v188
v_mul_f32 v33, v33, v189
v_mul_f32 v178, v178, v188
v_mul_f32 v34, v34, v189
v_mul_f32 v179, v179, v188
v_mul_f32 v35, v35, v189
v_mul_f32 v180, v180, v188
v_mul_f32 v36, v36, v189
v_mul_f32 v181, v181, v188
v_mul_f32 v37, v37, v189
v_mul_f32 v182, v182, v188
v_mul_f32 v38, v38, v189
v_mul_f32 v183, v183, v188
v_mul_f32 v39, v39, v189
v_cvt_pk_bf16_f32 v32, v32, v33
v_cvt_pk_bf16_f32 v33, v34, v35
v_cvt_pk_bf16_f32 v34, v36, v37
v_cvt_pk_bf16_f32 v35, v38, v39
v_cvt_pk_bf16_f32 v36, v176, v177
v_cvt_pk_bf16_f32 v37, v178, v179
v_cvt_pk_bf16_f32 v38, v180, v181
v_cvt_pk_bf16_f32 v39, v182, v183
ds_write_b64 v225, v[36:37] offset:8192
v_permlane32_swap_b32 v251, v252
v_max_f32 v5, v251, v252
v_mov_b32 v6, v5
v_max3_f32 v184, v48, v49, v50
v_max3_f32 v185, -v48, -v49, -v50
v_permlane32_swap_b32 v5, v6
v_mul_f32 v7, v5, v3
v_mul_f32 v23, v6, v3
v_fma_f32 v243, v40, v3, -v7
v_fma_f32 v40, -v40, v3, -v23
v_fma_f32 v244, v41, v3, -v7
v_fma_f32 v41, -v41, v3, -v23
v_fma_f32 v245, v42, v3, -v7
v_fma_f32 v42, -v42, v3, -v23
v_fma_f32 v246, v43, v3, -v7
v_fma_f32 v43, -v43, v3, -v23
v_fma_f32 v247, v44, v3, -v7
v_fma_f32 v44, -v44, v3, -v23
v_fma_f32 v248, v45, v3, -v7
v_fma_f32 v45, -v45, v3, -v23
v_fma_f32 v249, v46, v3, -v7
v_fma_f32 v46, -v46, v3, -v23
v_fma_f32 v250, v47, v3, -v7
v_fma_f32 v47, -v47, v3, -v23
v_exp_f32 v243, v243
v_exp_f32 v40, v40
v_exp_f32 v244, v244
v_exp_f32 v41, v41
v_exp_f32 v245, v245
v_exp_f32 v42, v42
v_exp_f32 v246, v246
v_exp_f32 v43, v43
v_exp_f32 v247, v247
v_exp_f32 v44, v44
v_exp_f32 v248, v248
v_exp_f32 v45, v45
v_exp_f32 v249, v249
v_exp_f32 v46, v46
v_exp_f32 v250, v250
v_exp_f32 v47, v47
v_add_f32 v251, v243, v244
v_add_f32 v252, v40, v41
v_add_f32 v251, v251, v245
v_add_f32 v252, v252, v42
v_add_f32 v251, v251, v246
v_add_f32 v252, v252, v43
v_add_f32 v251, v251, v247
v_add_f32 v252, v252, v44
v_add_f32 v251, v251, v248
v_add_f32 v252, v252, v45
v_add_f32 v251, v251, v249
v_add_f32 v252, v252, v46
v_add_f32 v251, v251, v250
v_add_f32 v252, v252, v47
v_max3_f32 v184, v184, v51, v52
v_max3_f32 v185, v185, -v51, -v52
v_permlane32_swap_b32 v251, v252
v_add_f32 v5, v251, v252
v_mov_b32 v6, v5
v_max3_f32 v184, v184, v53, v54
v_max3_f32 v185, v185, -v53, -v54
v_permlane32_swap_b32 v5, v6
v_rcp_f32 v7, v5
v_rcp_f32 v23, v6
v_mul_f32 v243, v243, v7
v_mul_f32 v40, v40, v23
v_mul_f32 v244, v244, v7
v_mul_f32 v41, v41, v23
v_mul_f32 v245, v245, v7
v_mul_f32 v42, v42, v23
v_mul_f32 v246, v246, v7
v_mul_f32 v43, v43, v23
v_mul_f32 v247, v247, v7
v_mul_f32 v44, v44, v23
v_mul_f32 v248, v248, v7
v_mul_f32 v45, v45, v23
v_mul_f32 v249, v249, v7
v_mul_f32 v46, v46, v23
v_mul_f32 v250, v250, v7
v_mul_f32 v47, v47, v23
v_cvt_pk_bf16_f32 v40, v40, v41
v_cvt_pk_bf16_f32 v41, v42, v43
v_cvt_pk_bf16_f32 v42, v44, v45
v_cvt_pk_bf16_f32 v43, v46, v47
v_cvt_pk_bf16_f32 v44, v243, v244
v_cvt_pk_bf16_f32 v45, v245, v246
v_cvt_pk_bf16_f32 v46, v247, v248
v_cvt_pk_bf16_f32 v47, v249, v250
v_max_f32 v184, v184, v55
v_max_f32 v185, v185, -v55
v_max3_f32 v251, v56, v57, v58
v_max3_f32 v252, -v56, -v57, -v58
v_permlane32_swap_b32 v184, v185
v_max_f32 v186, v184, v185
v_mov_b32 v187, v186
v_max3_f32 v251, v251, v59, v60
v_max3_f32 v252, v252, -v59, -v60
s_waitcnt lgkmcnt(7)
v_mfma_f32_32x32x16_bf16 v[64:79], a[128:131], a[0:3], 0
s_add_u32 m0, s74, 0x1b000
ds_read_b64_tr_b16 a[148:149], v204 offset:4096
ds_read_b64_tr_b16 a[150:151], v204 offset:4608
buffer_load_dwordx4 v217, s[48:51], s77 offen lds
v_mfma_f32_32x32x16_bf16 v[80:95], a[132:135], a[0:3], 0
ds_read_b64_tr_b16 a[152:153], v201 offset:6144
ds_read_b64_tr_b16 a[154:155], v201 offset:6656
ds_write_b64 v226, v[38:39] offset:8192
s_waitcnt lgkmcnt(8)
v_mfma_f32_32x32x16_bf16 v[64:79], a[136:139], a[4:7], v[64:79]
ds_read_b64_tr_b16 a[156:157], v204 offset:6144
ds_read_b64_tr_b16 a[158:159], v204 offset:6656
v_permlane32_swap_b32 v186, v187
v_mul_f32 v188, v186, v3
v_mul_f32 v189, v187, v3
v_fma_f32 v176, v48, v3, -v188
v_mfma_f32_32x32x16_bf16 v[80:95], a[140:143], a[4:7], v[80:95]
s_add_u32 s77, s80, s13
s_add_u32 m0, s74, 0x1c000
ds_read_b64_tr_b16 a[128:129], v201 offset:8192
ds_read_b64_tr_b16 a[130:131], v201 offset:8704
buffer_load_dwordx4 v214, s[44:47], s77 offen lds
s_waitcnt lgkmcnt(7)
v_mfma_f32_32x32x16_bf16 v[64:79], a[144:147], a[8:11], v[64:79]
ds_read_b64_tr_b16 a[132:133], v204 offset:8192
ds_read_b64_tr_b16 a[134:135], v204 offset:8704
ds_write_b64 v225, v[32:33] offset:8320
v_mfma_f32_32x32x16_bf16 v[80:95], a[148:151], a[8:11], v[80:95]
ds_read_b64_tr_b16 a[136:137], v201 offset:10240
ds_read_b64_tr_b16 a[138:139], v201 offset:10752
v_fma_f32 v48, -v48, v3, -v189
v_fma_f32 v177, v49, v3, -v188
v_fma_f32 v49, -v49, v3, -v189
v_fma_f32 v178, v50, v3, -v188
s_waitcnt lgkmcnt(7)
v_mfma_f32_32x32x16_bf16 v[64:79], a[152:155], a[12:15], v[64:79]
s_add_u32 m0, s74, 0x1e000
ds_read_b64_tr_b16 a[140:141], v204 offset:10240
ds_read_b64_tr_b16 a[142:143], v204 offset:10752
buffer_load_dwordx4 v216, s[48:51], s77 offen lds
v_mfma_f32_32x32x16_bf16 v[80:95], a[156:159], a[12:15], v[80:95]
ds_read_b64_tr_b16 a[144:145], v201 offset:12288
ds_read_b64_tr_b16 a[146:147], v201 offset:12800
ds_write_b64 v226, v[34:35] offset:8320
s_waitcnt lgkmcnt(8)
v_mfma_f32_32x32x16_bf16 v[64:79], a[128:131], a[16:19], v[64:79]
ds_read_b64_tr_b16 a[148:149], v204 offset:12288
ds_read_b64_tr_b16 a[150:151], v204 offset:12800
buffer_load_dword v198, v242, s[60:63], 0 offen sc1
v_mfma_f32_32x32x16_bf16 v[80:95], a[132:135], a[16:19], v[80:95]
s_add_u32 m0, s74, 0x1d000
ds_read_b64_tr_b16 a[152:153], v201 offset:14336
ds_read_b64_tr_b16 a[154:155], v201 offset:14848
buffer_load_dwordx4 v215, s[44:47], s77 offen lds
s_waitcnt lgkmcnt(7)
v_mfma_f32_32x32x16_bf16 v[64:79], a[136:139], a[20:23], v[64:79]
ds_read_b64_tr_b16 a[156:157], v204 offset:14336
ds_read_b64_tr_b16 a[158:159], v204 offset:14848
ds_write_b64 v225, v[44:45] offset:16384
v_mfma_f32_32x32x16_bf16 v[80:95], a[140:143], a[20:23], v[80:95]
ds_read_b64_tr_b16 a[128:129], v201 offset:16384
ds_read_b64_tr_b16 a[130:131], v201 offset:16896
v_fma_f32 v50, -v50, v3, -v189
v_fma_f32 v179, v51, v3, -v188
v_fma_f32 v51, -v51, v3, -v189
v_fma_f32 v180, v52, v3, -v188
s_waitcnt lgkmcnt(7)
v_mfma_f32_32x32x16_bf16 v[64:79], a[144:147], a[24:27], v[64:79]
s_add_u32 m0, s74, 0x1f000
ds_read_b64_tr_b16 a[132:133], v204 offset:16384
ds_read_b64_tr_b16 a[134:135], v204 offset:16896
buffer_load_dwordx4 v217, s[48:51], s77 offen lds
v_mfma_f32_32x32x16_bf16 v[80:95], a[148:151], a[24:27], v[80:95]
ds_read_b64_tr_b16 a[136:137], v201 offset:18432
ds_read_b64_tr_b16 a[138:139], v201 offset:18944
ds_write_b64 v226, v[46:47] offset:16384
s_waitcnt lgkmcnt(8)
v_mfma_f32_32x32x16_bf16 v[64:79], a[152:155], a[28:31], v[64:79]
ds_read_b64_tr_b16 a[140:141], v204 offset:18432
ds_read_b64_tr_b16 a[142:143], v204 offset:18944
v_fma_f32 v52, -v52, v3, -v189
v_fma_f32 v181, v53, v3, -v188
v_fma_f32 v53, -v53, v3, -v189
v_fma_f32 v182, v54, v3, -v188
v_mfma_f32_32x32x16_bf16 v[80:95], a[156:159], a[28:31], v[80:95]
s_add_u32 s77, s80, s14
s_add_u32 m0, s74, 0
ds_read_b64_tr_b16 a[144:145], v201 offset:20480
ds_read_b64_tr_b16 a[146:147], v201 offset:20992
buffer_load_dwordx4 v214, s[44:47], s77 offen lds
s_waitcnt lgkmcnt(7)
v_mfma_f32_32x32x16_bf16 v[64:79], a[128:131], a[32:35], v[64:79]
ds_read_b64_tr_b16 a[148:149], v204 offset:20480
ds_read_b64_tr_b16 a[150:151], v204 offset:20992
ds_write_b64 v225, v[40:41] offset:16512
v_mfma_f32_32x32x16_bf16 v[80:95], a[132:135], a[32:35], v[80:95]
ds_read_b64_tr_b16 a[152:153], v201 offset:22528
ds_read_b64_tr_b16 a[154:155], v201 offset:23040
v_fma_f32 v54, -v54, v3, -v189
v_fma_f32 v183, v55, v3, -v188
v_fma_f32 v55, -v55, v3, -v189
v_exp_f32 v176, v176
s_waitcnt lgkmcnt(7)
v_mfma_f32_32x32x16_bf16 v[64:79], a[136:139], a[36:39], v[64:79]
s_add_u32 m0, s74, 0x2000
ds_read_b64_tr_b16 a[156:157], v204 offset:22528
ds_read_b64_tr_b16 a[158:159], v204 offset:23040
buffer_load_dwordx4 v216, s[48:51], s77 offen lds
v_mfma_f32_32x32x16_bf16 v[80:95], a[140:143], a[36:39], v[80:95]
ds_read_b64_tr_b16 a[128:129], v201 offset:24576
ds_read_b64_tr_b16 a[130:131], v201 offset:25088
ds_write_b64 v226, v[42:43] offset:16512
s_waitcnt lgkmcnt(8)
v_mfma_f32_32x32x16_bf16 v[64:79], a[144:147], a[40:43], v[64:79]
ds_read_b64_tr_b16 a[132:133], v204 offset:24576
ds_read_b64_tr_b16 a[134:135], v204 offset:25088
v_exp_f32 v48, v48
v_exp_f32 v177, v177
v_mfma_f32_32x32x16_bf16 v[80:95], a[148:151], a[40:43], v[80:95]
s_add_u32 m0, s74, 0x1000
ds_read_b64_tr_b16 a[136:137], v201 offset:26624
ds_read_b64_tr_b16 a[138:139], v201 offset:27136
buffer_load_dwordx4 v215, s[44:47], s77 offen lds
s_waitcnt lgkmcnt(7)
v_mfma_f32_32x32x16_bf16 v[64:79], a[152:155], a[44:47], v[64:79]
ds_read_b64_tr_b16 a[140:141], v204 offset:26624
ds_read_b64_tr_b16 a[142:143], v204 offset:27136
v_exp_f32 v49, v49
v_exp_f32 v178, v178
v_mfma_f32_32x32x16_bf16 v[80:95], a[156:159], a[44:47], v[80:95]
ds_read_b64_tr_b16 a[144:145], v201 offset:28672
ds_read_b64_tr_b16 a[146:147], v201 offset:29184
v_exp_f32 v50, v50
v_exp_f32 v179, v179
s_waitcnt lgkmcnt(6)
v_mfma_f32_32x32x16_bf16 v[64:79], a[128:131], a[48:51], v[64:79]
s_add_u32 m0, s74, 0x3000
ds_read_b64_tr_b16 a[148:149], v204 offset:28672
ds_read_b64_tr_b16 a[150:151], v204 offset:29184
buffer_load_dwordx4 v217, s[48:51], s77 offen lds
v_mfma_f32_32x32x16_bf16 v[80:95], a[132:135], a[48:51], v[80:95]
ds_read_b64_tr_b16 a[152:153], v201 offset:30720
ds_read_b64_tr_b16 a[154:155], v201 offset:31232
v_exp_f32 v51, v51
v_exp_f32 v180, v180
s_waitcnt lgkmcnt(6)
v_mfma_f32_32x32x16_bf16 v[64:79], a[136:139], a[52:55], v[64:79]
ds_read_b64_tr_b16 a[156:157], v204 offset:30720
ds_read_b64_tr_b16 a[158:159], v204 offset:31232
v_exp_f32 v52, v52
v_exp_f32 v181, v181
v_mfma_f32_32x32x16_bf16 v[80:95], a[140:143], a[52:55], v[80:95]
s_waitcnt vmcnt(13)
s_barrier
s_add_u32 s77, s80, s15
s_add_u32 m0, s74, 0x4000
ds_read_b64_tr_b16 a[128:129], v200 offset:32768
ds_read_b64_tr_b16 a[130:131], v200 offset:33280
buffer_load_dwordx4 v214, s[44:47], s77 offen lds
s_waitcnt lgkmcnt(6)
v_mfma_f32_32x32x16_bf16 v[64:79], a[144:147], a[56:59], v[64:79]
ds_read_b64_tr_b16 a[132:133], v203 offset:32768
ds_read_b64_tr_b16 a[134:135], v203 offset:33280
v_exp_f32 v53, v53
v_exp_f32 v182, v182
v_mfma_f32_32x32x16_bf16 v[80:95], a[148:151], a[56:59], v[80:95]
ds_read_b64_tr_b16 a[136:137], v200 offset:34816
ds_read_b64_tr_b16 a[138:139], v200 offset:35328
v_exp_f32 v54, v54
v_exp_f32 v183, v183
s_waitcnt lgkmcnt(6)
v_mfma_f32_32x32x16_bf16 v[64:79], a[152:155], a[60:63], v[64:79]
s_add_u32 m0, s74, 0x6000
ds_read_b64_tr_b16 a[140:141], v203 offset:34816
ds_read_b64_tr_b16 a[142:143], v203 offset:35328
buffer_load_dwordx4 v216, s[48:51], s77 offen lds
v_mfma_f32_32x32x16_bf16 v[80:95], a[156:159], a[60:63], v[80:95]
ds_read_b64_tr_b16 a[144:145], v200 offset:36864
ds_read_b64_tr_b16 a[146:147], v200 offset:37376
v_exp_f32 v55, v55
v_add_f32 v184, v176, v177
v_add_f32 v185, v48, v49
s_waitcnt lgkmcnt(6)
v_mfma_f32_32x32x16_bf16 v[64:79], a[128:131], a[64:67], v[64:79]
ds_read_b64_tr_b16 a[148:149], v203 offset:36864
ds_read_b64_tr_b16 a[150:151], v203 offset:37376
v_add_f32 v184, v184, v178
v_add_f32 v185, v185, v50
v_add_f32 v184, v184, v179
v_add_f32 v185, v185, v51
v_mfma_f32_32x32x16_bf16 v[80:95], a[132:135], a[64:67], v[80:95]
s_add_u32 m0, s74, 0x5000
ds_read_b64_tr_b16 a[152:153], v200 offset:38912
ds_read_b64_tr_b16 a[154:155], v200 offset:39424
buffer_load_dwordx4 v215, s[44:47], s77 offen lds
s_waitcnt lgkmcnt(6)
v_mfma_f32_32x32x16_bf16 v[64:79], a[136:139], a[68:71], v[64:79]
ds_read_b64_tr_b16 a[156:157], v203 offset:38912
ds_read_b64_tr_b16 a[158:159], v203 offset:39424
v_add_f32 v184, v184, v180
v_add_f32 v185, v185, v52
v_add_f32 v184, v184, v181
v_add_f32 v185, v185, v53
v_mfma_f32_32x32x16_bf16 v[80:95], a[140:143], a[68:71], v[80:95]
ds_read_b64_tr_b16 a[128:129], v200 offset:40960
ds_read_b64_tr_b16 a[130:131], v200 offset:41472
v_add_f32 v184, v184, v182
v_add_f32 v185, v185, v54
v_add_f32 v184, v184, v183
v_add_f32 v185, v185, v55
s_waitcnt lgkmcnt(6)
v_mfma_f32_32x32x16_bf16 v[64:79], a[144:147], a[72:75], v[64:79]
s_add_u32 m0, s74, 0x7000
ds_read_b64_tr_b16 a[132:133], v203 offset:40960
ds_read_b64_tr_b16 a[134:135], v203 offset:41472
buffer_load_dwordx4 v217, s[48:51], s77 offen lds
v_mfma_f32_32x32x16_bf16 v[80:95], a[148:151], a[72:75], v[80:95]
ds_read_b64_tr_b16 a[136:137], v200 offset:43008
ds_read_b64_tr_b16 a[138:139], v200 offset:43520
v_permlane32_swap_b32 v184, v185
v_add_f32 v186, v184, v185
v_mov_b32 v187, v186
v_max3_f32 v251, v251, v61, v62
s_waitcnt lgkmcnt(6)
v_mfma_f32_32x32x16_bf16 v[64:79], a[152:155], a[76:79], v[64:79]
ds_read_b64_tr_b16 a[140:141], v203 offset:43008
ds_read_b64_tr_b16 a[142:143], v203 offset:43520
v_permlane32_swap_b32 v186, v187
v_rcp_f32 v188, v186
v_rcp_f32 v189, v187
v_mfma_f32_32x32x16_bf16 v[80:95], a[156:159], a[76:79], v[80:95]
ds_read_b64_tr_b16 a[144:145], v200 offset:45056
ds_read_b64_tr_b16 a[146:147], v200 offset:45568
v_mul_f32 v176, v176, v188
v_mul_f32 v48, v48, v189
v_mul_f32 v177, v177, v188
v_mul_f32 v49, v49, v189
s_waitcnt lgkmcnt(6)
v_mfma_f32_32x32x16_bf16 v[64:79], a[128:131], a[80:83], v[64:79]
ds_read_b64_tr_b16 a[148:149], v203 offset:45056
ds_read_b64_tr_b16 a[150:151], v203 offset:45568
v_mul_f32 v178, v178, v188
v_mul_f32 v50, v50, v189
v_mul_f32 v179, v179, v188
v_mul_f32 v51, v51, v189
v_mfma_f32_32x32x16_bf16 v[80:95], a[132:135], a[80:83], v[80:95]
ds_read_b64_tr_b16 a[152:153], v200 offset:47104
ds_read_b64_tr_b16 a[154:155], v200 offset:47616
v_mul_f32 v180, v180, v188
v_mul_f32 v52, v52, v189
v_mul_f32 v181, v181, v188
v_mul_f32 v53, v53, v189
s_waitcnt lgkmcnt(6)
v_mfma_f32_32x32x16_bf16 v[64:79], a[136:139], a[84:87], v[64:79]
ds_read_b64_tr_b16 a[156:157], v203 offset:47104
ds_read_b64_tr_b16 a[158:159], v203 offset:47616
v_mul_f32 v182, v182, v188
v_mul_f32 v54, v54, v189
v_mul_f32 v183, v183, v188
v_mul_f32 v55, v55, v189
v_mfma_f32_32x32x16_bf16 v[80:95], a[140:143], a[84:87], v[80:95]
ds_read_b64_tr_b16 a[128:129], v200 offset:49152
ds_read_b64_tr_b16 a[130:131], v200 offset:49664
v_cvt_pk_bf16_f32 v48, v48, v49
v_cvt_pk_bf16_f32 v49, v50, v51
v_cvt_pk_bf16_f32 v50, v52, v53
v_cvt_pk_bf16_f32 v51, v54, v55
s_waitcnt lgkmcnt(6)
v_mfma_f32_32x32x16_bf16 v[64:79], a[144:147], a[88:91], v[64:79]
ds_read_b64_tr_b16 a[132:133], v203 offset:49152
ds_read_b64_tr_b16 a[134:135], v203 offset:49664
v_cvt_pk_bf16_f32 v52, v176, v177
v_cvt_pk_bf16_f32 v53, v178, v179
v_cvt_pk_bf16_f32 v54, v180, v181
v_cvt_pk_bf16_f32 v55, v182, v183
v_mfma_f32_32x32x16_bf16 v[80:95], a[148:151], a[88:91], v[80:95]
ds_read_b64_tr_b16 a[136:137], v200 offset:51200
ds_read_b64_tr_b16 a[138:139], v200 offset:51712
ds_write_b64 v225, v[52:53] offset:24576
s_waitcnt lgkmcnt(7)
v_mfma_f32_32x32x16_bf16 v[64:79], a[152:155], a[92:95], v[64:79]
ds_read_b64_tr_b16 a[140:141], v203 offset:51200
ds_read_b64_tr_b16 a[142:143], v203 offset:51712
v_max3_f32 v252, v252, -v61, -v62
v_max_f32 v251, v251, v63
v_max_f32 v252, v252, -v63
v_mfma_f32_32x32x16_bf16 v[80:95], a[156:159], a[92:95], v[80:95]
ds_read_b64_tr_b16 a[144:145], v200 offset:53248
ds_read_b64_tr_b16 a[146:147], v200 offset:53760
ds_write_b64 v226, v[54:55] offset:24576
s_waitcnt lgkmcnt(8)
v_mfma_f32_32x32x16_bf16 v[64:79], a[128:131], a[96:99], v[64:79]
ds_read_b64_tr_b16 a[148:149], v203 offset:53248
ds_read_b64_tr_b16 a[150:151], v203 offset:53760
v_permlane32_swap_b32 v251, v252
v_max_f32 v5, v251, v252
v_mov_b32 v6, v5
v_mfma_f32_32x32x16_bf16 v[80:95], a[132:135], a[96:99], v[80:95]
ds_read_b64_tr_b16 a[152:153], v200 offset:55296
ds_read_b64_tr_b16 a[154:155], v200 offset:55808
ds_write_b64 v225, v[48:49] offset:24704
s_waitcnt lgkmcnt(8)
v_mfma_f32_32x32x16_bf16 v[64:79], a[136:139], a[100:103], v[64:79]
ds_read_b64_tr_b16 a[156:157], v203 offset:55296
ds_read_b64_tr_b16 a[158:159], v203 offset:55808
v_permlane32_swap_b32 v5, v6
v_mul_f32 v7, v5, v3
v_mul_f32 v23, v6, v3
v_fma_f32 v243, v56, v3, -v7
v_mfma_f32_32x32x16_bf16 v[80:95], a[140:143], a[100:103], v[80:95]
ds_read_b64_tr_b16 a[128:129], v200 offset:57344
ds_read_b64_tr_b16 a[130:131], v200 offset:57856
ds_write_b64 v226, v[50:51] offset:24704
s_waitcnt lgkmcnt(8)
v_mfma_f32_32x32x16_bf16 v[64:79], a[144:147], a[104:107], v[64:79]
ds_read_b64_tr_b16 a[132:133], v203 offset:57344
ds_read_b64_tr_b16 a[134:135], v203 offset:57856
v_fma_f32 v56, -v56, v3, -v23
v_fma_f32 v244, v57, v3, -v7
v_fma_f32 v57, -v57, v3, -v23
v_fma_f32 v245, v58, v3, -v7
v_mfma_f32_32x32x16_bf16 v[80:95], a[148:151], a[104:107], v[80:95]
ds_read_b64_tr_b16 a[136:137], v200 offset:59392
ds_read_b64_tr_b16 a[138:139], v200 offset:59904
v_fma_f32 v58, -v58, v3, -v23
v_fma_f32 v246, v59, v3, -v7
v_fma_f32 v59, -v59, v3, -v23
v_fma_f32 v247, v60, v3, -v7
s_waitcnt lgkmcnt(7)
v_mfma_f32_32x32x16_bf16 v[64:79], a[152:155], a[108:111], v[64:79]
ds_read_b64_tr_b16 a[140:141], v203 offset:59392
ds_read_b64_tr_b16 a[142:143], v203 offset:59904
v_fma_f32 v60, -v60, v3, -v23
v_fma_f32 v248, v61, v3, -v7
v_fma_f32 v61, -v61, v3, -v23
v_fma_f32 v249, v62, v3, -v7
v_mfma_f32_32x32x16_bf16 v[80:95], a[156:159], a[108:111], v[80:95]
ds_read_b64_tr_b16 a[144:145], v200 offset:61440
ds_read_b64_tr_b16 a[146:147], v200 offset:61952
v_fma_f32 v62, -v62, v3, -v23
v_fma_f32 v250, v63, v3, -v7
v_fma_f32 v63, -v63, v3, -v23
v_exp_f32 v243, v243
s_waitcnt lgkmcnt(6)
v_mfma_f32_32x32x16_bf16 v[64:79], a[128:131], a[112:115], v[64:79]
ds_read_b64_tr_b16 a[148:149], v203 offset:61440
ds_read_b64_tr_b16 a[150:151], v203 offset:61952
v_exp_f32 v56, v56
v_exp_f32 v244, v244
v_mfma_f32_32x32x16_bf16 v[80:95], a[132:135], a[112:115], v[80:95]
ds_read_b64_tr_b16 a[152:153], v200 offset:63488
ds_read_b64_tr_b16 a[154:155], v200 offset:64000
v_exp_f32 v57, v57
v_exp_f32 v245, v245
s_waitcnt lgkmcnt(6)
v_mfma_f32_32x32x16_bf16 v[64:79], a[136:139], a[116:119], v[64:79]
ds_read_b64_tr_b16 a[156:157], v203 offset:63488
ds_read_b64_tr_b16 a[158:159], v203 offset:64000
v_exp_f32 v58, v58
v_exp_f32 v246, v246
v_mfma_f32_32x32x16_bf16 v[80:95], a[140:143], a[116:119], v[80:95]
s_waitcnt vmcnt(8)
s_barrier
s_add_u32 s77, s80, s16
s_add_u32 m0, s74, 0x10000
ds_read_b64_tr_b16 a[128:129], v207 offset:32768
ds_read_b64_tr_b16 a[130:131], v207 offset:33280
buffer_load_dwordx4 v214, s[44:47], s77 offen lds
s_waitcnt lgkmcnt(6)
v_mfma_f32_32x32x16_bf16 v[64:79], a[144:147], a[120:123], v[64:79]
ds_read_b64_tr_b16 a[132:133], v209 offset:32768
ds_read_b64_tr_b16 a[134:135], v209 offset:33280
v_exp_f32 v59, v59
v_exp_f32 v247, v247
v_mfma_f32_32x32x16_bf16 v[80:95], a[148:151], a[120:123], v[80:95]
ds_read_b64_tr_b16 a[136:137], v211 offset:32768
ds_read_b64_tr_b16 a[138:139], v211 offset:33280
v_exp_f32 v60, v60
v_exp_f32 v248, v248
s_waitcnt lgkmcnt(6)
v_mfma_f32_32x32x16_bf16 v[64:79], a[152:155], a[124:127], v[64:79]
s_add_u32 m0, s74, 0x12000
ds_read_b64_tr_b16 a[140:141], v213 offset:32768
ds_read_b64_tr_b16 a[142:143], v213 offset:33280
buffer_load_dwordx4 v216, s[48:51], s77 offen lds
v_mfma_f32_32x32x16_bf16 v[80:95], a[156:159], a[124:127], v[80:95]
ds_read_b64_tr_b16 a[144:145], v207 offset:34816
ds_read_b64_tr_b16 a[146:147], v207 offset:35328
v_exp_f32 v61, v61
v_exp_f32 v249, v249
s_waitcnt lgkmcnt(6)
v_mfma_f32_32x32x16_bf16 v[96:111], a[128:131], a[0:3], 0
ds_read_b64_tr_b16 a[148:149], v209 offset:34816
ds_read_b64_tr_b16 a[150:151], v209 offset:35328
v_exp_f32 v62, v62
v_exp_f32 v250, v250
v_mfma_f32_32x32x16_bf16 v[112:127], a[132:135], a[0:3], 0
s_add_u32 m0, s74, 0x11000
ds_read_b64_tr_b16 a[152:153], v211 offset:34816
ds_read_b64_tr_b16 a[154:155], v211 offset:35328
buffer_load_dwordx4 v215, s[44:47], s77 offen lds
s_waitcnt lgkmcnt(6)
v_mfma_f32_32x32x16_bf16 v[128:143], a[136:139], a[0:3], 0
ds_read_b64_tr_b16 a[156:157], v213 offset:34816
ds_read_b64_tr_b16 a[158:159], v213 offset:35328
v_exp_f32 v63, v63
v_add_f32 v251, v243, v244
v_add_f32 v252, v56, v57
v_mfma_f32_32x32x16_bf16 v[144:159], a[140:143], a[0:3], 0
ds_read_b64_tr_b16 a[128:129], v207 offset:36864
ds_read_b64_tr_b16 a[130:131], v207 offset:37376
v_add_f32 v251, v251, v245
v_add_f32 v252, v252, v58
v_add_f32 v251, v251, v246
v_add_f32 v252, v252, v59
s_waitcnt lgkmcnt(6)
v_mfma_f32_32x32x16_bf16 v[96:111], a[144:147], a[4:7], v[96:111]
s_add_u32 m0, s74, 0x13000
ds_read_b64_tr_b16 a[132:133], v209 offset:36864
ds_read_b64_tr_b16 a[134:135], v209 offset:37376
buffer_load_dwordx4 v217, s[48:51], s77 offen lds
v_mfma_f32_32x32x16_bf16 v[112:127], a[148:151], a[4:7], v[112:127]
ds_read_b64_tr_b16 a[136:137], v211 offset:36864
ds_read_b64_tr_b16 a[138:139], v211 offset:37376
v_add_f32 v251, v251, v247
v_add_f32 v252, v252, v60
v_add_f32 v251, v251, v248
v_add_f32 v252, v252, v61
s_waitcnt lgkmcnt(6)
v_mfma_f32_32x32x16_bf16 v[128:143], a[152:155], a[4:7], v[128:143]
ds_read_b64_tr_b16 a[140:141], v213 offset:36864
ds_read_b64_tr_b16 a[142:143], v213 offset:37376
v_add_f32 v251, v251, v249
v_add_f32 v252, v252, v62
v_add_f32 v251, v251, v250
v_add_f32 v252, v252, v63
v_mfma_f32_32x32x16_bf16 v[144:159], a[156:159], a[4:7], v[144:159]
s_add_u32 s77, s80, s17
s_add_u32 m0, s74, 0x14000
ds_read_b64_tr_b16 a[144:145], v207 offset:38912
ds_read_b64_tr_b16 a[146:147], v207 offset:39424
buffer_load_dwordx4 v214, s[44:47], s77 offen lds
s_waitcnt lgkmcnt(6)
v_mfma_f32_32x32x16_bf16 v[96:111], a[128:131], a[8:11], v[96:111]
ds_read_b64_tr_b16 a[148:149], v209 offset:38912
ds_read_b64_tr_b16 a[150:151], v209 offset:39424
v_permlane32_swap_b32 v251, v252
v_add_f32 v5, v251, v252
v_mov_b32 v6, v5
v_mul_f32 v64, v64, v2
v_mfma_f32_32x32x16_bf16 v[112:127], a[132:135], a[8:11], v[112:127]
ds_read_b64_tr_b16 a[152:153], v211 offset:38912
ds_read_b64_tr_b16 a[154:155], v211 offset:39424
v_permlane32_swap_b32 v5, v6
v_rcp_f32 v7, v5
v_rcp_f32 v23, v6
s_waitcnt lgkmcnt(6)
v_mfma_f32_32x32x16_bf16 v[128:143], a[136:139], a[8:11], v[128:143]
s_add_u32 m0, s74, 0x16000
ds_read_b64_tr_b16 a[156:157], v213 offset:38912
ds_read_b64_tr_b16 a[158:159], v213 offset:39424
buffer_load_dwordx4 v216, s[48:51], s77 offen lds
v_mfma_f32_32x32x16_bf16 v[144:159], a[140:143], a[8:11], v[144:159]
ds_read_b64_tr_b16 a[128:129], v207 offset:49152
ds_read_b64_tr_b16 a[130:131], v207 offset:49664
v_mul_f32 v243, v243, v7
v_mul_f32 v56, v56, v23
v_mul_f32 v244, v244, v7
v_mul_f32 v57, v57, v23
s_waitcnt lgkmcnt(6)
v_mfma_f32_32x32x16_bf16 v[96:111], a[144:147], a[12:15], v[96:111]
ds_read_b64_tr_b16 a[132:133], v209 offset:49152
ds_read_b64_tr_b16 a[134:135], v209 offset:49664
v_mul_f32 v245, v245, v7
v_mul_f32 v58, v58, v23
v_mul_f32 v246, v246, v7
v_mul_f32 v59, v59, v23
v_mfma_f32_32x32x16_bf16 v[112:127], a[148:151], a[12:15], v[112:127]
s_add_u32 m0, s74, 0x15000
ds_read_b64_tr_b16 a[136:137], v211 offset:49152
ds_read_b64_tr_b16 a[138:139], v211 offset:49664
buffer_load_dwordx4 v215, s[44:47], s77 offen lds
s_waitcnt lgkmcnt(6)
v_mfma_f32_32x32x16_bf16 v[128:143], a[152:155], a[12:15], v[128:143]
ds_read_b64_tr_b16 a[140:141], v213 offset:49152
ds_read_b64_tr_b16 a[142:143], v213 offset:49664
v_mul_f32 v247, v247, v7
v_mul_f32 v60, v60, v23
v_mul_f32 v248, v248, v7
v_mul_f32 v61, v61, v23
v_mfma_f32_32x32x16_bf16 v[144:159], a[156:159], a[12:15], v[144:159]
ds_read_b64_tr_b16 a[144:145], v207 offset:51200
ds_read_b64_tr_b16 a[146:147], v207 offset:51712
v_mul_f32 v249, v249, v7
v_mul_f32 v62, v62, v23
v_mul_f32 v250, v250, v7
v_mul_f32 v63, v63, v23
s_waitcnt lgkmcnt(6)
v_mfma_f32_32x32x16_bf16 v[96:111], a[128:131], a[16:19], v[96:111]
s_add_u32 m0, s74, 0x17000
ds_read_b64_tr_b16 a[148:149], v209 offset:51200
ds_read_b64_tr_b16 a[150:151], v209 offset:51712
buffer_load_dwordx4 v217, s[48:51], s77 offen lds
v_mfma_f32_32x32x16_bf16 v[112:127], a[132:135], a[16:19], v[112:127]
ds_read_b64_tr_b16 a[152:153], v211 offset:51200
ds_read_b64_tr_b16 a[154:155], v211 offset:51712
v_cvt_pk_bf16_f32 v56, v56, v57
v_cvt_pk_bf16_f32 v57, v58, v59
v_cvt_pk_bf16_f32 v58, v60, v61
v_cvt_pk_bf16_f32 v59, v62, v63
s_waitcnt lgkmcnt(6)
v_mfma_f32_32x32x16_bf16 v[128:143], a[136:139], a[16:19], v[128:143]
ds_read_b64_tr_b16 a[156:157], v213 offset:51200
ds_read_b64_tr_b16 a[158:159], v213 offset:51712
v_cvt_pk_bf16_f32 v60, v243, v244
v_cvt_pk_bf16_f32 v61, v245, v246
v_cvt_pk_bf16_f32 v62, v247, v248
v_cvt_pk_bf16_f32 v63, v249, v250
v_mfma_f32_32x32x16_bf16 v[144:159], a[140:143], a[16:19], v[144:159]
ds_read_b64_tr_b16 a[128:129], v207 offset:53248
ds_read_b64_tr_b16 a[130:131], v207 offset:53760
ds_write_b64 v225, v[60:61] offset:0
s_waitcnt lgkmcnt(7)
v_mfma_f32_32x32x16_bf16 v[96:111], a[144:147], a[20:23], v[96:111]
ds_read_b64_tr_b16 a[132:133], v209 offset:53248
ds_read_b64_tr_b16 a[134:135], v209 offset:53760
v_mul_f32 v65, v65, v2
v_mul_f32 v66, v66, v2
v_mul_f32 v67, v67, v2
v_mul_f32 v68, v68, v2
v_mfma_f32_32x32x16_bf16 v[112:127], a[148:151], a[20:23], v[112:127]
ds_read_b64_tr_b16 a[136:137], v211 offset:53248
ds_read_b64_tr_b16 a[138:139], v211 offset:53760
ds_write_b64 v226, v[62:63] offset:0
s_waitcnt lgkmcnt(8)
v_mfma_f32_32x32x16_bf16 v[128:143], a[152:155], a[20:23], v[128:143]
ds_read_b64_tr_b16 a[140:141], v213 offset:53248
ds_read_b64_tr_b16 a[142:143], v213 offset:53760
v_mul_f32 v69, v69, v2
v_mul_f32 v70, v70, v2
v_mul_f32 v71, v71, v2
v_mul_f32 v72, v72, v2
v_mfma_f32_32x32x16_bf16 v[144:159], a[156:159], a[20:23], v[144:159]
ds_read_b64_tr_b16 a[144:145], v207 offset:55296
ds_read_b64_tr_b16 a[146:147], v207 offset:55808
ds_write_b64 v225, v[56:57] offset:128
s_waitcnt lgkmcnt(8)
v_mfma_f32_32x32x16_bf16 v[96:111], a[128:131], a[24:27], v[96:111]
ds_read_b64_tr_b16 a[148:149], v209 offset:55296
ds_read_b64_tr_b16 a[150:151], v209 offset:55808
v_mul_f32 v73, v73, v2
v_mul_f32 v74, v74, v2
v_mul_f32 v75, v75, v2
v_mul_f32 v76, v76, v2
v_mfma_f32_32x32x16_bf16 v[112:127], a[132:135], a[24:27], v[112:127]
ds_read_b64_tr_b16 a[152:153], v211 offset:55296
ds_read_b64_tr_b16 a[154:155], v211 offset:55808
ds_write_b64 v226, v[58:59] offset:128
s_waitcnt lgkmcnt(8)
v_mfma_f32_32x32x16_bf16 v[128:143], a[136:139], a[24:27], v[128:143]
ds_read_b64_tr_b16 a[156:157], v213 offset:55296
ds_read_b64_tr_b16 a[158:159], v213 offset:55808
v_mul_f32 v77, v77, v2
v_mul_f32 v78, v78, v2
v_mul_f32 v79, v79, v2
v_cvt_pk_bf16_f32 v64, v64, v65
v_mfma_f32_32x32x16_bf16 v[144:159], a[140:143], a[24:27], v[144:159]
s_waitcnt vmcnt(8)
s_barrier
s_add_u32 s77, s80, s18
s_add_u32 m0, s74, 0x18000
ds_read_b64_tr_b16 a[128:129], v206 offset:0
ds_read_b64_tr_b16 a[130:131], v206 offset:512
buffer_load_dwordx4 v214, s[44:47], s77 offen lds
s_waitcnt lgkmcnt(7)
v_mfma_f32_32x32x16_bf16 v[96:111], a[144:147], a[28:31], v[96:111]
ds_read_b64_tr_b16 a[132:133], v208 offset:0
ds_read_b64_tr_b16 a[134:135], v208 offset:512
v_cvt_pk_bf16_f32 v65, v66, v67
v_cvt_pk_bf16_f32 v66, v68, v69
v_cvt_pk_bf16_f32 v67, v70, v71
v_cvt_pk_bf16_f32 v68, v72, v73
v_mfma_f32_32x32x16_bf16 v[112:127], a[148:151], a[28:31], v[112:127]
ds_read_b64_tr_b16 a[136:137], v210 offset:0
ds_read_b64_tr_b16 a[138:139], v210 offset:512
v_cvt_pk_bf16_f32 v69, v74, v75
v_cvt_pk_bf16_f32 v70, v76, v77
v_cvt_pk_bf16_f32 v71, v78, v79
v_mul_f32 v80, v80, v2
s_waitcnt lgkmcnt(6)
v_mfma_f32_32x32x16_bf16 v[128:143], a[152:155], a[28:31], v[128:143]
s_add_u32 m0, s74, 0x1a000
ds_read_b64_tr_b16 a[140:141], v212 offset:0
ds_read_b64_tr_b16 a[142:143], v212 offset:512
buffer_load_dwordx4 v216, s[48:51], s77 offen lds
v_mfma_f32_32x32x16_bf16 v[144:159], a[156:159], a[28:31], v[144:159]
ds_read_b64_tr_b16 a[144:145], v206 offset:2048
ds_read_b64_tr_b16 a[146:147], v206 offset:2560
v_mul_f32 v81, v81, v2
v_mul_f32 v82, v82, v2
v_mul_f32 v83, v83, v2
v_mul_f32 v84, v84, v2
s_waitcnt lgkmcnt(6)
v_mfma_f32_32x32x16_bf16 v[96:111], a[128:131], a[32:35], v[96:111]
ds_read_b64_tr_b16 a[148:149], v208 offset:2048
ds_read_b64_tr_b16 a[150:151], v208 offset:2560
v_mul_f32 v85, v85, v2
v_mul_f32 v86, v86, v2
v_mul_f32 v87, v87, v2
v_mul_f32 v88, v88, v2
v_mfma_f32_32x32x16_bf16 v[112:127], a[132:135], a[32:35], v[112:127]
s_add_u32 m0, s74, 0x19000
ds_read_b64_tr_b16 a[152:153], v210 offset:2048
ds_read_b64_tr_b16 a[154:155], v210 offset:2560
buffer_load_dwordx4 v215, s[44:47], s77 offen lds
s_waitcnt lgkmcnt(6)
v_mfma_f32_32x32x16_bf16 v[128:143], a[136:139], a[32:35], v[128:143]
ds_read_b64_tr_b16 a[156:157], v212 offset:2048
ds_read_b64_tr_b16 a[158:159], v212 offset:2560
v_mul_f32 v89, v89, v2
v_mul_f32 v90, v90, v2
v_mul_f32 v91, v91, v2
v_mul_f32 v92, v92, v2
v_mfma_f32_32x32x16_bf16 v[144:159], a[140:143], a[32:35], v[144:159]
ds_read_b64_tr_b16 a[128:129], v206 offset:4096
ds_read_b64_tr_b16 a[130:131], v206 offset:4608
v_mul_f32 v93, v93, v2
v_mul_f32 v94, v94, v2
v_mul_f32 v95, v95, v2
v_cvt_pk_bf16_f32 v80, v80, v81
s_waitcnt lgkmcnt(6)
v_mfma_f32_32x32x16_bf16 v[96:111], a[144:147], a[36:39], v[96:111]
s_add_u32 m0, s74, 0x1b000
ds_read_b64_tr_b16 a[132:133], v208 offset:4096
ds_read_b64_tr_b16 a[134:135], v208 offset:4608
buffer_load_dwordx4 v217, s[48:51], s77 offen lds
v_mfma_f32_32x32x16_bf16 v[112:127], a[148:151], a[36:39], v[112:127]
ds_read_b64_tr_b16 a[136:137], v210 offset:4096
ds_read_b64_tr_b16 a[138:139], v210 offset:4608
v_cvt_pk_bf16_f32 v81, v82, v83
v_cvt_pk_bf16_f32 v82, v84, v85
v_cvt_pk_bf16_f32 v83, v86, v87
v_cvt_pk_bf16_f32 v84, v88, v89
s_waitcnt lgkmcnt(6)
v_mfma_f32_32x32x16_bf16 v[128:143], a[152:155], a[36:39], v[128:143]
ds_read_b64_tr_b16 a[140:141], v212 offset:4096
ds_read_b64_tr_b16 a[142:143], v212 offset:4608
v_cvt_pk_bf16_f32 v85, v90, v91
v_cvt_pk_bf16_f32 v86, v92, v93
v_cvt_pk_bf16_f32 v87, v94, v95
v_mov_b32 v190, 0x3f803f80
v_mfma_f32_32x32x16_bf16 v[144:159], a[156:159], a[36:39], v[144:159]
ds_read_b64_tr_b16 a[144:145], v206 offset:6144
ds_read_b64_tr_b16 a[146:147], v206 offset:6656
s_barrier
v_mov_b32 v191, 0
s_waitcnt lgkmcnt(6)
v_mfma_f32_32x32x16_bf16 v[96:111], a[128:131], a[40:43], v[96:111]
ds_read_b64_tr_b16 a[148:149], v208 offset:6144
ds_read_b64_tr_b16 a[150:151], v208 offset:6656
ds_write_b32 v220, v190 offset:0
v_mfma_f32_32x32x16_bf16 v[112:127], a[132:135], a[40:43], v[112:127]
ds_read_b64_tr_b16 a[152:153], v210 offset:6144
ds_read_b64_tr_b16 a[154:155], v210 offset:6656
v_lshlrev_b32 v190, 2, v1
s_waitcnt lgkmcnt(7)
v_mfma_f32_32x32x16_bf16 v[128:143], a[136:139], a[40:43], v[128:143]
ds_read_b64_tr_b16 a[156:157], v212 offset:6144
ds_read_b64_tr_b16 a[158:159], v212 offset:6656
ds_write_b64 v229, v[64:65] offset:0
v_mfma_f32_32x32x16_bf16 v[144:159], a[140:143], a[40:43], v[144:159]
ds_read_b64_tr_b16 a[128:129], v206 offset:16384
ds_read_b64_tr_b16 a[130:131], v206 offset:16896
v_readfirstlane_b32 s83, v198
s_nop 3
s_cmp_ge_u32 s83, 16
s_cbranch_scc1 L_gateok_14
s_mov_b32 s84, 0
L_poll_15:
buffer_load_dword v198, v242, s[60:63], 0 offen sc1
s_waitcnt vmcnt(0)
v_readfirstlane_b32 s81, v198
s_nop 3
s_cmp_ge_u32 s81, 16
s_cbranch_scc1 L_pdone_16
s_add_u32 s84, s84, 1
s_cmp_lt_u32 s84, 0x30d40
s_cbranch_scc1 L_poll_15
L_pdone_16:
L_gateok_14:
s_waitcnt lgkmcnt(8)
v_mfma_f32_32x32x16_bf16 v[96:111], a[144:147], a[44:47], v[96:111]
ds_read_b64_tr_b16 a[132:133], v208 offset:16384
ds_read_b64_tr_b16 a[134:135], v208 offset:16896
s_lshr_b32 s0, s2, 3
s_lshl_b32 s0, s0, 2
s_add_u32 s0, s0, s68
s_mul_i32 s27, s0, 0x2b00
v_lshlrev_b32 v16, 7, v1
buffer_load_dword v254, v16, s[52:55], s27 offen
v_mfma_f32_32x32x16_bf16 v[112:127], a[148:151], a[44:47], v[112:127]
ds_read_b64_tr_b16 a[136:137], v210 offset:16384
ds_read_b64_tr_b16 a[138:139], v210 offset:16896
ds_write_b64 v230, v[66:67] offset:0
s_waitcnt lgkmcnt(8)
v_mfma_f32_32x32x16_bf16 v[128:143], a[152:155], a[44:47], v[128:143]
ds_read_b64_tr_b16 a[140:141], v212 offset:16384
ds_read_b64_tr_b16 a[142:143], v212 offset:16896
v_mfma_f32_32x32x16_bf16 v[144:159], a[156:159], a[44:47], v[144:159]
ds_read_b64_tr_b16 a[144:145], v206 offset:18432
ds_read_b64_tr_b16 a[146:147], v206 offset:18944
ds_write_b64 v229, v[68:69] offset:128
s_waitcnt lgkmcnt(8)
v_mfma_f32_32x32x16_bf16 v[96:111], a[128:131], a[48:51], v[96:111]
ds_read_b64_tr_b16 a[148:149], v208 offset:18432
ds_read_b64_tr_b16 a[150:151], v208 offset:18944
s_add_u32 s27, s27, 0x2000
v_min_u32 v17, 21, v1
v_lshlrev_b32 v17, 7, v17
buffer_load_dword v255, v17, s[52:55], s27 offen
v_mfma_f32_32x32x16_bf16 v[112:127], a[132:135], a[48:51], v[112:127]
ds_read_b64_tr_b16 a[152:153], v210 offset:18432
ds_read_b64_tr_b16 a[154:155], v210 offset:18944
ds_write_b64 v230, v[70:71] offset:128
s_waitcnt lgkmcnt(8)
v_mfma_f32_32x32x16_bf16 v[128:143], a[136:139], a[48:51], v[128:143]
ds_read_b64_tr_b16 a[156:157], v212 offset:18432
ds_read_b64_tr_b16 a[158:159], v212 offset:18944
v_mfma_f32_32x32x16_bf16 v[144:159], a[140:143], a[48:51], v[144:159]
ds_read_b64_tr_b16 a[128:129], v206 offset:20480
ds_read_b64_tr_b16 a[130:131], v206 offset:20992
ds_write_b64 v229, v[80:81] offset:8704
s_waitcnt lgkmcnt(8)
v_mfma_f32_32x32x16_bf16 v[96:111], a[144:147], a[52:55], v[96:111]
ds_read_b64_tr_b16 a[132:133], v208 offset:20480
ds_read_b64_tr_b16 a[134:135], v208 offset:20992
s_lshl_b32 s27, s0, 12
v_and_b32 v17, 31, v1
v_lshlrev_b32 v17, 7, v17
buffer_load_dword v254, v17, s[40:43], s27 offen
v_mfma_f32_32x32x16_bf16 v[112:127], a[148:151], a[52:55], v[112:127]
ds_read_b64_tr_b16 a[136:137], v210 offset:20480
ds_read_b64_tr_b16 a[138:139], v210 offset:20992
ds_write_b64 v230, v[82:83] offset:8704
s_waitcnt lgkmcnt(8)
v_mfma_f32_32x32x16_bf16 v[128:143], a[152:155], a[52:55], v[128:143]
ds_read_b64_tr_b16 a[140:141], v212 offset:20480
ds_read_b64_tr_b16 a[142:143], v212 offset:20992
v_mfma_f32_32x32x16_bf16 v[144:159], a[156:159], a[52:55], v[144:159]
ds_read_b64_tr_b16 a[144:145], v206 offset:22528
ds_read_b64_tr_b16 a[146:147], v206 offset:23040
ds_write_b64 v229, v[84:85] offset:8832
s_waitcnt lgkmcnt(8)
v_mfma_f32_32x32x16_bf16 v[96:111], a[128:131], a[56:59], v[96:111]
ds_read_b64_tr_b16 a[148:149], v208 offset:22528
ds_read_b64_tr_b16 a[150:151], v208 offset:23040
v_mfma_f32_32x32x16_bf16 v[112:127], a[132:135], a[56:59], v[112:127]
ds_read_b64_tr_b16 a[152:153], v210 offset:22528
ds_read_b64_tr_b16 a[154:155], v210 offset:23040
ds_write_b64 v230, v[86:87] offset:8832
s_waitcnt lgkmcnt(8)
v_mfma_f32_32x32x16_bf16 v[128:143], a[136:139], a[56:59], v[128:143]
ds_read_b64_tr_b16 a[156:157], v212 offset:22528
ds_read_b64_tr_b16 a[158:159], v212 offset:23040
s_waitcnt lgkmcnt(0)
s_barrier
ds_read_b64_tr_b16 a[176:177], v221 offset:0
ds_read_b64_tr_b16 a[178:179], v222 offset:0
v_mfma_f32_32x32x16_bf16 v[144:159], a[140:143], a[56:59], v[144:159]
s_waitcnt vmcnt(7)
s_barrier
s_add_u32 s77, s80, s19
s_add_u32 m0, s74, 0x1c000
ds_read_b64_tr_b16 a[128:129], v207 offset:0
ds_read_b64_tr_b16 a[130:131], v207 offset:512
buffer_load_dwordx4 v214, s[44:47], s77 offen lds
v_mfma_f32_32x32x16_bf16 v[96:111], a[144:147], a[60:63], v[96:111]
ds_read_b64_tr_b16 a[132:133], v209 offset:0
ds_read_b64_tr_b16 a[134:135], v209 offset:512
ds_read_b64_tr_b16 a[180:181], v223 offset:0
ds_read_b64_tr_b16 a[182:183], v224 offset:0
ds_read_b64_tr_b16 a[184:185], v221 offset:1024
ds_read_b64_tr_b16 a[186:187], v222 offset:1024
v_mfma_f32_32x32x16_bf16 v[112:127], a[148:151], a[60:63], v[112:127]
ds_read_b64_tr_b16 a[136:137], v211 offset:0
ds_read_b64_tr_b16 a[138:139], v211 offset:512
ds_read_b64_tr_b16 a[188:189], v223 offset:1088
ds_read_b64_tr_b16 a[190:191], v224 offset:1088
ds_read_b64_tr_b16 a[192:193], v221 offset:2048
ds_read_b64_tr_b16 a[194:195], v222 offset:2048
v_mfma_f32_32x32x16_bf16 v[128:143], a[152:155], a[60:63], v[128:143]
s_add_u32 m0, s74, 0x1e000
ds_read_b64_tr_b16 a[140:141], v213 offset:0
ds_read_b64_tr_b16 a[142:143], v213 offset:512
buffer_load_dwordx4 v216, s[48:51], s77 offen lds
v_mfma_f32_32x32x16_bf16 v[144:159], a[156:159], a[60:63], v[144:159]
ds_read_b64_tr_b16 a[144:145], v207 offset:2048
ds_read_b64_tr_b16 a[146:147], v207 offset:2560
ds_read_b64_tr_b16 a[196:197], v223 offset:2176
ds_read_b64_tr_b16 a[198:199], v224 offset:2176
ds_read_b64_tr_b16 a[200:201], v221 offset:3072
ds_read_b64_tr_b16 a[202:203], v222 offset:3072
s_waitcnt lgkmcnt(15)
v_mfma_f32_32x32x16_bf16 v[96:111], a[128:131], a[64:67], v[96:111]
ds_read_b64_tr_b16 a[148:149], v209 offset:2048
ds_read_b64_tr_b16 a[150:151], v209 offset:2560
ds_read_b64_tr_b16 a[204:205], v223 offset:3264
ds_read_b64_tr_b16 a[206:207], v224 offset:3264
v_mfma_f32_32x32x16_bf16 v[160:175], a[176:179], a[180:183], 0
ds_read_b64_tr_b16 a[176:177], v221 offset:4096
ds_read_b64_tr_b16 a[178:179], v222 offset:4096
ds_read_b64_tr_b16 a[180:181], v223 offset:4352
ds_read_b64_tr_b16 a[182:183], v224 offset:4352
s_waitcnt lgkmcnt(15)
v_mfma_f32_32x32x16_bf16 v[160:175], a[184:187], a[188:191], v[160:175]
ds_read_b64_tr_b16 a[184:185], v221 offset:5120
ds_read_b64_tr_b16 a[186:187], v222 offset:5120
ds_read_b64_tr_b16 a[188:189], v223 offset:5440
ds_read_b64_tr_b16 a[190:191], v224 offset:5440
s_waitcnt lgkmcnt(14)
v_mfma_f32_32x32x16_bf16 v[160:175], a[192:195], a[196:199], v[160:175]
ds_read_b64_tr_b16 a[192:193], v221 offset:6144
ds_read_b64_tr_b16 a[194:195], v222 offset:6144
ds_read_b64_tr_b16 a[196:197], v223 offset:6528
ds_read_b64_tr_b16 a[198:199], v224 offset:6528
s_waitcnt lgkmcnt(12)
v_mfma_f32_32x32x16_bf16 v[160:175], a[200:203], a[204:207], v[160:175]
ds_read_b64_tr_b16 a[200:201], v221 offset:7168
ds_read_b64_tr_b16 a[202:203], v222 offset:7168
ds_read_b64_tr_b16 a[204:205], v223 offset:7616
ds_read_b64_tr_b16 a[206:207], v224 offset:7616
s_waitcnt lgkmcnt(12)
v_mfma_f32_32x32x16_bf16 v[160:175], a[176:179], a[180:183], v[160:175]
s_waitcnt lgkmcnt(8)
v_mfma_f32_32x32x16_bf16 v[160:175], a[184:187], a[188:191], v[160:175]
s_waitcnt lgkmcnt(4)
v_mfma_f32_32x32x16_bf16 v[160:175], a[192:195], a[196:199], v[160:175]
s_waitcnt lgkmcnt(0)
v_mfma_f32_32x32x16_bf16 v[160:175], a[200:203], a[204:207], v[160:175]
s_lshl_b32 s92, s70, 2
s_add_u32 s92, s92, s68
s_lshl_b32 s92, s92, 12
s_add_u32 s92, s92, 0x760000
s_mov_b32 s100, 0x10001
v_mfma_f32_32x32x16_bf16 v[112:127], a[132:135], a[64:67], v[112:127]
s_add_u32 m0, s74, 0x1d000
ds_read_b64_tr_b16 a[152:153], v211 offset:2048
ds_read_b64_tr_b16 a[154:155], v211 offset:2560
buffer_load_dwordx4 v215, s[44:47], s77 offen lds
v_mfma_f32_32x32x16_bf16 v[128:143], a[136:139], a[64:67], v[128:143]
ds_read_b64_tr_b16 a[156:157], v213 offset:2048
ds_read_b64_tr_b16 a[158:159], v213 offset:2560
s_mov_b32 s101, 0x10001
v_permlane16_swap_b32 v160, v161
v_cndmask_b32 v191, v191, v161, s[100:101]
s_lshl_b64 s[100:101], s[100:101], 1
v_mfma_f32_32x32x16_bf16 v[144:159], a[140:143], a[64:67], v[144:159]
ds_read_b64_tr_b16 a[128:129], v207 offset:4096
ds_read_b64_tr_b16 a[130:131], v207 offset:4608
v_permlane16_swap_b32 v162, v163
v_cndmask_b32 v191, v191, v163, s[100:101]
s_lshl_b64 s[100:101], s[100:101], 1
v_permlane16_swap_b32 v164, v165
v_mfma_f32_32x32x16_bf16 v[96:111], a[144:147], a[68:71], v[96:111]
s_add_u32 m0, s74, 0x1f000
ds_read_b64_tr_b16 a[132:133], v209 offset:4096
ds_read_b64_tr_b16 a[134:135], v209 offset:4608
buffer_load_dwordx4 v217, s[48:51], s77 offen lds
v_mfma_f32_32x32x16_bf16 v[112:127], a[148:151], a[68:71], v[112:127]
ds_read_b64_tr_b16 a[136:137], v211 offset:4096
ds_read_b64_tr_b16 a[138:139], v211 offset:4608
v_cndmask_b32 v191, v191, v165, s[100:101]
s_lshl_b64 s[100:101], s[100:101], 1
v_permlane16_swap_b32 v166, v167
v_cndmask_b32 v191, v191, v167, s[100:101]
s_waitcnt lgkmcnt(6)
v_mfma_f32_32x32x16_bf16 v[128:143], a[152:155], a[68:71], v[128:143]
ds_read_b64_tr_b16 a[140:141], v213 offset:4096
ds_read_b64_tr_b16 a[142:143], v213 offset:4608
s_lshl_b64 s[100:101], s[100:101], 1
v_permlane16_swap_b32 v168, v169
v_cndmask_b32 v191, v191, v169, s[100:101]
s_lshl_b64 s[100:101], s[100:101], 1
v_mfma_f32_32x32x16_bf16 v[144:159], a[156:159], a[68:71], v[144:159]
ds_read_b64_tr_b16 a[144:145], v207 offset:6144
ds_read_b64_tr_b16 a[146:147], v207 offset:6656
v_permlane16_swap_b32 v170, v171
v_cndmask_b32 v191, v191, v171, s[100:101]
s_lshl_b64 s[100:101], s[100:101], 1
v_permlane16_swap_b32 v172, v173
s_waitcnt lgkmcnt(6)
v_mfma_f32_32x32x16_bf16 v[96:111], a[128:131], a[72:75], v[96:111]
ds_read_b64_tr_b16 a[148:149], v209 offset:6144
ds_read_b64_tr_b16 a[150:151], v209 offset:6656
v_cndmask_b32 v191, v191, v173, s[100:101]
s_lshl_b64 s[100:101], s[100:101], 1
v_permlane16_swap_b32 v174, v175
v_cndmask_b32 v191, v191, v175, s[100:101]
v_mfma_f32_32x32x16_bf16 v[112:127], a[132:135], a[72:75], v[112:127]
ds_read_b64_tr_b16 a[152:153], v211 offset:6144
ds_read_b64_tr_b16 a[154:155], v211 offset:6656
buffer_atomic_add_f32 v160, v190, s[64:67], s92 offen offset:0 sc1
s_waitcnt lgkmcnt(6)
v_mfma_f32_32x32x16_bf16 v[128:143], a[136:139], a[72:75], v[128:143]
ds_read_b64_tr_b16 a[156:157], v213 offset:6144
ds_read_b64_tr_b16 a[158:159], v213 offset:6656
v_mfma_f32_32x32x16_bf16 v[144:159], a[140:143], a[72:75], v[144:159]
ds_read_b64_tr_b16 a[128:129], v207 offset:16384
ds_read_b64_tr_b16 a[130:131], v207 offset:16896
buffer_atomic_add_f32 v162, v190, s[64:67], s92 offen offset:256 sc1
s_waitcnt lgkmcnt(6)
v_mfma_f32_32x32x16_bf16 v[96:111], a[144:147], a[76:79], v[96:111]
ds_read_b64_tr_b16 a[132:133], v209 offset:16384
ds_read_b64_tr_b16 a[134:135], v209 offset:16896
v_mfma_f32_32x32x16_bf16 v[112:127], a[148:151], a[76:79], v[112:127]
ds_read_b64_tr_b16 a[136:137], v211 offset:16384
ds_read_b64_tr_b16 a[138:139], v211 offset:16896
buffer_atomic_add_f32 v164, v190, s[64:67], s92 offen offset:512 sc1
s_waitcnt lgkmcnt(6)
v_mfma_f32_32x32x16_bf16 v[128:143], a[152:155], a[76:79], v[128:143]
ds_read_b64_tr_b16 a[140:141], v213 offset:16384
ds_read_b64_tr_b16 a[142:143], v213 offset:16896
v_mfma_f32_32x32x16_bf16 v[144:159], a[156:159], a[76:79], v[144:159]
ds_read_b64_tr_b16 a[144:145], v207 offset:18432
ds_read_b64_tr_b16 a[146:147], v207 offset:18944
buffer_atomic_add_f32 v166, v190, s[64:67], s92 offen offset:768 sc1
s_waitcnt lgkmcnt(6)
v_mfma_f32_32x32x16_bf16 v[96:111], a[128:131], a[80:83], v[96:111]
ds_read_b64_tr_b16 a[148:149], v209 offset:18432
ds_read_b64_tr_b16 a[150:151], v209 offset:18944
v_mfma_f32_32x32x16_bf16 v[112:127], a[132:135], a[80:83], v[112:127]
ds_read_b64_tr_b16 a[152:153], v211 offset:18432
ds_read_b64_tr_b16 a[154:155], v211 offset:18944
buffer_atomic_add_f32 v168, v190, s[64:67], s92 offen offset:1024 sc1
s_waitcnt lgkmcnt(6)
v_mfma_f32_32x32x16_bf16 v[128:143], a[136:139], a[80:83], v[128:143]
ds_read_b64_tr_b16 a[156:157], v213 offset:18432
ds_read_b64_tr_b16 a[158:159], v213 offset:18944
v_mfma_f32_32x32x16_bf16 v[144:159], a[140:143], a[80:83], v[144:159]
ds_read_b64_tr_b16 a[128:129], v207 offset:20480
ds_read_b64_tr_b16 a[130:131], v207 offset:20992
buffer_atomic_add_f32 v170, v190, s[64:67], s92 offen offset:1280 sc1
s_waitcnt lgkmcnt(6)
v_mfma_f32_32x32x16_bf16 v[96:111], a[144:147], a[84:87], v[96:111]
ds_read_b64_tr_b16 a[132:133], v209 offset:20480
ds_read_b64_tr_b16 a[134:135], v209 offset:20992
v_mfma_f32_32x32x16_bf16 v[112:127], a[148:151], a[84:87], v[112:127]
ds_read_b64_tr_b16 a[136:137], v211 offset:20480
ds_read_b64_tr_b16 a[138:139], v211 offset:20992
buffer_atomic_add_f32 v172, v190, s[64:67], s92 offen offset:1536 sc1
s_waitcnt lgkmcnt(6)
v_mfma_f32_32x32x16_bf16 v[128:143], a[152:155], a[84:87], v[128:143]
ds_read_b64_tr_b16 a[140:141], v213 offset:20480
ds_read_b64_tr_b16 a[142:143], v213 offset:20992
v_mfma_f32_32x32x16_bf16 v[144:159], a[156:159], a[84:87], v[144:159]
ds_read_b64_tr_b16 a[144:145], v207 offset:22528
ds_read_b64_tr_b16 a[146:147], v207 offset:23040
buffer_atomic_add_f32 v174, v190, s[64:67], s92 offen offset:1792 sc1
s_waitcnt lgkmcnt(6)
v_mfma_f32_32x32x16_bf16 v[96:111], a[128:131], a[88:91], v[96:111]
ds_read_b64_tr_b16 a[148:149], v209 offset:22528
ds_read_b64_tr_b16 a[150:151], v209 offset:23040
v_mfma_f32_32x32x16_bf16 v[112:127], a[132:135], a[88:91], v[112:127]
ds_read_b64_tr_b16 a[152:153], v211 offset:22528
ds_read_b64_tr_b16 a[154:155], v211 offset:23040
buffer_atomic_add_f32 v191, v190, s[64:67], s92 offen offset:2048 sc1
s_waitcnt lgkmcnt(6)
v_mfma_f32_32x32x16_bf16 v[128:143], a[136:139], a[88:91], v[128:143]
ds_read_b64_tr_b16 a[156:157], v213 offset:22528
ds_read_b64_tr_b16 a[158:159], v213 offset:23040
v_mfma_f32_32x32x16_bf16 v[144:159], a[140:143], a[88:91], v[144:159]
s_waitcnt vmcnt(9)
s_barrier
ds_read_b64_tr_b16 a[128:129], v207 offset:32768
ds_read_b64_tr_b16 a[130:131], v207 offset:33280
s_waitcnt lgkmcnt(6)
v_mfma_f32_32x32x16_bf16 v[96:111], a[144:147], a[92:95], v[96:111]
ds_read_b64_tr_b16 a[132:133], v209 offset:32768
ds_read_b64_tr_b16 a[134:135], v209 offset:33280
s_add_u32 s98, s88, 0x90000
s_add_u32 m0, s94, 0
s_nop 0
buffer_load_dwordx4 v233, s[52:55], s98 offen lds
v_mfma_f32_32x32x16_bf16 v[112:127], a[148:151], a[92:95], v[112:127]
ds_read_b64_tr_b16 a[136:137], v211 offset:32768
ds_read_b64_tr_b16 a[138:139], v211 offset:33280
s_and_b32 s26, s69, 3
s_lshl_b32 s26, s26, 1
s_add_u32 s26, s26, s73
s_cmp_ge_u32 s26, 9
s_cselect_b32 s25, 9, 0
s_waitcnt lgkmcnt(6)
v_mfma_f32_32x32x16_bf16 v[128:143], a[152:155], a[92:95], v[128:143]
ds_read_b64_tr_b16 a[140:141], v213 offset:32768
ds_read_b64_tr_b16 a[142:143], v213 offset:33280
s_add_u32 m0, s94, 0x400
s_nop 0
buffer_load_dwordx4 v234, s[52:55], s98 offen lds
v_mfma_f32_32x32x16_bf16 v[144:159], a[156:159], a[92:95], v[144:159]
ds_read_b64_tr_b16 a[144:145], v207 offset:34816
ds_read_b64_tr_b16 a[146:147], v207 offset:35328
s_sub_u32 s26, s26, s25
s_add_u32 s20, s26, 0
s_cmp_ge_u32 s20, 9
s_cselect_b32 s25, 9, 0
s_waitcnt lgkmcnt(6)
v_mfma_f32_32x32x16_bf16 v[96:111], a[128:131], a[96:99], v[96:111]
ds_read_b64_tr_b16 a[148:149], v209 offset:34816
ds_read_b64_tr_b16 a[150:151], v209 offset:35328
s_add_u32 s98, s88, 0x13c000
s_add_u32 m0, s94, 0x2000
s_nop 0
buffer_load_dwordx4 v233, s[52:55], s98 offen lds
v_mfma_f32_32x32x16_bf16 v[112:127], a[132:135], a[96:99], v[112:127]
ds_read_b64_tr_b16 a[152:153], v211 offset:34816
ds_read_b64_tr_b16 a[154:155], v211 offset:35328
s_sub_u32 s20, s20, s25
s_lshl_b32 s25, s20, 16
s_add_u32 s4, s88, s25
s_lshl_b32 s25, s20, 12
s_waitcnt lgkmcnt(6)
v_mfma_f32_32x32x16_bf16 v[128:143], a[136:139], a[96:99], v[128:143]
ds_read_b64_tr_b16 a[156:157], v213 offset:34816
ds_read_b64_tr_b16 a[158:159], v213 offset:35328
s_add_u32 m0, s94, 0x2400
s_nop 0
buffer_load_dwordx4 v234, s[52:55], s98 offen lds
v_mfma_f32_32x32x16_bf16 v[144:159], a[140:143], a[96:99], v[144:159]
ds_read_b64_tr_b16 a[128:129], v207 offset:36864
ds_read_b64_tr_b16 a[130:131], v207 offset:37376
s_add_u32 s13, s90, s25
s_add_u32 s20, s26, 1
s_cmp_ge_u32 s20, 9
s_cselect_b32 s25, 9, 0
s_waitcnt lgkmcnt(6)
v_mfma_f32_32x32x16_bf16 v[96:111], a[144:147], a[100:103], v[96:111]
ds_read_b64_tr_b16 a[132:133], v209 offset:36864
ds_read_b64_tr_b16 a[134:135], v209 offset:37376
s_add_u32 s98, s88, 0xa0000
s_add_u32 m0, s94, 0x4000
s_nop 0
buffer_load_dwordx4 v233, s[52:55], s98 offen lds
v_mfma_f32_32x32x16_bf16 v[112:127], a[148:151], a[100:103], v[112:127]
ds_read_b64_tr_b16 a[136:137], v211 offset:36864
ds_read_b64_tr_b16 a[138:139], v211 offset:37376
s_sub_u32 s20, s20, s25
s_lshl_b32 s25, s20, 16
s_add_u32 s5, s88, s25
s_lshl_b32 s25, s20, 12
s_waitcnt lgkmcnt(6)
v_mfma_f32_32x32x16_bf16 v[128:143], a[152:155], a[100:103], v[128:143]
ds_read_b64_tr_b16 a[140:141], v213 offset:36864
ds_read_b64_tr_b16 a[142:143], v213 offset:37376
s_add_u32 m0, s94, 0x4400
s_nop 0
buffer_load_dwordx4 v234, s[52:55], s98 offen lds
v_mfma_f32_32x32x16_bf16 v[144:159], a[156:159], a[100:103], v[144:159]
ds_read_b64_tr_b16 a[144:145], v207 offset:38912
ds_read_b64_tr_b16 a[146:147], v207 offset:39424
s_add_u32 s14, s90, s25
s_add_u32 s20, s26, 2
s_cmp_ge_u32 s20, 9
s_cselect_b32 s25, 9, 0
s_waitcnt lgkmcnt(6)
v_mfma_f32_32x32x16_bf16 v[96:111], a[128:131], a[104:107], v[96:111]
ds_read_b64_tr_b16 a[148:149], v209 offset:38912
ds_read_b64_tr_b16 a[150:151], v209 offset:39424
s_add_u32 s98, s88, 0x14c000
s_add_u32 m0, s94, 0x6000
s_nop 0
buffer_load_dwordx4 v233, s[52:55], s98 offen lds
v_mfma_f32_32x32x16_bf16 v[112:127], a[132:135], a[104:107], v[112:127]
ds_read_b64_tr_b16 a[152:153], v211 offset:38912
ds_read_b64_tr_b16 a[154:155], v211 offset:39424
s_sub_u32 s20, s20, s25
s_lshl_b32 s25, s20, 16
s_add_u32 s6, s88, s25
s_lshl_b32 s25, s20, 12
s_waitcnt lgkmcnt(6)
v_mfma_f32_32x32x16_bf16 v[128:143], a[136:139], a[104:107], v[128:143]
ds_read_b64_tr_b16 a[156:157], v213 offset:38912
ds_read_b64_tr_b16 a[158:159], v213 offset:39424
s_add_u32 m0, s94, 0x6400
s_nop 0
buffer_load_dwordx4 v234, s[52:55], s98 offen lds
v_mfma_f32_32x32x16_bf16 v[144:159], a[140:143], a[104:107], v[144:159]
ds_read_b64_tr_b16 a[128:129], v207 offset:49152
ds_read_b64_tr_b16 a[130:131], v207 offset:49664
s_add_u32 s15, s90, s25
s_add_u32 s20, s26, 3
s_cmp_ge_u32 s20, 9
s_cselect_b32 s25, 9, 0
s_waitcnt lgkmcnt(6)
v_mfma_f32_32x32x16_bf16 v[96:111], a[144:147], a[108:111], v[96:111]
ds_read_b64_tr_b16 a[132:133], v209 offset:49152
ds_read_b64_tr_b16 a[134:135], v209 offset:49664
s_add_u32 s98, s88, 0
s_add_u32 m0, s94, 0x8000
s_nop 0
buffer_load_dwordx4 v233, s[40:43], s98 offen lds
v_mfma_f32_32x32x16_bf16 v[112:127], a[148:151], a[108:111], v[112:127]
ds_read_b64_tr_b16 a[136:137], v211 offset:49152
ds_read_b64_tr_b16 a[138:139], v211 offset:49664
s_sub_u32 s20, s20, s25
s_lshl_b32 s25, s20, 16
s_add_u32 s7, s88, s25
s_lshl_b32 s25, s20, 12
s_waitcnt lgkmcnt(6)
v_mfma_f32_32x32x16_bf16 v[128:143], a[152:155], a[108:111], v[128:143]
ds_read_b64_tr_b16 a[140:141], v213 offset:49152
ds_read_b64_tr_b16 a[142:143], v213 offset:49664
s_add_u32 m0, s94, 0x8400
s_nop 0
buffer_load_dwordx4 v234, s[40:43], s98 offen lds
v_mfma_f32_32x32x16_bf16 v[144:159], a[156:159], a[108:111], v[144:159]
ds_read_b64_tr_b16 a[144:145], v207 offset:51200
ds_read_b64_tr_b16 a[146:147], v207 offset:51712
s_add_u32 s16, s90, s25
s_add_u32 s20, s26, 4
s_cmp_ge_u32 s20, 9
s_cselect_b32 s25, 9, 0
s_waitcnt lgkmcnt(6)
v_mfma_f32_32x32x16_bf16 v[96:111], a[128:131], a[112:115], v[96:111]
ds_read_b64_tr_b16 a[148:149], v209 offset:51200
ds_read_b64_tr_b16 a[150:151], v209 offset:51712
s_add_u32 s98, s88, 0x40000
s_add_u32 m0, s94, 0xa000
s_nop 0
buffer_load_dwordx4 v233, s[40:43], s98 offen lds
v_mfma_f32_32x32x16_bf16 v[112:127], a[132:135], a[112:115], v[112:127]
ds_read_b64_tr_b16 a[152:153], v211 offset:51200
ds_read_b64_tr_b16 a[154:155], v211 offset:51712
s_sub_u32 s20, s20, s25
s_lshl_b32 s25, s20, 16
s_add_u32 s8, s88, s25
s_lshl_b32 s25, s20, 12
s_waitcnt lgkmcnt(6)
v_mfma_f32_32x32x16_bf16 v[128:143], a[136:139], a[112:115], v[128:143]
ds_read_b64_tr_b16 a[156:157], v213 offset:51200
ds_read_b64_tr_b16 a[158:159], v213 offset:51712
s_add_u32 m0, s94, 0xa400
s_nop 0
buffer_load_dwordx4 v234, s[40:43], s98 offen lds
v_mfma_f32_32x32x16_bf16 v[144:159], a[140:143], a[112:115], v[144:159]
ds_read_b64_tr_b16 a[128:129], v207 offset:53248
ds_read_b64_tr_b16 a[130:131], v207 offset:53760
s_add_u32 s17, s90, s25
s_add_u32 s20, s26, 5
s_cmp_ge_u32 s20, 9
s_cselect_b32 s25, 9, 0
s_waitcnt lgkmcnt(6)
v_mfma_f32_32x32x16_bf16 v[96:111], a[144:147], a[116:119], v[96:111]
ds_read_b64_tr_b16 a[132:133], v209 offset:53248
ds_read_b64_tr_b16 a[134:135], v209 offset:53760
s_add_u32 s98, s88, 0x10000
s_add_u32 m0, s94, 0xc000
s_nop 0
buffer_load_dwordx4 v233, s[40:43], s98 offen lds
v_mfma_f32_32x32x16_bf16 v[112:127], a[148:151], a[116:119], v[112:127]
ds_read_b64_tr_b16 a[136:137], v211 offset:53248
ds_read_b64_tr_b16 a[138:139], v211 offset:53760
s_sub_u32 s20, s20, s25
s_lshl_b32 s25, s20, 16
s_add_u32 s9, s88, s25
s_lshl_b32 s25, s20, 12
s_waitcnt lgkmcnt(6)
v_mfma_f32_32x32x16_bf16 v[128:143], a[152:155], a[116:119], v[128:143]
ds_read_b64_tr_b16 a[140:141], v213 offset:53248
ds_read_b64_tr_b16 a[142:143], v213 offset:53760
s_add_u32 m0, s94, 0xc400
s_nop 0
buffer_load_dwordx4 v234, s[40:43], s98 offen lds
v_mfma_f32_32x32x16_bf16 v[144:159], a[156:159], a[116:119], v[144:159]
ds_read_b64_tr_b16 a[144:145], v207 offset:55296
ds_read_b64_tr_b16 a[146:147], v207 offset:55808
s_add_u32 s18, s90, s25
s_add_u32 s20, s26, 6
s_cmp_ge_u32 s20, 9
s_cselect_b32 s25, 9, 0
s_waitcnt lgkmcnt(6)
v_mfma_f32_32x32x16_bf16 v[96:111], a[128:131], a[120:123], v[96:111]
ds_read_b64_tr_b16 a[148:149], v209 offset:55296
ds_read_b64_tr_b16 a[150:151], v209 offset:55808
s_add_u32 s98, s88, 0x50000
s_add_u32 m0, s94, 0xe000
s_nop 0
buffer_load_dwordx4 v233, s[40:43], s98 offen lds
v_mfma_f32_32x32x16_bf16 v[112:127], a[132:135], a[120:123], v[112:127]
ds_read_b64_tr_b16 a[152:153], v211 offset:55296
ds_read_b64_tr_b16 a[154:155], v211 offset:55808
s_sub_u32 s20, s20, s25
s_lshl_b32 s25, s20, 16
s_add_u32 s10, s88, s25
s_lshl_b32 s25, s20, 12
s_waitcnt lgkmcnt(6)
v_mfma_f32_32x32x16_bf16 v[128:143], a[136:139], a[120:123], v[128:143]
ds_read_b64_tr_b16 a[156:157], v213 offset:55296
ds_read_b64_tr_b16 a[158:159], v213 offset:55808
s_add_u32 m0, s94, 0xe400
s_nop 0
buffer_load_dwordx4 v234, s[40:43], s98 offen lds
v_mfma_f32_32x32x16_bf16 v[144:159], a[140:143], a[120:123], v[144:159]
s_add_u32 s19, s90, s25
s_add_u32 s20, s26, 7
s_cmp_ge_u32 s20, 9
s_cselect_b32 s25, 9, 0
s_sub_u32 s20, s20, s25
s_lshl_b32 s25, s20, 16
s_waitcnt lgkmcnt(4)
v_mfma_f32_32x32x16_bf16 v[96:111], a[144:147], a[124:127], v[96:111]
s_add_u32 s98, s88, 0x20000
s_add_u32 m0, s94, 0x20000
s_nop 0
buffer_load_dwordx4 v233, s[40:43], s98 offen lds
v_mfma_f32_32x32x16_bf16 v[112:127], a[148:151], a[124:127], v[112:127]
s_add_u32 s11, s88, s25
s_lshl_b32 s25, s20, 12
s_add_u32 s0, s90, s25
s_add_u32 s20, s26, 8
s_cmp_ge_u32 s20, 9
s_cselect_b32 s25, 9, 0
s_waitcnt lgkmcnt(0)
v_mfma_f32_32x32x16_bf16 v[128:143], a[152:155], a[124:127], v[128:143]
s_add_u32 m0, s94, 0x20400
s_nop 0
buffer_load_dwordx4 v234, s[40:43], s98 offen lds
v_mfma_f32_32x32x16_bf16 v[144:159], a[156:159], a[124:127], v[144:159]
s_sub_u32 s20, s20, s25
s_lshl_b32 s25, s20, 16
s_add_u32 s12, s88, s25
s_lshl_b32 s25, s20, 12
s_add_u32 s1, s90, s25
s_add_u32 s98, s88, 0x60000
s_add_u32 m0, s94, 0x22000
s_nop 0
buffer_load_dwordx4 v233, s[40:43], s98 offen lds
s_add_u32 m0, s94, 0x22400
s_nop 0
buffer_load_dwordx4 v234, s[40:43], s98 offen lds
s_add_u32 s98, s88, 0x30000
s_add_u32 m0, s94, 0x24000
s_nop 0
buffer_load_dwordx4 v233, s[40:43], s98 offen lds
s_add_u32 m0, s94, 0x24400
s_nop 0
buffer_load_dwordx4 v234, s[40:43], s98 offen lds
s_add_u32 s98, s88, 0x70000
s_add_u32 m0, s94, 0x26000
s_nop 0
buffer_load_dwordx4 v233, s[40:43], s98 offen lds
s_add_u32 m0, s94, 0x26400
s_nop 0
buffer_load_dwordx4 v234, s[40:43], s98 offen lds
s_waitcnt vmcnt(24)
s_barrier
s_lshl_b32 s82, s70, 7
s_add_u32 s82, s82, 0x781000
s_cmp_lg_u32 s68, 0
s_cbranch_scc1 L_noflag_17
s_mov_b64 exec, 1
v_mov_b32 v8, 0
v_mov_b32 v9, 1
buffer_atomic_add v9, v8, s[64:67], s82 offen sc1
s_mov_b64 exec, -1
L_noflag_17:
v_max_f32 v96, 0, v96
v_max_f32 v97, 0, v97
v_max_f32 v98, 0, v98
v_max_f32 v99, 0, v99
v_max_f32 v100, 0, v100
v_max_f32 v101, 0, v101
v_max_f32 v102, 0, v102
v_max_f32 v103, 0, v103
v_mul_f32 v96, v96, v104
v_mul_f32 v97, v97, v105
v_mul_f32 v98, v98, v106
v_mul_f32 v99, v99, v107
v_mul_f32 v100, v100, v108
v_mul_f32 v101, v101, v109
v_mul_f32 v102, v102, v110
v_mul_f32 v103, v103, v111
v_cvt_pk_bf16_f32 v176, v96, v97
v_cvt_pk_bf16_f32 v177, v98, v99
v_cvt_pk_bf16_f32 v178, v100, v101
v_cvt_pk_bf16_f32 v179, v102, v103
buffer_store_dwordx4 v[176:179], v241, s[64:67], s85 offen sc1
v_max_f32 v112, 0, v112
v_max_f32 v113, 0, v113
v_max_f32 v114, 0, v114
v_max_f32 v115, 0, v115
v_max_f32 v116, 0, v116
v_max_f32 v117, 0, v117
v_max_f32 v118, 0, v118
v_max_f32 v119, 0, v119
v_mul_f32 v112, v112, v120
v_mul_f32 v113, v113, v121
v_mul_f32 v114, v114, v122
v_mul_f32 v115, v115, v123
v_mul_f32 v116, v116, v124
v_mul_f32 v117, v117, v125
v_mul_f32 v118, v118, v126
v_mul_f32 v119, v119, v127
v_cvt_pk_bf16_f32 v180, v112, v113
v_cvt_pk_bf16_f32 v181, v114, v115
v_cvt_pk_bf16_f32 v182, v116, v117
v_cvt_pk_bf16_f32 v183, v118, v119
buffer_store_dwordx4 v[180:183], v241, s[64:67], s85 offen offset:1024 sc1
v_max_f32 v128, 0, v128
v_max_f32 v129, 0, v129
v_max_f32 v130, 0, v130
v_max_f32 v131, 0, v131
v_max_f32 v132, 0, v132
v_max_f32 v133, 0, v133
v_max_f32 v134, 0, v134
v_max_f32 v135, 0, v135
v_mul_f32 v128, v128, v136
v_mul_f32 v129, v129, v137
v_mul_f32 v130, v130, v138
v_mul_f32 v131, v131, v139
v_mul_f32 v132, v132, v140
v_mul_f32 v133, v133, v141
v_mul_f32 v134, v134, v142
v_mul_f32 v135, v135, v143
v_cvt_pk_bf16_f32 v176, v128, v129
v_cvt_pk_bf16_f32 v177, v130, v131
v_cvt_pk_bf16_f32 v178, v132, v133
v_cvt_pk_bf16_f32 v179, v134, v135
buffer_store_dwordx4 v[176:179], v241, s[64:67], s85 offen offset:2048 sc1
v_max_f32 v144, 0, v144
v_max_f32 v145, 0, v145
v_max_f32 v146, 0, v146
v_max_f32 v147, 0, v147
v_max_f32 v148, 0, v148
v_max_f32 v149, 0, v149
v_max_f32 v150, 0, v150
v_max_f32 v151, 0, v151
v_mul_f32 v144, v144, v152
v_mul_f32 v145, v145, v153
v_mul_f32 v146, v146, v154
v_mul_f32 v147, v147, v155
v_mul_f32 v148, v148, v156
v_mul_f32 v149, v149, v157
v_mul_f32 v150, v150, v158
v_mul_f32 v151, v151, v159
v_cvt_pk_bf16_f32 v180, v144, v145
v_cvt_pk_bf16_f32 v181, v146, v147
v_cvt_pk_bf16_f32 v182, v148, v149
v_cvt_pk_bf16_f32 v183, v150, v151
buffer_store_dwordx4 v[180:183], v241, s[64:67], s85 offen offset:3072 sc1
s_waitcnt vmcnt(0)
s_barrier
s_lshl_b32 s82, s69, 7
s_add_u32 s82, s82, 0x780000
s_cmp_lg_u32 s68, 0
s_cbranch_scc1 L_noflag_18
s_mov_b64 exec, 1
v_mov_b32 v8, 0
v_mov_b32 v9, 1
buffer_atomic_add v9, v8, s[64:67], s82 offen sc1
s_mov_b64 exec, -1
L_noflag_18:
ds_read_b64_tr_b16 v[140:141], v235 offset:0
ds_read_b64_tr_b16 v[142:143], v235 offset:1024
s_add_u32 s78, s8, 0
s_add_u32 m0, s94, 0x10000
ds_read_b64_tr_b16 v[144:145], v238 offset:0
buffer_load_dwordx4 v233, s[52:55], s78 offen lds
ds_read_b64_tr_b16 v[146:147], v238 offset:1024
ds_read_b64_tr_b16 v[148:149], v235 offset:2048
ds_read_b64_tr_b16 v[150:151], v235 offset:3072
ds_read_b64_tr_b16 v[152:153], v238 offset:2048
s_add_u32 m0, s94, 0x10400
ds_read_b64_tr_b16 v[154:155], v238 offset:3072
buffer_load_dwordx4 v234, s[52:55], s78 offen lds
ds_read_b64_tr_b16 v[156:157], v235 offset:4096
ds_read_b64_tr_b16 v[158:159], v235 offset:5120
ds_read_b64_tr_b16 v[160:161], v238 offset:4096
ds_read_b64_tr_b16 v[162:163], v238 offset:5120
s_add_u32 s78, s8, 0xac000
s_add_u32 m0, s94, 0x12000
ds_read_b64_tr_b16 v[164:165], v235 offset:6144
buffer_load_dwordx4 v233, s[52:55], s78 offen lds
ds_read_b64_tr_b16 v[166:167], v235 offset:7168
ds_read_b64_tr_b16 v[168:169], v238 offset:6144
ds_read_b64_tr_b16 v[170:171], v238 offset:7168
ds_read_b64_tr_b16 v[172:173], v235 offset:16384
s_add_u32 m0, s94, 0x12400
ds_read_b64_tr_b16 v[174:175], v235 offset:17408
buffer_load_dwordx4 v234, s[52:55], s78 offen lds
ds_read_b64_tr_b16 v[176:177], v238 offset:16384
ds_read_b64_tr_b16 v[178:179], v238 offset:17408
ds_read_b64_tr_b16 v[180:181], v235 offset:18432
ds_read_b64_tr_b16 v[182:183], v235 offset:19456
s_add_u32 s78, s9, 0
s_add_u32 m0, s94, 0x14000
ds_read_b64_tr_b16 v[184:185], v238 offset:18432
buffer_load_dwordx4 v233, s[52:55], s78 offen lds
ds_read_b64_tr_b16 v[186:187], v238 offset:19456
ds_read_b64_tr_b16 v[188:189], v235 offset:20480
ds_read_b64_tr_b16 v[190:191], v235 offset:21504
ds_read_b64_tr_b16 v[192:193], v238 offset:20480
s_add_u32 m0, s94, 0x14400
ds_read_b64_tr_b16 v[194:195], v238 offset:21504
buffer_load_dwordx4 v234, s[52:55], s78 offen lds
ds_read_b64_tr_b16 a[160:161], v235 offset:32768
ds_read_b64_tr_b16 a[162:163], v235 offset:33792
ds_read_b64_tr_b16 a[164:165], v238 offset:32768
ds_read_b64_tr_b16 a[166:167], v238 offset:33792
s_add_u32 s78, s9, 0xac000
s_add_u32 m0, s94, 0x16000
ds_read_b64_tr_b16 a[168:169], v235 offset:34816
buffer_load_dwordx4 v233, s[52:55], s78 offen lds
ds_read_b64_tr_b16 a[170:171], v235 offset:35840
ds_read_b64_tr_b16 a[172:173], v238 offset:34816
ds_read_b64_tr_b16 a[174:175], v238 offset:35840
ds_read_b64_tr_b16 a[176:177], v235 offset:36864
s_add_u32 m0, s94, 0x16400
ds_read_b64_tr_b16 a[178:179], v235 offset:37888
buffer_load_dwordx4 v234, s[52:55], s78 offen lds
ds_read_b64_tr_b16 a[180:181], v238 offset:36864
ds_read_b64_tr_b16 a[182:183], v238 offset:37888
ds_read_b64_tr_b16 a[184:185], v235 offset:38912
ds_read_b64_tr_b16 a[186:187], v235 offset:39936
s_add_u32 s78, s10, 0
s_add_u32 m0, s94, 0x18000
ds_read_b64_tr_b16 a[188:189], v238 offset:38912
buffer_load_dwordx4 v233, s[52:55], s78 offen lds
ds_read_b64_tr_b16 a[190:191], v238 offset:39936
ds_read_b64_tr_b16 a[192:193], v235 offset:49152
ds_read_b64_tr_b16 a[194:195], v235 offset:50176
ds_read_b64_tr_b16 a[196:197], v238 offset:49152
s_add_u32 m0, s94, 0x18400
ds_read_b64_tr_b16 a[198:199], v238 offset:50176
buffer_load_dwordx4 v234, s[52:55], s78 offen lds
ds_read_b64_tr_b16 a[200:201], v235 offset:51200
ds_read_b64_tr_b16 a[202:203], v235 offset:52224
ds_read_b64_tr_b16 a[204:205], v238 offset:51200
ds_read_b64_tr_b16 a[206:207], v238 offset:52224
s_add_u32 s78, s10, 0xac000
s_add_u32 m0, s94, 0x1a000
ds_read_b64_tr_b16 a[208:209], v235 offset:53248
buffer_load_dwordx4 v233, s[52:55], s78 offen lds
ds_read_b64_tr_b16 a[210:211], v235 offset:54272
ds_read_b64_tr_b16 a[212:213], v238 offset:53248
ds_read_b64_tr_b16 a[214:215], v238 offset:54272
ds_read_b64_tr_b16 a[216:217], v235 offset:55296
s_add_u32 m0, s94, 0x1a400
ds_read_b64_tr_b16 a[218:219], v235 offset:56320
buffer_load_dwordx4 v234, s[52:55], s78 offen lds
ds_read_b64_tr_b16 a[220:221], v238 offset:55296
ds_read_b64_tr_b16 a[222:223], v238 offset:56320
ds_read_b64_tr_b16 a[224:225], v237 offset:0
ds_read_b64_tr_b16 a[226:227], v237 offset:1024
s_add_u32 s78, s11, 0
s_add_u32 m0, s94, 0x1c000
ds_read_b64_tr_b16 a[228:229], v240 offset:0
buffer_load_dwordx4 v233, s[52:55], s78 offen lds
ds_read_b64_tr_b16 a[230:231], v240 offset:1024
ds_read_b64_tr_b16 a[232:233], v237 offset:2048
ds_read_b64_tr_b16 a[234:235], v237 offset:3072
ds_read_b64_tr_b16 a[236:237], v240 offset:2048
s_add_u32 m0, s94, 0x1c400
ds_read_b64_tr_b16 a[238:239], v240 offset:3072
buffer_load_dwordx4 v234, s[52:55], s78 offen lds
ds_read_b64_tr_b16 a[240:241], v237 offset:4096
ds_read_b64_tr_b16 a[242:243], v237 offset:5120
ds_read_b64_tr_b16 a[244:245], v240 offset:4096
ds_read_b64_tr_b16 a[246:247], v240 offset:5120
s_add_u32 s78, s11, 0xac000
s_add_u32 m0, s94, 0x1e000
ds_read_b64_tr_b16 a[248:249], v237 offset:6144
buffer_load_dwordx4 v233, s[52:55], s78 offen lds
ds_read_b64_tr_b16 a[250:251], v237 offset:7168
ds_read_b64_tr_b16 a[252:253], v240 offset:6144
ds_read_b64_tr_b16 a[254:255], v240 offset:7168
ds_read_b64_tr_b16 a[96:97], v237 offset:16384
s_add_u32 m0, s94, 0x1e400
ds_read_b64_tr_b16 a[98:99], v237 offset:17408
buffer_load_dwordx4 v234, s[52:55], s78 offen lds
ds_read_b64_tr_b16 a[100:101], v240 offset:16384
ds_read_b64_tr_b16 a[102:103], v240 offset:17408
ds_read_b64_tr_b16 a[104:105], v237 offset:18432
ds_read_b64_tr_b16 a[106:107], v237 offset:19456
ds_read_b64_tr_b16 a[108:109], v240 offset:18432
ds_read_b64_tr_b16 a[110:111], v240 offset:19456
ds_read_b64_tr_b16 a[112:113], v237 offset:20480
ds_read_b64_tr_b16 a[114:115], v237 offset:21504
ds_read_b64_tr_b16 a[116:117], v240 offset:20480
ds_read_b64_tr_b16 a[118:119], v240 offset:21504
ds_read_b64_tr_b16 a[120:121], v237 offset:22528
ds_read_b64_tr_b16 a[122:123], v237 offset:23552
ds_read_b64_tr_b16 a[124:125], v240 offset:22528
ds_read_b64_tr_b16 a[126:127], v240 offset:23552
s_waitcnt lgkmcnt(0)
s_barrier
s_lshl_b32 s82, s69, 7
s_add_u32 s82, s82, 0x780000
buffer_load_dword v199, v242, s[64:67], s82 offen sc1
s_add_u32 s78, s4, 0
s_add_u32 m0, s94, 0
s_nop 0
buffer_load_dwordx4 v233, s[52:55], s78 offen lds
s_add_u32 m0, s94, 0x400
s_nop 0
buffer_load_dwordx4 v234, s[52:55], s78 offen lds
s_add_u32 s78, s4, 0xac000
s_add_u32 m0, s94, 0x2000
s_nop 0
buffer_load_dwordx4 v233, s[52:55], s78 offen lds
s_add_u32 m0, s94, 0x2400
s_nop 0
buffer_load_dwordx4 v234, s[52:55], s78 offen lds
s_add_u32 s78, s5, 0
s_add_u32 m0, s94, 0x4000
s_nop 0
buffer_load_dwordx4 v233, s[52:55], s78 offen lds
s_add_u32 m0, s94, 0x4400
s_nop 0
buffer_load_dwordx4 v234, s[52:55], s78 offen lds
s_add_u32 s78, s5, 0xac000
s_add_u32 m0, s94, 0x6000
s_nop 0
buffer_load_dwordx4 v233, s[52:55], s78 offen lds
s_add_u32 m0, s94, 0x6400
s_nop 0
buffer_load_dwordx4 v234, s[52:55], s78 offen lds
L_p2:
s_lshl_b32 s81, s68, 8
v_lshlrev_b32 v8, 2, v1
v_add_u32 v9, s81, v8
v_add_u32 v9, 0x24000, v9
ds_write_b32 v9, v4 offset:0
s_lshl_b32 s81, s69, 7
s_lshl_b32 s82, s72, 6
s_add_u32 s81, s81, s82
s_lshl_b32 s82, s96, 5
s_add_u32 s81, s81, s82
s_lshl_b32 s81, s81, 10
s_lshl_b32 s82, s73, 7
s_add_u32 s81, s81, s82
s_lshl_b32 s82, s95, 6
s_add_u32 s93, s81, s82
v_and_b32 v10, 31, v1
v_lshlrev_b32 v10, 10, v10
v_lshrrev_b32 v11, 5, v1
v_lshlrev_b32 v12, 3, v11
v_add_u32 v137, v10, v12
v_lshlrev_b32 v12, 4, v11
v_add_u32 v138, v10, v12
buffer_load_dwordx2 v[128:129], v137, s[28:31], s93 offen
buffer_load_dwordx2 v[130:131], v137, s[28:31], s93 offen offset:16
buffer_load_dwordx2 v[132:133], v137, s[28:31], s93 offen offset:32
buffer_load_dwordx2 v[134:135], v137, s[28:31], s93 offen offset:48
s_waitcnt lgkmcnt(0)
s_lshl_b32 s82, s69, 7
s_add_u32 s82, s82, 0x780000
s_cmp_eq_u32 s71, 0
s_cbranch_scc1 L_notq_19
s_waitcnt vmcnt(4)
s_branch L_join_21
L_notq_19:
s_waitcnt vmcnt(12)
L_join_21:
v_readfirstlane_b32 s81, v199
s_nop 3
s_cmp_ge_u32 s81, 16
s_cbranch_scc1 L_hseen_20
s_cmp_lg_u32 s68, 0
s_cbranch_scc1 L_pdone_23
s_mov_b32 s84, 0
L_poll_22:
buffer_load_dword v198, v242, s[64:67], s82 offen sc1
s_waitcnt vmcnt(0)
v_readfirstlane_b32 s81, v198
s_nop 3
s_cmp_ge_u32 s81, 16
s_cbranch_scc1 L_pdone_23
s_add_u32 s84, s84, 1
s_cmp_lt_u32 s84, 0x30d40
s_cbranch_scc1 L_poll_22
L_pdone_23:
L_hseen_20:
s_waitcnt vmcnt(4)
s_barrier
s_cmp_eq_u32 s71, 0
s_cbranch_scc1 L_notq_24
s_lshl_b32 s82, s69, 7
s_add_u32 s82, s82, 0x780800
s_cmp_lg_u32 s68, 0
s_cbranch_scc1 L_noflag_25
s_mov_b64 exec, 1
v_mov_b32 v8, 0
v_mov_b32 v9, 1
buffer_atomic_add v9, v8, s[64:67], s82 offen sc1
s_mov_b64 exec, -1
L_noflag_25:
L_notq_24:
s_lshl_b32 s81, s72, 1
s_add_u32 s81, s81, s96
s_lshl_b32 s81, s81, 8
v_add_u32 v9, s81, v8
v_add_u32 v9, 0x24000, v9
ds_read_b32 v136, v9 offset:0
buffer_load_dwordx4 a[0:3], v241, s[64:67], s13 offen sc1
buffer_load_dwordx4 a[4:7], v241, s[64:67], s13 offen offset:1024 sc1
buffer_load_dwordx4 a[8:11], v241, s[64:67], s13 offen offset:2048 sc1
buffer_load_dwordx4 a[12:15], v241, s[64:67], s13 offen offset:3072 sc1
s_add_u32 s78, s6, 0
s_add_u32 m0, s94, 0x8000
s_nop 0
buffer_load_dwordx4 v233, s[52:55], s78 offen lds
s_add_u32 m0, s94, 0x8400
s_nop 0
buffer_load_dwordx4 v234, s[52:55], s78 offen lds
s_add_u32 s78, s6, 0xac000
s_add_u32 m0, s94, 0xa000
s_nop 0
buffer_load_dwordx4 v233, s[52:55], s78 offen lds
s_add_u32 m0, s94, 0xa400
s_nop 0
buffer_load_dwordx4 v234, s[52:55], s78 offen lds
buffer_load_dwordx4 a[16:19], v241, s[64:67], s14 offen sc1
buffer_load_dwordx4 a[20:23], v241, s[64:67], s14 offen offset:1024 sc1
buffer_load_dwordx4 a[24:27], v241, s[64:67], s14 offen offset:2048 sc1
buffer_load_dwordx4 a[28:31], v241, s[64:67], s14 offen offset:3072 sc1
s_add_u32 s78, s7, 0
s_add_u32 m0, s94, 0xc000
s_nop 0
buffer_load_dwordx4 v233, s[52:55], s78 offen lds
s_add_u32 m0, s94, 0xc400
s_nop 0
buffer_load_dwordx4 v234, s[52:55], s78 offen lds
s_add_u32 s78, s7, 0xac000
s_add_u32 m0, s94, 0xe000
s_nop 0
buffer_load_dwordx4 v233, s[52:55], s78 offen lds
s_add_u32 m0, s94, 0xe400
s_nop 0
buffer_load_dwordx4 v234, s[52:55], s78 offen lds
buffer_load_dwordx4 a[32:35], v241, s[64:67], s15 offen sc1
buffer_load_dwordx4 a[36:39], v241, s[64:67], s15 offen offset:1024 sc1
buffer_load_dwordx4 a[40:43], v241, s[64:67], s15 offen offset:2048 sc1
buffer_load_dwordx4 a[44:47], v241, s[64:67], s15 offen offset:3072 sc1
ds_read_b64_tr_b16 a[128:129], v235 offset:0
ds_read_b64_tr_b16 a[130:131], v235 offset:1024
ds_read_b64_tr_b16 a[132:133], v238 offset:0
ds_read_b64_tr_b16 a[134:135], v238 offset:1024
ds_read_b64_tr_b16 a[136:137], v235 offset:2048
ds_read_b64_tr_b16 a[138:139], v235 offset:3072
ds_read_b64_tr_b16 a[140:141], v238 offset:2048
ds_read_b64_tr_b16 a[142:143], v238 offset:3072
ds_read_b64_tr_b16 a[144:145], v235 offset:4096
ds_read_b64_tr_b16 a[146:147], v235 offset:5120
s_waitcnt vmcnt(19) lgkmcnt(6)
v_mfma_f32_32x32x16_bf16 v[32:47], a[128:131], a[0:3], 0
ds_read_b64_tr_b16 a[148:149], v238 offset:4096
ds_read_b64_tr_b16 a[150:151], v238 offset:5120
buffer_load_dwordx4 a[48:51], v241, s[64:67], s16 offen sc1
v_mfma_f32_32x32x16_bf16 v[48:63], a[132:135], a[0:3], 0
ds_read_b64_tr_b16 a[152:153], v235 offset:6144
ds_read_b64_tr_b16 a[154:155], v235 offset:7168
buffer_load_dwordx4 a[52:55], v241, s[64:67], s16 offen offset:1024 sc1
s_waitcnt vmcnt(20) lgkmcnt(6)
v_mfma_f32_32x32x16_bf16 v[32:47], a[136:139], a[4:7], v[32:47]
ds_read_b64_tr_b16 a[156:157], v238 offset:6144
ds_read_b64_tr_b16 a[158:159], v238 offset:7168
buffer_load_dwordx4 a[56:59], v241, s[64:67], s16 offen offset:2048 sc1
v_mfma_f32_32x32x16_bf16 v[48:63], a[140:143], a[4:7], v[48:63]
ds_read_b64_tr_b16 a[128:129], v235 offset:16384
ds_read_b64_tr_b16 a[130:131], v235 offset:17408
buffer_load_dwordx4 a[60:63], v241, s[64:67], s16 offen offset:3072 sc1
s_waitcnt vmcnt(21) lgkmcnt(6)
v_mfma_f32_32x32x16_bf16 v[32:47], a[144:147], a[8:11], v[32:47]
ds_read_b64_tr_b16 a[132:133], v238 offset:16384
ds_read_b64_tr_b16 a[134:135], v238 offset:17408
buffer_load_dwordx4 a[64:67], v241, s[64:67], s17 offen sc1
v_mfma_f32_32x32x16_bf16 v[48:63], a[148:151], a[8:11], v[48:63]
ds_read_b64_tr_b16 a[136:137], v235 offset:18432
ds_read_b64_tr_b16 a[138:139], v235 offset:19456
buffer_load_dwordx4 a[68:71], v241, s[64:67], s17 offen offset:1024 sc1
s_waitcnt vmcnt(22) lgkmcnt(6)
v_mfma_f32_32x32x16_bf16 v[32:47], a[152:155], a[12:15], v[32:47]
ds_read_b64_tr_b16 a[140:141], v238 offset:18432
ds_read_b64_tr_b16 a[142:143], v238 offset:19456
buffer_load_dwordx4 a[72:75], v241, s[64:67], s17 offen offset:2048 sc1
v_mfma_f32_32x32x16_bf16 v[48:63], a[156:159], a[12:15], v[48:63]
ds_read_b64_tr_b16 a[144:145], v235 offset:20480
ds_read_b64_tr_b16 a[146:147], v235 offset:21504
buffer_load_dwordx4 a[76:79], v241, s[64:67], s17 offen offset:3072 sc1
s_waitcnt vmcnt(19) lgkmcnt(6)
v_mfma_f32_32x32x16_bf16 v[32:47], a[128:131], a[16:19], v[32:47]
ds_read_b64_tr_b16 a[148:149], v238 offset:20480
ds_read_b64_tr_b16 a[150:151], v238 offset:21504
buffer_load_dwordx4 a[80:83], v241, s[64:67], s18 offen sc1
v_mfma_f32_32x32x16_bf16 v[48:63], a[132:135], a[16:19], v[48:63]
ds_read_b64_tr_b16 a[152:153], v235 offset:22528
ds_read_b64_tr_b16 a[154:155], v235 offset:23552
buffer_load_dwordx4 a[84:87], v241, s[64:67], s18 offen offset:1024 sc1
s_waitcnt vmcnt(20) lgkmcnt(6)
v_mfma_f32_32x32x16_bf16 v[32:47], a[136:139], a[20:23], v[32:47]
ds_read_b64_tr_b16 a[156:157], v238 offset:22528
ds_read_b64_tr_b16 a[158:159], v238 offset:23552
buffer_load_dwordx4 a[88:91], v241, s[64:67], s18 offen offset:2048 sc1
v_mfma_f32_32x32x16_bf16 v[48:63], a[140:143], a[20:23], v[48:63]
s_waitcnt vmcnt(15)
s_barrier
ds_read_b64_tr_b16 a[128:129], v235 offset:32768
ds_read_b64_tr_b16 a[130:131], v235 offset:33792
buffer_load_dwordx4 a[92:95], v241, s[64:67], s18 offen offset:3072 sc1
s_waitcnt lgkmcnt(6)
v_mfma_f32_32x32x16_bf16 v[32:47], a[144:147], a[24:27], v[32:47]
ds_read_b64_tr_b16 a[132:133], v238 offset:32768
ds_read_b64_tr_b16 a[134:135], v238 offset:33792
buffer_load_dwordx4 a[0:3], v241, s[64:67], s19 offen sc1
v_mfma_f32_32x32x16_bf16 v[48:63], a[148:151], a[24:27], v[48:63]
ds_read_b64_tr_b16 a[136:137], v235 offset:34816
ds_read_b64_tr_b16 a[138:139], v235 offset:35840
buffer_load_dwordx4 a[4:7], v241, s[64:67], s19 offen offset:1024 sc1
s_waitcnt lgkmcnt(6)
v_mfma_f32_32x32x16_bf16 v[32:47], a[152:155], a[28:31], v[32:47]
ds_read_b64_tr_b16 a[140:141], v238 offset:34816
ds_read_b64_tr_b16 a[142:143], v238 offset:35840
buffer_load_dwordx4 a[8:11], v241, s[64:67], s19 offen offset:2048 sc1
v_mfma_f32_32x32x16_bf16 v[48:63], a[156:159], a[28:31], v[48:63]
ds_read_b64_tr_b16 a[144:145], v235 offset:36864
ds_read_b64_tr_b16 a[146:147], v235 offset:37888
buffer_load_dwordx4 a[12:15], v241, s[64:67], s19 offen offset:3072 sc1
s_waitcnt vmcnt(19) lgkmcnt(6)
v_mfma_f32_32x32x16_bf16 v[32:47], a[128:131], a[32:35], v[32:47]
ds_read_b64_tr_b16 a[148:149], v238 offset:36864
ds_read_b64_tr_b16 a[150:151], v238 offset:37888
buffer_load_dwordx4 a[16:19], v241, s[64:67], s0 offen sc1
v_mfma_f32_32x32x16_bf16 v[48:63], a[132:135], a[32:35], v[48:63]
ds_read_b64_tr_b16 a[152:153], v235 offset:38912
ds_read_b64_tr_b16 a[154:155], v235 offset:39936
buffer_load_dwordx4 a[20:23], v241, s[64:67], s0 offen offset:1024 sc1
s_waitcnt vmcnt(20) lgkmcnt(6)
v_mfma_f32_32x32x16_bf16 v[32:47], a[136:139], a[36:39], v[32:47]
ds_read_b64_tr_b16 a[156:157], v238 offset:38912
ds_read_b64_tr_b16 a[158:159], v238 offset:39936
buffer_load_dwordx4 a[24:27], v241, s[64:67], s0 offen offset:2048 sc1
v_mfma_f32_32x32x16_bf16 v[48:63], a[140:143], a[36:39], v[48:63]
ds_read_b64_tr_b16 a[128:129], v235 offset:49152
ds_read_b64_tr_b16 a[130:131], v235 offset:50176
s_waitcnt vmcnt(20) lgkmcnt(6)
v_mfma_f32_32x32x16_bf16 v[32:47], a[144:147], a[40:43], v[32:47]
ds_read_b64_tr_b16 a[132:133], v238 offset:49152
ds_read_b64_tr_b16 a[134:135], v238 offset:50176
buffer_load_dwordx4 a[28:31], v241, s[64:67], s0 offen offset:3072 sc1
v_mfma_f32_32x32x16_bf16 v[48:63], a[148:151], a[40:43], v[48:63]
s_add_u32 s78, s12, 0
s_add_u32 m0, s94, 0x20000
ds_read_b64_tr_b16 a[136:137], v235 offset:51200
ds_read_b64_tr_b16 a[138:139], v235 offset:52224
buffer_load_dwordx4 v233, s[52:55], s78 offen lds
s_waitcnt vmcnt(21) lgkmcnt(6)
v_mfma_f32_32x32x16_bf16 v[32:47], a[152:155], a[44:47], v[32:47]
ds_read_b64_tr_b16 a[140:141], v238 offset:51200
ds_read_b64_tr_b16 a[142:143], v238 offset:52224
buffer_load_dwordx4 a[32:35], v241, s[64:67], s1 offen sc1
v_mfma_f32_32x32x16_bf16 v[48:63], a[156:159], a[44:47], v[48:63]
s_add_u32 m0, s94, 0x20400
ds_read_b64_tr_b16 a[144:145], v235 offset:53248
ds_read_b64_tr_b16 a[146:147], v235 offset:54272
buffer_load_dwordx4 v234, s[52:55], s78 offen lds
s_waitcnt vmcnt(22) lgkmcnt(6)
v_mfma_f32_32x32x16_bf16 v[32:47], a[128:131], a[48:51], v[32:47]
ds_read_b64_tr_b16 a[148:149], v238 offset:53248
ds_read_b64_tr_b16 a[150:151], v238 offset:54272
buffer_load_dwordx4 a[36:39], v241, s[64:67], s1 offen offset:1024 sc1
v_mfma_f32_32x32x16_bf16 v[48:63], a[132:135], a[48:51], v[48:63]
s_add_u32 s78, s12, 0xac000
s_add_u32 m0, s94, 0x22000
ds_read_b64_tr_b16 a[152:153], v235 offset:55296
ds_read_b64_tr_b16 a[154:155], v235 offset:56320
buffer_load_dwordx4 v233, s[52:55], s78 offen lds
s_waitcnt vmcnt(23) lgkmcnt(6)
v_mfma_f32_32x32x16_bf16 v[32:47], a[136:139], a[52:55], v[32:47]
ds_read_b64_tr_b16 a[156:157], v238 offset:55296
ds_read_b64_tr_b16 a[158:159], v238 offset:56320
buffer_load_dwordx4 a[40:43], v241, s[64:67], s1 offen offset:2048 sc1
v_mfma_f32_32x32x16_bf16 v[48:63], a[140:143], a[52:55], v[48:63]
s_add_u32 m0, s94, 0x22400
ds_read_b64_tr_b16 a[128:129], v236 offset:0
ds_read_b64_tr_b16 a[130:131], v236 offset:1024
buffer_load_dwordx4 v234, s[52:55], s78 offen lds
s_waitcnt vmcnt(24) lgkmcnt(6)
v_mfma_f32_32x32x16_bf16 v[32:47], a[144:147], a[56:59], v[32:47]
ds_read_b64_tr_b16 a[132:133], v239 offset:0
ds_read_b64_tr_b16 a[134:135], v239 offset:1024
buffer_load_dwordx4 a[44:47], v241, s[64:67], s1 offen offset:3072 sc1
v_mfma_f32_32x32x16_bf16 v[48:63], a[148:151], a[56:59], v[48:63]
ds_read_b64_tr_b16 a[136:137], v236 offset:2048
ds_read_b64_tr_b16 a[138:139], v236 offset:3072
s_waitcnt vmcnt(24) lgkmcnt(6)
v_mfma_f32_32x32x16_bf16 v[32:47], a[152:155], a[60:63], v[32:47]
s_add_u32 s85, s90, 0x9000
ds_read_b64_tr_b16 a[140:141], v239 offset:2048
ds_read_b64_tr_b16 a[142:143], v239 offset:3072
buffer_load_dwordx4 a[48:51], v241, s[64:67], s85 offen sc1
v_mfma_f32_32x32x16_bf16 v[48:63], a[156:159], a[60:63], v[48:63]
ds_read_b64_tr_b16 a[144:145], v236 offset:4096
ds_read_b64_tr_b16 a[146:147], v236 offset:5120
s_waitcnt vmcnt(24) lgkmcnt(6)
v_mfma_f32_32x32x16_bf16 v[32:47], a[128:131], a[64:67], v[32:47]
ds_read_b64_tr_b16 a[148:149], v239 offset:4096
ds_read_b64_tr_b16 a[150:151], v239 offset:5120
buffer_load_dwordx4 a[52:55], v241, s[64:67], s85 offen offset:1024 sc1
v_mfma_f32_32x32x16_bf16 v[48:63], a[132:135], a[64:67], v[48:63]
ds_read_b64_tr_b16 a[152:153], v236 offset:6144
ds_read_b64_tr_b16 a[154:155], v236 offset:7168
s_waitcnt vmcnt(24) lgkmcnt(6)
v_mfma_f32_32x32x16_bf16 v[32:47], a[136:139], a[68:71], v[32:47]
ds_read_b64_tr_b16 a[156:157], v239 offset:6144
ds_read_b64_tr_b16 a[158:159], v239 offset:7168
buffer_load_dwordx4 a[56:59], v241, s[64:67], s85 offen offset:2048 sc1
v_mfma_f32_32x32x16_bf16 v[48:63], a[140:143], a[68:71], v[48:63]
ds_read_b64_tr_b16 a[128:129], v236 offset:16384
ds_read_b64_tr_b16 a[130:131], v236 offset:17408
s_waitcnt vmcnt(24) lgkmcnt(6)
v_mfma_f32_32x32x16_bf16 v[32:47], a[144:147], a[72:75], v[32:47]
ds_read_b64_tr_b16 a[132:133], v239 offset:16384
ds_read_b64_tr_b16 a[134:135], v239 offset:17408
buffer_load_dwordx4 a[60:63], v241, s[64:67], s85 offen offset:3072 sc1
v_mfma_f32_32x32x16_bf16 v[48:63], a[148:151], a[72:75], v[48:63]
ds_read_b64_tr_b16 a[136:137], v236 offset:18432
ds_read_b64_tr_b16 a[138:139], v236 offset:19456
s_waitcnt vmcnt(24) lgkmcnt(6)
v_mfma_f32_32x32x16_bf16 v[32:47], a[152:155], a[76:79], v[32:47]
s_add_u32 s85, s90, 0xa000
ds_read_b64_tr_b16 a[140:141], v239 offset:18432
ds_read_b64_tr_b16 a[142:143], v239 offset:19456
buffer_load_dwordx4 a[64:67], v241, s[64:67], s85 offen sc1
v_mfma_f32_32x32x16_bf16 v[48:63], a[156:159], a[76:79], v[48:63]
ds_read_b64_tr_b16 a[144:145], v236 offset:20480
ds_read_b64_tr_b16 a[146:147], v236 offset:21504
s_waitcnt vmcnt(24) lgkmcnt(6)
v_mfma_f32_32x32x16_bf16 v[32:47], a[128:131], a[80:83], v[32:47]
ds_read_b64_tr_b16 a[148:149], v239 offset:20480
ds_read_b64_tr_b16 a[150:151], v239 offset:21504
buffer_load_dwordx4 a[68:71], v241, s[64:67], s85 offen offset:1024 sc1
v_mfma_f32_32x32x16_bf16 v[48:63], a[132:135], a[80:83], v[48:63]
ds_read_b64_tr_b16 a[152:153], v236 offset:22528
ds_read_b64_tr_b16 a[154:155], v236 offset:23552
s_waitcnt vmcnt(24) lgkmcnt(6)
v_mfma_f32_32x32x16_bf16 v[32:47], a[136:139], a[84:87], v[32:47]
ds_read_b64_tr_b16 a[156:157], v239 offset:22528
ds_read_b64_tr_b16 a[158:159], v239 offset:23552
buffer_load_dwordx4 a[72:75], v241, s[64:67], s85 offen offset:2048 sc1
v_mfma_f32_32x32x16_bf16 v[48:63], a[140:143], a[84:87], v[48:63]
ds_read_b64_tr_b16 a[128:129], v236 offset:32768
ds_read_b64_tr_b16 a[130:131], v236 offset:33792
s_waitcnt vmcnt(24) lgkmcnt(6)
v_mfma_f32_32x32x16_bf16 v[32:47], a[144:147], a[88:91], v[32:47]
ds_read_b64_tr_b16 a[132:133], v239 offset:32768
ds_read_b64_tr_b16 a[134:135], v239 offset:33792
v_mfma_f32_32x32x16_bf16 v[48:63], a[148:151], a[88:91], v[48:63]
ds_read_b64_tr_b16 a[136:137], v236 offset:34816
ds_read_b64_tr_b16 a[138:139], v236 offset:35840
s_waitcnt vmcnt(23) lgkmcnt(6)
v_mfma_f32_32x32x16_bf16 v[32:47], a[152:155], a[92:95], v[32:47]
ds_read_b64_tr_b16 a[140:141], v239 offset:34816
ds_read_b64_tr_b16 a[142:143], v239 offset:35840
v_mfma_f32_32x32x16_bf16 v[48:63], a[156:159], a[92:95], v[48:63]
ds_read_b64_tr_b16 a[144:145], v236 offset:36864
ds_read_b64_tr_b16 a[146:147], v236 offset:37888
s_waitcnt vmcnt(22) lgkmcnt(6)
v_mfma_f32_32x32x16_bf16 v[32:47], a[128:131], a[0:3], v[32:47]
ds_read_b64_tr_b16 a[148:149], v239 offset:36864
ds_read_b64_tr_b16 a[150:151], v239 offset:37888
v_mfma_f32_32x32x16_bf16 v[48:63], a[132:135], a[0:3], v[48:63]
ds_read_b64_tr_b16 a[152:153], v236 offset:38912
ds_read_b64_tr_b16 a[154:155], v236 offset:39936
s_waitcnt vmcnt(21) lgkmcnt(6)
v_mfma_f32_32x32x16_bf16 v[32:47], a[136:139], a[4:7], v[32:47]
ds_read_b64_tr_b16 a[156:157], v239 offset:38912
ds_read_b64_tr_b16 a[158:159], v239 offset:39936
v_mfma_f32_32x32x16_bf16 v[48:63], a[140:143], a[4:7], v[48:63]
ds_read_b64_tr_b16 a[128:129], v236 offset:49152
ds_read_b64_tr_b16 a[130:131], v236 offset:50176
s_waitcnt vmcnt(20) lgkmcnt(6)
v_mfma_f32_32x32x16_bf16 v[32:47], a[144:147], a[8:11], v[32:47]
ds_read_b64_tr_b16 a[132:133], v239 offset:49152
ds_read_b64_tr_b16 a[134:135], v239 offset:50176
v_mfma_f32_32x32x16_bf16 v[48:63], a[148:151], a[8:11], v[48:63]
ds_read_b64_tr_b16 a[136:137], v236 offset:51200
ds_read_b64_tr_b16 a[138:139], v236 offset:52224
s_waitcnt vmcnt(19) lgkmcnt(6)
v_mfma_f32_32x32x16_bf16 v[32:47], a[152:155], a[12:15], v[32:47]
ds_read_b64_tr_b16 a[140:141], v239 offset:51200
ds_read_b64_tr_b16 a[142:143], v239 offset:52224
v_mfma_f32_32x32x16_bf16 v[48:63], a[156:159], a[12:15], v[48:63]
ds_read_b64_tr_b16 a[144:145], v236 offset:53248
ds_read_b64_tr_b16 a[146:147], v236 offset:54272
s_waitcnt vmcnt(18) lgkmcnt(6)
v_mfma_f32_32x32x16_bf16 v[32:47], a[128:131], a[16:19], v[32:47]
ds_read_b64_tr_b16 a[148:149], v239 offset:53248
ds_read_b64_tr_b16 a[150:151], v239 offset:54272
v_mfma_f32_32x32x16_bf16 v[48:63], a[132:135], a[16:19], v[48:63]
ds_read_b64_tr_b16 a[152:153], v236 offset:55296
ds_read_b64_tr_b16 a[154:155], v236 offset:56320
s_waitcnt vmcnt(17) lgkmcnt(6)
v_mfma_f32_32x32x16_bf16 v[32:47], a[136:139], a[20:23], v[32:47]
ds_read_b64_tr_b16 a[156:157], v239 offset:55296
ds_read_b64_tr_b16 a[158:159], v239 offset:56320
v_mfma_f32_32x32x16_bf16 v[48:63], a[140:143], a[20:23], v[48:63]
s_lshl_b32 s82, s69, 7
s_add_u32 s82, s82, 0x780800
s_cmp_lg_u32 s68, 0
s_cbranch_scc1 L_pdone_27
s_mov_b32 s84, 0
L_poll_26:
buffer_load_dword v198, v242, s[64:67], s82 offen sc1
s_waitcnt vmcnt(0)
v_readfirstlane_b32 s81, v198
s_nop 3
s_cmp_ge_u32 s81, 8
s_cbranch_scc1 L_pdone_27
s_add_u32 s84, s84, 1
s_cmp_lt_u32 s84, 0x30d40
s_cbranch_scc1 L_poll_26
L_pdone_27:
s_waitcnt vmcnt(8)
s_barrier
ds_read_b64_tr_b16 a[128:129], v237 offset:0
ds_read_b64_tr_b16 a[130:131], v237 offset:1024
s_waitcnt lgkmcnt(6)
v_mfma_f32_32x32x16_bf16 v[32:47], a[144:147], a[24:27], v[32:47]
s_add_u32 s97, s91, 0
ds_read_b64_tr_b16 a[132:133], v240 offset:0
ds_read_b64_tr_b16 a[134:135], v240 offset:1024
buffer_load_dwordx4 a[76:79], v241, s[64:67], s97 offen sc1
v_mfma_f32_32x32x16_bf16 v[48:63], a[148:151], a[24:27], v[48:63]
ds_read_b64_tr_b16 a[136:137], v237 offset:2048
ds_read_b64_tr_b16 a[138:139], v237 offset:3072
buffer_load_dwordx4 a[80:83], v241, s[64:67], s97 offen offset:1024 sc1
s_waitcnt lgkmcnt(6)
v_mfma_f32_32x32x16_bf16 v[32:47], a[152:155], a[28:31], v[32:47]
ds_read_b64_tr_b16 a[140:141], v240 offset:2048
ds_read_b64_tr_b16 a[142:143], v240 offset:3072
buffer_load_dwordx4 a[84:87], v241, s[64:67], s97 offen offset:2048 sc1
v_mfma_f32_32x32x16_bf16 v[48:63], a[156:159], a[28:31], v[48:63]
ds_read_b64_tr_b16 a[144:145], v237 offset:4096
ds_read_b64_tr_b16 a[146:147], v237 offset:5120
buffer_load_dwordx4 a[88:91], v241, s[64:67], s97 offen offset:3072 sc1
s_waitcnt lgkmcnt(6)
v_mfma_f32_32x32x16_bf16 v[32:47], a[128:131], a[32:35], v[32:47]
s_add_u32 s97, s91, 0x1000
ds_read_b64_tr_b16 a[148:149], v240 offset:4096
ds_read_b64_tr_b16 a[150:151], v240 offset:5120
buffer_load_dwordx4 a[92:95], v241, s[64:67], s97 offen sc1
v_mfma_f32_32x32x16_bf16 v[48:63], a[132:135], a[32:35], v[48:63]
ds_read_b64_tr_b16 a[152:153], v237 offset:6144
ds_read_b64_tr_b16 a[154:155], v237 offset:7168
buffer_load_dwordx4 a[0:3], v241, s[64:67], s97 offen offset:1024 sc1
s_waitcnt lgkmcnt(6)
v_mfma_f32_32x32x16_bf16 v[32:47], a[136:139], a[36:39], v[32:47]
ds_read_b64_tr_b16 a[156:157], v240 offset:6144
ds_read_b64_tr_b16 a[158:159], v240 offset:7168
buffer_load_dwordx4 a[4:7], v241, s[64:67], s97 offen offset:2048 sc1
v_mfma_f32_32x32x16_bf16 v[48:63], a[140:143], a[36:39], v[48:63]
buffer_load_dwordx4 a[8:11], v241, s[64:67], s97 offen offset:3072 sc1
s_waitcnt lgkmcnt(4)
v_mfma_f32_32x32x16_bf16 v[32:47], a[144:147], a[40:43], v[32:47]
s_add_u32 s97, s91, 0x2000
buffer_load_dwordx4 a[12:15], v241, s[64:67], s97 offen sc1
v_mfma_f32_32x32x16_bf16 v[48:63], a[148:151], a[40:43], v[48:63]
buffer_load_dwordx4 a[16:19], v241, s[64:67], s97 offen offset:1024 sc1
s_waitcnt vmcnt(17) lgkmcnt(0)
v_mfma_f32_32x32x16_bf16 v[32:47], a[152:155], a[44:47], v[32:47]
buffer_load_dwordx4 a[20:23], v241, s[64:67], s97 offen offset:2048 sc1
v_mfma_f32_32x32x16_bf16 v[48:63], a[156:159], a[44:47], v[48:63]
buffer_load_dwordx4 a[24:27], v241, s[64:67], s97 offen offset:3072 sc1
s_waitcnt vmcnt(18)
v_mfma_f32_32x32x16_bf16 v[32:47], v[140:143], a[48:51], v[32:47]
s_add_u32 s97, s91, 0x3000
buffer_load_dwordx4 a[28:31], v241, s[64:67], s97 offen sc1
v_mfma_f32_32x32x16_bf16 v[48:63], v[144:147], a[48:51], v[48:63]
buffer_load_dwordx4 a[32:35], v241, s[64:67], s97 offen offset:1024 sc1
s_waitcnt vmcnt(19)
v_mfma_f32_32x32x16_bf16 v[32:47], v[148:151], a[52:55], v[32:47]
buffer_load_dwordx4 a[36:39], v241, s[64:67], s97 offen offset:2048 sc1
v_mfma_f32_32x32x16_bf16 v[48:63], v[152:155], a[52:55], v[48:63]
buffer_load_dwordx4 a[40:43], v241, s[64:67], s97 offen offset:3072 sc1
s_waitcnt vmcnt(20)
v_mfma_f32_32x32x16_bf16 v[32:47], v[156:159], a[56:59], v[32:47]
v_mfma_f32_32x32x16_bf16 v[48:63], v[160:163], a[56:59], v[48:63]
s_waitcnt vmcnt(19)
v_mfma_f32_32x32x16_bf16 v[32:47], v[164:167], a[60:63], v[32:47]
v_mfma_f32_32x32x16_bf16 v[48:63], v[168:171], a[60:63], v[48:63]
s_waitcnt vmcnt(18)
v_mfma_f32_32x32x16_bf16 v[32:47], v[172:175], a[64:67], v[32:47]
v_mfma_f32_32x32x16_bf16 v[48:63], v[176:179], a[64:67], v[48:63]
s_waitcnt vmcnt(17)
v_mfma_f32_32x32x16_bf16 v[32:47], v[180:183], a[68:71], v[32:47]
v_mfma_f32_32x32x16_bf16 v[48:63], v[184:187], a[68:71], v[48:63]
s_waitcnt vmcnt(16)
v_mfma_f32_32x32x16_bf16 v[32:47], v[188:191], a[72:75], v[32:47]
v_mfma_f32_32x32x16_bf16 v[48:63], v[192:195], a[72:75], v[48:63]
s_lshl_b32 s81, s68, 13
v_add_u32 v14, s81, v241
s_xor_b32 s82, s68, 2
s_lshl_b32 s82, s82, 13
v_add_u32 v15, s82, v241
v_mul_f32 v139, 0xbfb8aa3b, v136
s_waitcnt vmcnt(15)
v_mfma_f32_32x32x16_bf16 v[80:95], a[164:167], a[76:79], 0
v_rcp_f32 v13, v136
v_lshlrev_b32 v200, 16, v128
v_and_b32 v201, 0xffff0000, v128
v_lshlrev_b32 v202, 16, v129
v_and_b32 v203, 0xffff0000, v129
s_waitcnt vmcnt(14)
v_mfma_f32_32x32x16_bf16 v[80:95], a[172:175], a[80:83], v[80:95]
v_lshlrev_b32 v204, 16, v130
v_and_b32 v205, 0xffff0000, v130
v_lshlrev_b32 v206, 16, v131
v_and_b32 v207, 0xffff0000, v131
v_lshlrev_b32 v208, 16, v132
v_and_b32 v209, 0xffff0000, v132
s_waitcnt vmcnt(13)
v_mfma_f32_32x32x16_bf16 v[80:95], a[180:183], a[84:87], v[80:95]
v_lshlrev_b32 v210, 16, v133
v_and_b32 v211, 0xffff0000, v133
v_lshlrev_b32 v212, 16, v134
v_and_b32 v213, 0xffff0000, v134
v_lshlrev_b32 v214, 16, v135
v_and_b32 v215, 0xffff0000, v135
s_waitcnt vmcnt(12)
v_mfma_f32_32x32x16_bf16 v[80:95], a[188:191], a[88:91], v[80:95]
ds_write_b128 v14, v[48:51] offset:0
s_waitcnt vmcnt(11)
v_mfma_f32_32x32x16_bf16 v[80:95], a[196:199], a[92:95], v[80:95]
ds_write_b128 v14, v[52:55] offset:1024
s_waitcnt vmcnt(10)
v_mfma_f32_32x32x16_bf16 v[80:95], a[204:207], a[0:3], v[80:95]
ds_write_b128 v14, v[56:59] offset:2048
s_waitcnt vmcnt(9)
v_mfma_f32_32x32x16_bf16 v[80:95], a[212:215], a[4:7], v[80:95]
ds_write_b128 v14, v[60:63] offset:3072
s_waitcnt vmcnt(8)
v_mfma_f32_32x32x16_bf16 v[80:95], a[220:223], a[8:11], v[80:95]
s_waitcnt lgkmcnt(0)
s_barrier
ds_read_b128 v[96:99], v15 offset:0
ds_read_b128 v[100:103], v15 offset:1024
ds_read_b128 v[104:107], v15 offset:2048
ds_read_b128 v[108:111], v15 offset:3072
s_waitcnt vmcnt(7)
v_mfma_f32_32x32x16_bf16 v[80:95], a[228:231], a[12:15], v[80:95]
s_waitcnt vmcnt(6)
v_mfma_f32_32x32x16_bf16 v[80:95], a[236:239], a[16:19], v[80:95]
s_waitcnt vmcnt(5)
v_mfma_f32_32x32x16_bf16 v[80:95], a[244:247], a[20:23], v[80:95]
s_waitcnt lgkmcnt(3)
v_add_f32 v32, v32, v96
v_add_f32 v33, v33, v97
v_add_f32 v34, v34, v98
v_add_f32 v35, v35, v99
s_waitcnt lgkmcnt(2)
v_add_f32 v36, v36, v100
v_add_f32 v37, v37, v101
s_waitcnt vmcnt(4)
v_mfma_f32_32x32x16_bf16 v[80:95], a[252:255], a[24:27], v[80:95]
v_add_f32 v38, v38, v102
v_add_f32 v39, v39, v103
s_waitcnt lgkmcnt(1)
v_add_f32 v40, v40, v104
v_add_f32 v41, v41, v105
v_add_f32 v42, v42, v106
v_add_f32 v43, v43, v107
s_waitcnt vmcnt(3)
v_mfma_f32_32x32x16_bf16 v[80:95], a[100:103], a[28:31], v[80:95]
s_waitcnt lgkmcnt(0)
v_add_f32 v44, v44, v108
v_add_f32 v45, v45, v109
v_add_f32 v46, v46, v110
v_add_f32 v47, v47, v111
v_mul_f32 v140, v32, v139
v_mul_f32 v141, v33, v139
s_waitcnt vmcnt(2)
v_mfma_f32_32x32x16_bf16 v[80:95], a[108:111], a[32:35], v[80:95]
v_mul_f32 v142, v34, v139
v_mul_f32 v143, v35, v139
v_mul_f32 v144, v36, v139
v_mul_f32 v145, v37, v139
v_mul_f32 v146, v38, v139
v_mul_f32 v147, v39, v139
s_waitcnt vmcnt(1)
v_mfma_f32_32x32x16_bf16 v[80:95], a[116:119], a[36:39], v[80:95]
v_mul_f32 v148, v40, v139
v_mul_f32 v149, v41, v139
v_mul_f32 v150, v42, v139
v_mul_f32 v151, v43, v139
v_mul_f32 v152, v44, v139
v_mul_f32 v153, v45, v139
s_waitcnt vmcnt(0)
v_mfma_f32_32x32x16_bf16 v[80:95], a[124:127], a[40:43], v[80:95]
v_mul_f32 v154, v46, v139
v_mul_f32 v155, v47, v139
v_exp_f32 v140, v140
v_exp_f32 v141, v141
v_mfma_f32_32x32x16_bf16 v[64:79], a[160:163], a[76:79], 0
v_exp_f32 v142, v142
v_exp_f32 v143, v143
v_exp_f32 v144, v144
v_mfma_f32_32x32x16_bf16 v[64:79], a[168:171], a[80:83], v[64:79]
v_exp_f32 v145, v145
v_exp_f32 v146, v146
v_exp_f32 v147, v147
v_mfma_f32_32x32x16_bf16 v[64:79], a[176:179], a[84:87], v[64:79]
ds_write_b128 v14, v[80:83] offset:4096
v_mfma_f32_32x32x16_bf16 v[64:79], a[184:187], a[88:91], v[64:79]
ds_write_b128 v14, v[84:87] offset:5120
v_mfma_f32_32x32x16_bf16 v[64:79], a[192:195], a[92:95], v[64:79]
ds_write_b128 v14, v[88:91] offset:6144
v_mfma_f32_32x32x16_bf16 v[64:79], a[200:203], a[0:3], v[64:79]
ds_write_b128 v14, v[92:95] offset:7168
v_mfma_f32_32x32x16_bf16 v[64:79], a[208:211], a[4:7], v[64:79]
s_waitcnt lgkmcnt(0)
s_barrier
ds_read_b128 v[112:115], v15 offset:4096
ds_read_b128 v[116:119], v15 offset:5120
ds_read_b128 v[120:123], v15 offset:6144
ds_read_b128 v[124:127], v15 offset:7168
v_mfma_f32_32x32x16_bf16 v[64:79], a[216:219], a[8:11], v[64:79]
v_exp_f32 v148, v148
v_exp_f32 v149, v149
v_exp_f32 v150, v150
v_mfma_f32_32x32x16_bf16 v[64:79], a[224:227], a[12:15], v[64:79]
v_exp_f32 v151, v151
v_exp_f32 v152, v152
v_exp_f32 v153, v153
v_mfma_f32_32x32x16_bf16 v[64:79], a[232:235], a[16:19], v[64:79]
v_exp_f32 v154, v154
v_exp_f32 v155, v155
v_fma_f32 v140, v140, v13, v13
v_fma_f32 v141, v141, v13, v13
v_mfma_f32_32x32x16_bf16 v[64:79], a[240:243], a[20:23], v[64:79]
v_fma_f32 v142, v142, v13, v13
v_fma_f32 v143, v143, v13, v13
v_fma_f32 v144, v144, v13, v13
v_fma_f32 v145, v145, v13, v13
v_fma_f32 v146, v146, v13, v13
v_fma_f32 v147, v147, v13, v13
v_mfma_f32_32x32x16_bf16 v[64:79], a[248:251], a[24:27], v[64:79]
v_fma_f32 v148, v148, v13, v13
v_fma_f32 v149, v149, v13, v13
v_fma_f32 v150, v150, v13, v13
v_fma_f32 v151, v151, v13, v13
v_fma_f32 v152, v152, v13, v13
v_fma_f32 v153, v153, v13, v13
v_mfma_f32_32x32x16_bf16 v[64:79], a[96:99], a[28:31], v[64:79]
v_fma_f32 v154, v154, v13, v13
v_fma_f32 v155, v155, v13, v13
v_rcp_f32 v140, v140
v_rcp_f32 v141, v141
v_mfma_f32_32x32x16_bf16 v[64:79], a[104:107], a[32:35], v[64:79]
v_rcp_f32 v142, v142
v_rcp_f32 v143, v143
v_rcp_f32 v144, v144
v_mfma_f32_32x32x16_bf16 v[64:79], a[112:115], a[36:39], v[64:79]
v_rcp_f32 v145, v145
v_rcp_f32 v146, v146
v_rcp_f32 v147, v147
v_mfma_f32_32x32x16_bf16 v[64:79], a[120:123], a[40:43], v[64:79]
v_rcp_f32 v148, v148
v_rcp_f32 v149, v149
v_rcp_f32 v150, v150
v_rcp_f32 v151, v151
v_rcp_f32 v152, v152
v_rcp_f32 v153, v153
v_rcp_f32 v154, v154
v_rcp_f32 v155, v155
v_mul_f32 v180, v32, v140
v_mul_f32 v181, v33, v141
v_mul_f32 v182, v34, v142
v_mul_f32 v183, v35, v143
v_mul_f32 v184, v36, v144
v_mul_f32 v185, v37, v145
v_mul_f32 v186, v38, v146
v_mul_f32 v187, v39, v147
v_mul_f32 v188, v40, v148
v_mul_f32 v189, v41, v149
v_mul_f32 v190, v42, v150
v_mul_f32 v191, v43, v151
v_mul_f32 v192, v44, v152
v_mul_f32 v193, v45, v153
v_mul_f32 v194, v46, v154
v_mul_f32 v195, v47, v155
s_waitcnt lgkmcnt(3)
v_add_f32 v64, v64, v112
v_add_f32 v65, v65, v113
v_add_f32 v66, v66, v114
v_add_f32 v67, v67, v115
s_waitcnt lgkmcnt(2)
v_add_f32 v68, v68, v116
v_add_f32 v69, v69, v117
v_add_f32 v70, v70, v118
v_add_f32 v71, v71, v119
s_waitcnt lgkmcnt(1)
v_add_f32 v72, v72, v120
v_add_f32 v73, v73, v121
v_add_f32 v74, v74, v122
v_add_f32 v75, v75, v123
s_waitcnt lgkmcnt(0)
v_add_f32 v76, v76, v124
v_add_f32 v77, v77, v125
v_add_f32 v78, v78, v126
v_add_f32 v79, v79, v127
v_fma_f32 v156, v64, v180, v200
v_fma_f32 v157, v65, v181, v201
v_fma_f32 v158, v66, v182, v202
v_fma_f32 v159, v67, v183, v203
v_fma_f32 v160, v68, v184, v204
v_fma_f32 v161, v69, v185, v205
v_fma_f32 v162, v70, v186, v206
v_fma_f32 v163, v71, v187, v207
v_fma_f32 v164, v72, v188, v208
v_fma_f32 v165, v73, v189, v209
v_fma_f32 v166, v74, v190, v210
v_fma_f32 v167, v75, v191, v211
v_fma_f32 v168, v76, v192, v212
v_fma_f32 v169, v77, v193, v213
v_fma_f32 v170, v78, v194, v214
v_fma_f32 v171, v79, v195, v215
v_cvt_pk_bf16_f32 v172, v156, v157
v_cvt_pk_bf16_f32 v173, v158, v159
v_cvt_pk_bf16_f32 v174, v160, v161
v_cvt_pk_bf16_f32 v175, v162, v163
v_cvt_pk_bf16_f32 v176, v164, v165
v_cvt_pk_bf16_f32 v177, v166, v167
v_cvt_pk_bf16_f32 v178, v168, v169
v_cvt_pk_bf16_f32 v179, v170, v171
v_permlane32_swap_b32 v172, v174
v_permlane32_swap_b32 v173, v175
buffer_store_dwordx4 v[172:175], v138, s[56:59], s93 offen
v_permlane32_swap_b32 v176, v178
v_permlane32_swap_b32 v177, v179
buffer_store_dwordx4 v[176:179], v138, s[56:59], s93 offen offset:32
s_waitcnt vmcnt(0)
L_end:
s_endpgm
L_codeend:
.section .rodata,"a"
.p2align 6
.amdhsa_kernel recurrent_scan__linear_kernel_hedgehog__glu_gated_reglu__prompt_kernel
  .amdhsa_next_free_vgpr 512
  .amdhsa_next_free_sgpr 102
  .amdhsa_accum_offset 256
  .amdhsa_group_segment_fixed_size 0
  .amdhsa_kernarg_size 88
  .amdhsa_user_sgpr_count 2
  .amdhsa_user_sgpr_kernarg_segment_ptr 1
  .amdhsa_system_sgpr_workgroup_id_x 1
.end_amdhsa_kernel
```
